```python
import torch

def _softmax(x, axis=-1):
    return torch.softmax(x, dim=axis)

def _gelu(x):
    return torch.nn.functional.gelu(x, approximate='tanh')

def _silu(x):
    return torch.nn.functional.silu(x)

def _sigmoid(x):
    return torch.sigmoid(x)

def _layernorm(x, axis=-1, eps=1e-05):
    m = x.mean(dim=axis, keepdim=True)
    v = x.var(dim=axis, keepdim=True, unbiased=False)
    return (x - m) / torch.sqrt(v + eps)

def _scatter_add(tgt, idx, src, axis=0):
    return tgt.clone().index_add_(axis, idx, src)

def _segment_sum(src, seg, n):
    out = torch.zeros((n,) + src.shape[1:], dtype=src.dtype)
    return out.index_add_(0, seg, src)

def _pad(x, pw):
    flat = tuple((v for pair in reversed(pw) for v in pair))
    return torch.nn.functional.pad(x, flat)
kernel_name = 'adaLN_cond__sliding_block_cached__glu_gated_swiglu__prompt'

def setup_inputs():

    _w = lambda a: (lambda t: t.to(torch.bfloat16) if t.is_floating_point() else t)(torch.as_tensor(a))

    def _A_setup():
        B, Sq, D = (1, 2048, 576)
        Hq, Hkv, Sk, Dh = (32, 16, 2048, 128)
        assert Hq % Hkv == 0, (Hq, Hkv)
        return {'x': _w((lambda *s: torch.randn(*s, dtype=torch.bfloat16) * 0.05)(B, Sq, D)), 'k_cache': _w((lambda *s: torch.randn(*s, dtype=torch.bfloat16) * 1.6)(B, Hkv, Sk, Dh)), 'v_cache': _w((lambda *s: torch.randn(*s, dtype=torch.bfloat16) * 0.8)(B, Hkv, Sk, Dh)), 'wq': _w((lambda *s: torch.randn(*s, dtype=torch.bfloat16) * 1.6)(D, Hq * Dh) * D ** (-0.5)), 'wo': _w((lambda *s: torch.randn(*s, dtype=torch.bfloat16) * 0.8)(Hq * Dh, D) * (Hq * Dh) ** (-0.5))}
    _A_in = _A_setup()

    def _B_setup():
        B, S, D, F = (1, 2048, 576, 4608)
        return {'x': _w((lambda *s: torch.randn(*s, dtype=torch.bfloat16) * 0.05)(B, S, D)), 'w1': _w((lambda *s: torch.randn(*s, dtype=torch.bfloat16) * 0.4)(D, F) * (2.0 / D) ** 0.5), 'w3': _w((lambda *s: torch.randn(*s, dtype=torch.bfloat16) * 0.4)(D, F) * (2.0 / D) ** 0.5), 'w2': _w((lambda *s: torch.randn(*s, dtype=torch.bfloat16) * 0.4)(F, D) * (2.0 / F) ** 0.5)}
    _B_in = _B_setup()
    return {'A_x': _A_in['x'], 'A_k_cache': _A_in['k_cache'], 'A_v_cache': _A_in['v_cache'], 'A_wq': _A_in['wq'], 'A_wo': _A_in['wo'], 'B_x': _B_in['x'], 'B_w1': _B_in['w1'], 'B_w3': _B_in['w3'], 'B_w2': _B_in['w2'], 'c': _w((lambda *s: torch.randn(*s, dtype=torch.bfloat16) * 0.1)(1, 576) * 8.0), 'w_mod': _w((lambda *s: torch.randn(*s, dtype=torch.bfloat16) * 0.1)(576, 6 * 576) * 576 ** (-0.5) * 8.0)}

def reference(A_x, A_k_cache, A_v_cache, A_wq, A_wo, B_x, B_w1, B_w3, B_w2, c, w_mod):

    def _A_ref(x, k_cache, v_cache, wq, wo):
        B, Sq, D = x.shape
        Hq, Dh = (32, 128)
        Hkv, Sk = (k_cache.shape[1], k_cache.shape[2])
        W = min(4096, max(256, Sk // 4))
        rep = Hq // Hkv
        q = (lambda x, *d: x.permute(*d))((x @ wq).reshape(B, Sq, Hq, Dh), 0, 2, 1, 3)
        k = (lambda x, n, axis: torch.repeat_interleave(x, n, dim=axis))(k_cache[:, :, Sk - W:, :], rep, axis=1)
        v = (lambda x, n, axis: torch.repeat_interleave(x, n, dim=axis))(v_cache[:, :, Sk - W:, :], rep, axis=1)
        scores = torch.einsum('bhqd,bhkd->bhqk', q, k) * Dh ** (-0.5)
        p = _softmax(scores, axis=-1)
        o = torch.einsum('bhqk,bhkd->bhqd', p, v)
        return (lambda x, *d: x.permute(*d))(o, 0, 2, 1, 3).reshape(B, Sq, Hq * Dh) @ wo

    def _B_ref(x, w1, w3, w2):
        gate = torch.einsum('bsd,df->bsf', x, w1)
        up = torch.einsum('bsd,df->bsf', x, w3)
        h = _silu(gate) * up
        out = torch.einsum('bsf,fd->bsd', h, w2)
        return out
    x = A_x
    mod = (_silu(c) @ w_mod).reshape(c.shape[0], 6, 1, -1)
    sa, ca, ga, sb, cb, gb = (mod[:, 0].clone(), mod[:, 1].clone(), mod[:, 2].clone(), mod[:, 3].clone(), mod[:, 4].clone(), mod[:, 5].clone())
    h = _layernorm(x, axis=-1) * (1 + ca) + sa
    x = x + ga * _A_ref(h, A_k_cache, A_v_cache, A_wq, A_wo)
    h = _layernorm(x, axis=-1) * (1 + cb) + sb
    x = x + gb * _B_ref(h, B_w1, B_w3, B_w2)
    return x
```

```asm
; @launch kernel=mod_kernel grid=(256,1,1) block=(256,1,1) lds=1024
; @launch kernel=mega_kernel grid=(256,1,1) block=(256,1,1) lds=163840
.amdgcn_target "amdgcn-amd-amdhsa--gfx950"
.text
.globl mod_kernel
.p2align 8
.type mod_kernel,@function
mod_kernel:

    s_cmp_ge_u32 s2, 256
    s_cbranch_scc1 mod_kernel_end
    s_cmp_ge_u32 s2, 162
    s_cbranch_scc1 mod_kernel_pf
    s_load_dwordx4 s[4:7], s[0:1], 72
    s_load_dwordx2 s[16:17], s[0:1], 104
    v_and_b32 v1, 7, v0
    v_lshrrev_b32 v2, 3, v0
    s_mov_b32 s20, 6912
    v_mul_lo_u32 v3, v2, s20
    v_lshlrev_b32 v4, 4, v1
    v_add_u32 v3, v3, v4
    v_lshlrev_b32 v4, 1, v2
    s_mul_hi_u32 s24, s2, 79536432
    s_mul_i32 s25, s24, 54
    s_sub_u32 s25, s2, s25
    s_lshl_b32 s21, s25, 7
    s_mul_i32 s26, s24, 1327104
    s_add_u32 s21, s21, s26
    s_mul_i32 s27, s24, 384
    s_waitcnt lgkmcnt(0)
    s_mov_b32 s8, s4
    s_mov_b32 s9, s5
    s_mov_b32 s10, 0x480
    s_mov_b32 s11, 0x20000
    s_mov_b32 s12, s6
    s_mov_b32 s13, s7
    s_mov_b32 s14, 0x3cc000
    s_mov_b32 s15, 0x20000
    s_mov_b32 s18, 0x4ed8000
    s_mov_b32 s19, 0x20000
    buffer_load_ushort v10, v4, s[8:11], s27 offen offset:0
    buffer_load_ushort v11, v4, s[8:11], s27 offen offset:64
    buffer_load_ushort v12, v4, s[8:11], s27 offen offset:128
    buffer_load_ushort v13, v4, s[8:11], s27 offen offset:192
    buffer_load_ushort v14, v4, s[8:11], s27 offen offset:256
    buffer_load_ushort v15, v4, s[8:11], s27 offen offset:320
    buffer_load_dwordx4 v[32:35], v3, s[12:15], s21 offen
    s_add_u32 s21, s21, 221184
    buffer_load_dwordx4 v[36:39], v3, s[12:15], s21 offen
    s_add_u32 s21, s21, 221184
    buffer_load_dwordx4 v[40:43], v3, s[12:15], s21 offen
    s_add_u32 s21, s21, 221184
    buffer_load_dwordx4 v[44:47], v3, s[12:15], s21 offen
    s_add_u32 s21, s21, 221184
    buffer_load_dwordx4 v[48:51], v3, s[12:15], s21 offen
    s_add_u32 s21, s21, 221184
    buffer_load_dwordx4 v[52:55], v3, s[12:15], s21 offen
    s_waitcnt vmcnt(11)
    v_lshlrev_b32 v10, 16, v10
    v_mul_f32 v5, 0xbfb8aa3b, v10
    v_exp_f32 v5, v5
    s_nop 0
    v_add_f32 v5, 1.0, v5
    v_rcp_f32 v5, v5
    s_nop 0
    v_mul_f32 v5, v5, v10
    v_cvt_pk_bf16_f32 v5, v5, v5
    v_lshlrev_b32 v10, 16, v5
    s_waitcnt vmcnt(10)
    v_lshlrev_b32 v11, 16, v11
    v_mul_f32 v5, 0xbfb8aa3b, v11
    v_exp_f32 v5, v5
    s_nop 0
    v_add_f32 v5, 1.0, v5
    v_rcp_f32 v5, v5
    s_nop 0
    v_mul_f32 v5, v5, v11
    v_cvt_pk_bf16_f32 v5, v5, v5
    v_lshlrev_b32 v11, 16, v5
    s_waitcnt vmcnt(9)
    v_lshlrev_b32 v12, 16, v12
    v_mul_f32 v5, 0xbfb8aa3b, v12
    v_exp_f32 v5, v5
    s_nop 0
    v_add_f32 v5, 1.0, v5
    v_rcp_f32 v5, v5
    s_nop 0
    v_mul_f32 v5, v5, v12
    v_cvt_pk_bf16_f32 v5, v5, v5
    v_lshlrev_b32 v12, 16, v5
    s_waitcnt vmcnt(8)
    v_lshlrev_b32 v13, 16, v13
    v_mul_f32 v5, 0xbfb8aa3b, v13
    v_exp_f32 v5, v5
    s_nop 0
    v_add_f32 v5, 1.0, v5
    v_rcp_f32 v5, v5
    s_nop 0
    v_mul_f32 v5, v5, v13
    v_cvt_pk_bf16_f32 v5, v5, v5
    v_lshlrev_b32 v13, 16, v5
    s_waitcnt vmcnt(7)
    v_lshlrev_b32 v14, 16, v14
    v_mul_f32 v5, 0xbfb8aa3b, v14
    v_exp_f32 v5, v5
    s_nop 0
    v_add_f32 v5, 1.0, v5
    v_rcp_f32 v5, v5
    s_nop 0
    v_mul_f32 v5, v5, v14
    v_cvt_pk_bf16_f32 v5, v5, v5
    v_lshlrev_b32 v14, 16, v5
    s_waitcnt vmcnt(6)
    v_lshlrev_b32 v15, 16, v15
    v_mul_f32 v5, 0xbfb8aa3b, v15
    v_exp_f32 v5, v5
    s_nop 0
    v_add_f32 v5, 1.0, v5
    v_rcp_f32 v5, v5
    s_nop 0
    v_mul_f32 v5, v5, v15
    v_cvt_pk_bf16_f32 v5, v5, v5
    v_lshlrev_b32 v15, 16, v5
    s_waitcnt vmcnt(5)
    v_lshlrev_b32 v64, 16, v32
    v_and_b32 v65, 0xffff0000, v32
    v_lshlrev_b32 v66, 16, v33
    v_and_b32 v67, 0xffff0000, v33
    v_lshlrev_b32 v68, 16, v34
    v_and_b32 v69, 0xffff0000, v34
    v_lshlrev_b32 v70, 16, v35
    v_and_b32 v71, 0xffff0000, v35
    v_mul_f32 v56, v10, v64
    v_mul_f32 v57, v10, v65
    v_mul_f32 v58, v10, v66
    v_mul_f32 v59, v10, v67
    v_mul_f32 v60, v10, v68
    v_mul_f32 v61, v10, v69
    v_mul_f32 v62, v10, v70
    v_mul_f32 v63, v10, v71
    s_waitcnt vmcnt(4)
    v_lshlrev_b32 v64, 16, v36
    v_and_b32 v65, 0xffff0000, v36
    v_lshlrev_b32 v66, 16, v37
    v_and_b32 v67, 0xffff0000, v37
    v_lshlrev_b32 v68, 16, v38
    v_and_b32 v69, 0xffff0000, v38
    v_lshlrev_b32 v70, 16, v39
    v_and_b32 v71, 0xffff0000, v39
    v_fmac_f32 v56, v11, v64
    v_fmac_f32 v57, v11, v65
    v_fmac_f32 v58, v11, v66
    v_fmac_f32 v59, v11, v67
    v_fmac_f32 v60, v11, v68
    v_fmac_f32 v61, v11, v69
    v_fmac_f32 v62, v11, v70
    v_fmac_f32 v63, v11, v71
    s_waitcnt vmcnt(3)
    v_lshlrev_b32 v64, 16, v40
    v_and_b32 v65, 0xffff0000, v40
    v_lshlrev_b32 v66, 16, v41
    v_and_b32 v67, 0xffff0000, v41
    v_lshlrev_b32 v68, 16, v42
    v_and_b32 v69, 0xffff0000, v42
    v_lshlrev_b32 v70, 16, v43
    v_and_b32 v71, 0xffff0000, v43
    v_fmac_f32 v56, v12, v64
    v_fmac_f32 v57, v12, v65
    v_fmac_f32 v58, v12, v66
    v_fmac_f32 v59, v12, v67
    v_fmac_f32 v60, v12, v68
    v_fmac_f32 v61, v12, v69
    v_fmac_f32 v62, v12, v70
    v_fmac_f32 v63, v12, v71
    s_waitcnt vmcnt(2)
    v_lshlrev_b32 v64, 16, v44
    v_and_b32 v65, 0xffff0000, v44
    v_lshlrev_b32 v66, 16, v45
    v_and_b32 v67, 0xffff0000, v45
    v_lshlrev_b32 v68, 16, v46
    v_and_b32 v69, 0xffff0000, v46
    v_lshlrev_b32 v70, 16, v47
    v_and_b32 v71, 0xffff0000, v47
    v_fmac_f32 v56, v13, v64
    v_fmac_f32 v57, v13, v65
    v_fmac_f32 v58, v13, v66
    v_fmac_f32 v59, v13, v67
    v_fmac_f32 v60, v13, v68
    v_fmac_f32 v61, v13, v69
    v_fmac_f32 v62, v13, v70
    v_fmac_f32 v63, v13, v71
    s_waitcnt vmcnt(1)
    v_lshlrev_b32 v64, 16, v48
    v_and_b32 v65, 0xffff0000, v48
    v_lshlrev_b32 v66, 16, v49
    v_and_b32 v67, 0xffff0000, v49
    v_lshlrev_b32 v68, 16, v50
    v_and_b32 v69, 0xffff0000, v50
    v_lshlrev_b32 v70, 16, v51
    v_and_b32 v71, 0xffff0000, v51
    v_fmac_f32 v56, v14, v64
    v_fmac_f32 v57, v14, v65
    v_fmac_f32 v58, v14, v66
    v_fmac_f32 v59, v14, v67
    v_fmac_f32 v60, v14, v68
    v_fmac_f32 v61, v14, v69
    v_fmac_f32 v62, v14, v70
    v_fmac_f32 v63, v14, v71
    s_waitcnt vmcnt(0)
    v_lshlrev_b32 v64, 16, v52
    v_and_b32 v65, 0xffff0000, v52
    v_lshlrev_b32 v66, 16, v53
    v_and_b32 v67, 0xffff0000, v53
    v_lshlrev_b32 v68, 16, v54
    v_and_b32 v69, 0xffff0000, v54
    v_lshlrev_b32 v70, 16, v55
    v_and_b32 v71, 0xffff0000, v55
    v_fmac_f32 v56, v15, v64
    v_fmac_f32 v57, v15, v65
    v_fmac_f32 v58, v15, v66
    v_fmac_f32 v59, v15, v67
    v_fmac_f32 v60, v15, v68
    v_fmac_f32 v61, v15, v69
    v_fmac_f32 v62, v15, v70
    v_fmac_f32 v63, v15, v71
    v_add_f32_dpp v56, v56, v56 row_ror:8 row_mask:0xf bank_mask:0xf
    v_add_f32_dpp v57, v57, v57 row_ror:8 row_mask:0xf bank_mask:0xf
    v_add_f32_dpp v58, v58, v58 row_ror:8 row_mask:0xf bank_mask:0xf
    v_add_f32_dpp v59, v59, v59 row_ror:8 row_mask:0xf bank_mask:0xf
    v_add_f32_dpp v60, v60, v60 row_ror:8 row_mask:0xf bank_mask:0xf
    v_add_f32_dpp v61, v61, v61 row_ror:8 row_mask:0xf bank_mask:0xf
    v_add_f32_dpp v62, v62, v62 row_ror:8 row_mask:0xf bank_mask:0xf
    v_add_f32_dpp v63, v63, v63 row_ror:8 row_mask:0xf bank_mask:0xf
    v_mov_b32 v64, v56
    v_mov_b32 v65, v57
    v_mov_b32 v66, v58
    v_mov_b32 v67, v59
    v_mov_b32 v68, v60
    v_mov_b32 v69, v61
    v_mov_b32 v70, v62
    v_mov_b32 v71, v63
    v_permlane16_swap_b32 v64, v56
    v_permlane16_swap_b32 v65, v57
    v_permlane16_swap_b32 v66, v58
    v_permlane16_swap_b32 v67, v59
    v_permlane16_swap_b32 v68, v60
    v_permlane16_swap_b32 v69, v61
    v_permlane16_swap_b32 v70, v62
    v_permlane16_swap_b32 v71, v63
    v_add_f32 v56, v56, v64
    v_add_f32 v57, v57, v65
    v_add_f32 v58, v58, v66
    v_add_f32 v59, v59, v67
    v_add_f32 v60, v60, v68
    v_add_f32 v61, v61, v69
    v_add_f32 v62, v62, v70
    v_add_f32 v63, v63, v71
    v_mov_b32 v64, v56
    v_mov_b32 v65, v57
    v_mov_b32 v66, v58
    v_mov_b32 v67, v59
    v_mov_b32 v68, v60
    v_mov_b32 v69, v61
    v_mov_b32 v70, v62
    v_mov_b32 v71, v63
    v_permlane32_swap_b32 v64, v56
    v_permlane32_swap_b32 v65, v57
    v_permlane32_swap_b32 v66, v58
    v_permlane32_swap_b32 v67, v59
    v_permlane32_swap_b32 v68, v60
    v_permlane32_swap_b32 v69, v61
    v_permlane32_swap_b32 v70, v62
    v_permlane32_swap_b32 v71, v63
    v_add_f32 v56, v56, v64
    v_add_f32 v57, v57, v65
    v_add_f32 v58, v58, v66
    v_add_f32 v59, v59, v67
    v_add_f32 v60, v60, v68
    v_add_f32 v61, v61, v69
    v_add_f32 v62, v62, v70
    v_add_f32 v63, v63, v71
    v_lshrrev_b32 v5, 6, v0
    v_lshlrev_b32 v5, 8, v5
    v_lshlrev_b32 v6, 5, v1
    v_add_u32 v5, v5, v6
    v_and_b32 v6, 56, v0
    v_cmp_eq_u32 vcc, 0, v6
    s_and_saveexec_b64 s[22:23], vcc
    ds_write_b128 v5, v[56:59]
    ds_write_b128 v5, v[60:63] offset:16
    s_mov_b64 exec, s[22:23]
    s_waitcnt lgkmcnt(0)
    s_barrier
    v_cmp_gt_u32 vcc, 64, v0
    s_and_saveexec_b64 s[22:23], vcc
    s_cbranch_execz mod_kernel_fin
    v_lshlrev_b32 v5, 2, v0
    ds_read_b32 v32, v5 offset:0
    ds_read_b32 v33, v5 offset:256
    ds_read_b32 v34, v5 offset:512
    ds_read_b32 v35, v5 offset:768
    s_waitcnt lgkmcnt(2)
    v_add_f32 v32, v32, v33
    s_waitcnt lgkmcnt(0)
    v_add_f32 v34, v34, v35
    v_add_f32 v32, v32, v34
    s_mul_i32 s21, s24, 13824
    s_lshl_b32 s26, s25, 8
    s_add_u32 s21, s21, s26
    s_add_u32 s21, s21, 8192
    buffer_store_dword v32, v5, s[16:19], s21 offen
    s_branch mod_kernel_fin
mod_kernel_pf:
    v_and_b32 v1, 63, v0
    v_lshrrev_b32 v2, 6, v0
    s_nop 0
    v_readfirstlane_b32 s24, v2
    s_sub_u32 s22, s2, 163
    s_cmp_lt_u32 s22, 8
    s_cbranch_scc0 mod_kernel_nocp
    s_cmp_eq_u32 s24, 0
    s_cbranch_scc0 mod_kernel_nocp
    s_getpc_b64 s[64:65]
.Lpcfwd1:
    s_add_u32 s64, s64, mega_kernel-.Lpcfwd1
    s_addc_u32 s65, s65, 0
    s_lshl_b32 s66, s22, 13
    v_lshlrev_b32 v60, 7, v1
    v_add_u32 v60, s66, v60
    v_min_u32 v60, mega_kernel_end-mega_kernel-4, v60
    v_mov_b32 v61, s65
    v_add_co_u32 v60, vcc, s64, v60
    s_nop 1
    v_addc_co_u32 v61, vcc, 0, v61, vcc
    global_load_dword v62, v[60:61], off
mod_kernel_nocp:
    s_cmp_ge_u32 s2, 171
    s_cbranch_scc0 mod_kernel_nowq
    s_load_dwordx2 s[8:9], s[0:1], 24
    s_sub_u32 s21, s2, 171
    s_lshl_b32 s21, s21, 2
    s_add_u32 s21, s21, s24
    s_mul_i32 s21, s21, 14336
    v_lshlrev_b32 v3, 4, v1
    s_waitcnt lgkmcnt(0)
    s_mov_b32 s10, 0x480000
    s_mov_b32 s11, 0x20000
    buffer_load_dwordx4 v[12:15], v3, s[8:11], s21 offen offset:0
    buffer_load_dwordx4 v[16:19], v3, s[8:11], s21 offen offset:1024
    buffer_load_dwordx4 v[20:23], v3, s[8:11], s21 offen offset:2048
    buffer_load_dwordx4 v[24:27], v3, s[8:11], s21 offen offset:3072
    s_add_u32 s21, s21, 4096
    buffer_load_dwordx4 v[28:31], v3, s[8:11], s21 offen offset:0
    buffer_load_dwordx4 v[32:35], v3, s[8:11], s21 offen offset:1024
    buffer_load_dwordx4 v[36:39], v3, s[8:11], s21 offen offset:2048
    buffer_load_dwordx4 v[40:43], v3, s[8:11], s21 offen offset:3072
    s_add_u32 s21, s21, 4096
    buffer_load_dwordx4 v[44:47], v3, s[8:11], s21 offen offset:0
    buffer_load_dwordx4 v[48:51], v3, s[8:11], s21 offen offset:1024
    buffer_load_dwordx4 v[52:55], v3, s[8:11], s21 offen offset:2048
    buffer_load_dwordx4 v[56:59], v3, s[8:11], s21 offen offset:3072
    s_add_u32 s21, s21, 4096
    buffer_load_dwordx4 v[60:63], v3, s[8:11], s21 offen offset:0
    buffer_load_dwordx4 v[64:67], v3, s[8:11], s21 offen offset:1024
    s_branch mod_kernel_fin
mod_kernel_nowq:
    s_cmp_lg_u32 s2, 162
    s_cbranch_scc1 mod_kernel_fin
    s_load_dwordx2 s[16:17], s[0:1], 104
    v_lshlrev_b32 v3, 7, v0
    v_mov_b32 v8, 0
    v_mov_b32 v9, 0
    v_mov_b32 v10, 0
    v_mov_b32 v11, 0
    s_waitcnt lgkmcnt(0)
    s_mov_b32 s18, 0x4ed8000
    s_mov_b32 s19, 0x20000
    s_mov_b32 s21, 82640896
    buffer_store_dwordx4 v[8:11], v3, s[16:19], s21 offen offset:0
    buffer_store_dwordx4 v[8:11], v3, s[16:19], s21 offen offset:16
    buffer_store_dwordx4 v[8:11], v3, s[16:19], s21 offen offset:32
    buffer_store_dwordx4 v[8:11], v3, s[16:19], s21 offen offset:48

mod_kernel_fin:
mod_kernel_end:
    s_endpgm

.section .rodata,"a"
.p2align 6
.amdhsa_kernel mod_kernel
  .amdhsa_next_free_vgpr 80
  .amdhsa_next_free_sgpr 102
  .amdhsa_accum_offset 80
  .amdhsa_group_segment_fixed_size 0
  .amdhsa_kernarg_size 112
  .amdhsa_user_sgpr_count 2
  .amdhsa_user_sgpr_kernarg_segment_ptr 1
  .amdhsa_system_sgpr_workgroup_id_x 1
  .amdhsa_float_denorm_mode_32 3
.end_amdhsa_kernel
.text
.text
.globl mega_kernel
.p2align 8
.type mega_kernel,@function
mega_kernel:

    s_cmp_ge_u32 s2, 256
    s_cbranch_scc1 mega_kernel_end
    v_lshrrev_b32 v2, 6, v0
    s_nop 0
    v_readfirstlane_b32 s28, v2
    s_and_b32 s29, s2, 3
    s_lshl_b32 s29, s29, 2
    s_bfe_u32 s30, s2, 0x20003
    s_or_b32 s29, s29, s30
    s_bfe_u32 s30, s2, 0x10002
    s_lshl_b32 s30, s30, 3
    s_lshr_b32 s38, s2, 5
    s_or_b32 s30, s30, s38
    s_cmp_lg_u32 s28, 3
    s_cbranch_scc1 mega_kernel_nocp
    s_lshr_b32 s67, s2, 3
    s_and_b32 s67, s67, 7
    v_and_b32 v59, 63, v0
    s_getpc_b64 s[64:65]
.Lpcback1:
    s_add_u32 s64, s64, mega_kernel-.Lpcback1
    s_addc_u32 s65, s65, -1
    s_lshl_b32 s66, s67, 13
    v_lshlrev_b32 v60, 7, v59
    v_add_u32 v60, s66, v60
    v_min_u32 v60, mega_kernel_end-mega_kernel-4, v60
    v_mov_b32 v61, s65
    v_add_co_u32 v60, vcc, s64, v60
    s_nop 1
    v_addc_co_u32 v61, vcc, 0, v61, vcc
    global_load_dword v62, v[60:61], off
mega_kernel_nocp:
    s_load_dwordx2 s[4:5], s[0:1], 0
    s_load_dwordx2 s[6:7], s[0:1], 88
    s_load_dwordx2 s[20:21], s[0:1], 104
    v_and_b32 v1, 7, v0
    v_lshrrev_b32 v2, 3, v0
    s_mov_b32 s38, 1152
    v_mul_lo_u32 v5, v1, s38
    v_lshlrev_b32 v4, 4, v2
    v_add_u32 v5, v5, v4
    v_lshrrev_b32 v6, 4, v0
    v_lshlrev_b32 v6, 6, v6
    v_and_b32 v3, 1, v2
    v_lshlrev_b32 v3, 5, v3
    v_add3_u32 v6, v6, v3, v1
    v_lshlrev_b32 v6, 4, v6
    s_lshl_b32 s36, s30, 4
    s_add_u32 s36, s36, s29
    s_mul_i32 s32, s36, 9216
    s_lshr_b32 s33, s36, 2
    s_mul_i32 s33, s33, 36864
    s_and_b32 s36, s36, 3
    s_lshl_b32 s36, s36, 7
    s_add_u32 s33, s33, s36
    s_cmp_eq_u32 s28, 0
    s_cselect_b32 s35, 0, 0x7ff00000
    v_add_u32 v4, 160256, v4
    s_cselect_b32 s36, 1024, 0
    v_add_u32 v3, s36, v4
    s_waitcnt lgkmcnt(0)
    s_mov_b32 s8, s4
    s_mov_b32 s9, s5
    s_mov_b32 s10, 0x240000
    s_mov_b32 s11, 0x20000
    s_mov_b32 s12, s6
    s_mov_b32 s13, s7
    s_mov_b32 s14, 0x240000
    s_mov_b32 s15, 0x20000
    s_mov_b32 s22, 0x4ed8000
    s_mov_b32 s23, 0x20000
    s_add_u32 s36, s32, 0
    buffer_load_dwordx4 a[200:203], v5, s[8:11], s36 offen offset:0
    s_add_u32 s36, s32, 0
    buffer_load_dwordx4 a[204:207], v5, s[8:11], s36 offen offset:512
    s_add_u32 s36, s32, 0
    s_add_u32 s36, s36, s35
    buffer_load_dwordx4 a[208:211], v5, s[8:11], s36 offen offset:1024
    v_lshlrev_b32 v2, 4, v0
    s_mov_b32 s36, 10496
    buffer_load_dwordx4 v[64:67], v2, s[20:23], s36 offen sc1
    s_mov_b32 s36, 24320
    buffer_load_dwordx4 v[68:71], v2, s[20:23], s36 offen sc1
    s_mov_b32 s36, 38144
    buffer_load_dwordx4 v[72:75], v2, s[20:23], s36 offen sc1
    s_mov_b32 s36, 8192
    buffer_load_dwordx4 v[76:79], v2, s[20:23], s36 offen sc1
    s_mov_b32 s36, 22016
    buffer_load_dwordx4 v[80:83], v2, s[20:23], s36 offen sc1
    s_mov_b32 s36, 35840
    buffer_load_dwordx4 v[84:87], v2, s[20:23], s36 offen sc1
    v_lshlrev_b32 v9, 3, v0
    v_add_u32 v9, 160256, v9
    v_cmp_gt_u32 vcc, 144, v0
    s_mov_b64 s[92:93], exec
    s_waitcnt vmcnt(4)
    v_add_f32 v64, v64, v68
    v_add_f32 v65, v65, v69
    v_add_f32 v66, v66, v70
    v_add_f32 v67, v67, v71
    s_waitcnt vmcnt(3)
    v_add_f32 v64, v64, v72
    v_add_f32 v65, v65, v73
    v_add_f32 v66, v66, v74
    v_add_f32 v67, v67, v75
    v_cvt_pk_bf16_f32 v68, v64, v65
    v_cvt_pk_bf16_f32 v69, v66, v67
    v_lshlrev_b32 v64, 16, v68
    v_and_b32 v65, 0xffff0000, v68
    v_lshlrev_b32 v66, 16, v69
    v_and_b32 v67, 0xffff0000, v69
    v_add_f32 v64, 1.0, v64
    v_add_f32 v65, 1.0, v65
    v_add_f32 v66, 1.0, v66
    v_add_f32 v67, 1.0, v67
    v_cvt_pk_bf16_f32 v68, v64, v65
    v_cvt_pk_bf16_f32 v69, v66, v67
    s_waitcnt vmcnt(1)
    v_add_f32 v76, v76, v80
    v_add_f32 v77, v77, v81
    v_add_f32 v78, v78, v82
    v_add_f32 v79, v79, v83
    s_waitcnt vmcnt(0)
    v_add_f32 v76, v76, v84
    v_add_f32 v77, v77, v85
    v_add_f32 v78, v78, v86
    v_add_f32 v79, v79, v87
    v_cvt_pk_bf16_f32 v80, v76, v77
    v_cvt_pk_bf16_f32 v81, v78, v79
    s_and_b64 exec, exec, vcc
    ds_write_b64 v9, v[68:69] offset:0
    ds_write_b64 v9, v[80:81] offset:1152
    s_mov_b64 exec, s[92:93]
    s_waitcnt lgkmcnt(0)
    s_barrier
    s_mov_b32 s60, 0x00003f80
    s_mov_b32 s61, 0x3f800000
    v_accvgpr_read_b32 v8, a200
    v_accvgpr_read_b32 v9, a201
    v_accvgpr_read_b32 v10, a202
    v_accvgpr_read_b32 v11, a203
    v_lshlrev_b32 v32, 16, v8
    v_and_b32 v33, 0xffff0000, v8
    v_lshlrev_b32 v34, 16, v9
    v_and_b32 v35, 0xffff0000, v9
    v_lshlrev_b32 v36, 16, v10
    v_and_b32 v37, 0xffff0000, v10
    v_lshlrev_b32 v38, 16, v11
    v_and_b32 v39, 0xffff0000, v11
    v_accvgpr_read_b32 v8, a204
    v_accvgpr_read_b32 v9, a205
    v_accvgpr_read_b32 v10, a206
    v_accvgpr_read_b32 v11, a207
    v_lshlrev_b32 v40, 16, v8
    v_and_b32 v41, 0xffff0000, v8
    v_lshlrev_b32 v42, 16, v9
    v_and_b32 v43, 0xffff0000, v9
    v_lshlrev_b32 v44, 16, v10
    v_and_b32 v45, 0xffff0000, v10
    v_lshlrev_b32 v46, 16, v11
    v_and_b32 v47, 0xffff0000, v11
    v_accvgpr_read_b32 v8, a208
    v_accvgpr_read_b32 v9, a209
    v_accvgpr_read_b32 v10, a210
    v_accvgpr_read_b32 v11, a211
    v_lshlrev_b32 v48, 16, v8
    v_and_b32 v49, 0xffff0000, v8
    v_lshlrev_b32 v50, 16, v9
    v_and_b32 v51, 0xffff0000, v9
    v_lshlrev_b32 v52, 16, v10
    v_and_b32 v53, 0xffff0000, v10
    v_lshlrev_b32 v54, 16, v11
    v_and_b32 v55, 0xffff0000, v11
    s_cmp_eq_u32 s28, 0
    s_cselect_b32 s37, 1.0, 0
    v_mov_b32 v24, 0
    v_add_f32 v24, v24, v32
    v_add_f32 v24, v24, v33
    v_add_f32 v24, v24, v34
    v_add_f32 v24, v24, v35
    v_add_f32 v24, v24, v36
    v_add_f32 v24, v24, v37
    v_add_f32 v24, v24, v38
    v_add_f32 v24, v24, v39
    v_add_f32 v24, v24, v40
    v_add_f32 v24, v24, v41
    v_add_f32 v24, v24, v42
    v_add_f32 v24, v24, v43
    v_add_f32 v24, v24, v44
    v_add_f32 v24, v24, v45
    v_add_f32 v24, v24, v46
    v_add_f32 v24, v24, v47
    v_add_f32 v24, v24, v48
    v_add_f32 v24, v24, v49
    v_add_f32 v24, v24, v50
    v_add_f32 v24, v24, v51
    v_add_f32 v24, v24, v52
    v_add_f32 v24, v24, v53
    v_add_f32 v24, v24, v54
    v_add_f32 v24, v24, v55
    s_nop 1
    v_add_f32_dpp v24, v24, v24 row_ror:8 row_mask:0xf bank_mask:0xf
    v_mov_b32 v25, v24
    s_nop 1
    v_permlane16_swap_b32 v25, v24
    v_add_f32 v24, v24, v25
    v_mov_b32 v25, v24
    s_nop 1
    v_permlane32_swap_b32 v25, v24
    v_add_f32 v24, v24, v25
    v_lshlrev_b32 v25, 2, v1
    v_add_u32 v25, 159744, v25
    s_lshl_b32 s36, s28, 5
    v_add_u32 v26, s36, v25
    ds_write_b32 v26, v24
    s_waitcnt lgkmcnt(0)
    s_barrier
    ds_read_b32 v26, v25 offset:0
    ds_read_b32 v27, v25 offset:32
    ds_read_b32 v28, v25 offset:64
    ds_read_b32 v29, v25 offset:96
    s_waitcnt lgkmcnt(2)
    v_add_f32 v26, v26, v27
    s_waitcnt lgkmcnt(0)
    v_add_f32 v28, v28, v29
    v_add_f32 v30, v26, v28
    v_mul_f32 v30, 0x3ae38e39, v30
    v_mov_b32 v24, 0
    v_sub_f32 v32, v32, v30
    v_sub_f32 v33, v33, v30
    v_sub_f32 v34, v34, v30
    v_sub_f32 v35, v35, v30
    v_sub_f32 v36, v36, v30
    v_sub_f32 v37, v37, v30
    v_sub_f32 v38, v38, v30
    v_sub_f32 v39, v39, v30
    v_fmac_f32 v24, v32, v32
    v_fmac_f32 v24, v33, v33
    v_fmac_f32 v24, v34, v34
    v_fmac_f32 v24, v35, v35
    v_fmac_f32 v24, v36, v36
    v_fmac_f32 v24, v37, v37
    v_fmac_f32 v24, v38, v38
    v_fmac_f32 v24, v39, v39
    v_sub_f32 v40, v40, v30
    v_sub_f32 v41, v41, v30
    v_sub_f32 v42, v42, v30
    v_sub_f32 v43, v43, v30
    v_sub_f32 v44, v44, v30
    v_sub_f32 v45, v45, v30
    v_sub_f32 v46, v46, v30
    v_sub_f32 v47, v47, v30
    v_fmac_f32 v24, v40, v40
    v_fmac_f32 v24, v41, v41
    v_fmac_f32 v24, v42, v42
    v_fmac_f32 v24, v43, v43
    v_fmac_f32 v24, v44, v44
    v_fmac_f32 v24, v45, v45
    v_fmac_f32 v24, v46, v46
    v_fmac_f32 v24, v47, v47
    v_sub_f32 v48, v48, v30
    v_sub_f32 v49, v49, v30
    v_sub_f32 v50, v50, v30
    v_sub_f32 v51, v51, v30
    v_sub_f32 v52, v52, v30
    v_sub_f32 v53, v53, v30
    v_sub_f32 v54, v54, v30
    v_sub_f32 v55, v55, v30
    v_mul_f32 v48, s37, v48
    v_mul_f32 v49, s37, v49
    v_mul_f32 v50, s37, v50
    v_mul_f32 v51, s37, v51
    v_mul_f32 v52, s37, v52
    v_mul_f32 v53, s37, v53
    v_mul_f32 v54, s37, v54
    v_mul_f32 v55, s37, v55
    v_fmac_f32 v24, v48, v48
    v_fmac_f32 v24, v49, v49
    v_fmac_f32 v24, v50, v50
    v_fmac_f32 v24, v51, v51
    v_fmac_f32 v24, v52, v52
    v_fmac_f32 v24, v53, v53
    v_fmac_f32 v24, v54, v54
    v_fmac_f32 v24, v55, v55
    s_nop 1
    v_add_f32_dpp v24, v24, v24 row_ror:8 row_mask:0xf bank_mask:0xf
    v_mov_b32 v25, v24
    s_nop 1
    v_permlane16_swap_b32 v25, v24
    v_add_f32 v24, v24, v25
    v_mov_b32 v25, v24
    s_nop 1
    v_permlane32_swap_b32 v25, v24
    v_add_f32 v24, v24, v25
    v_lshlrev_b32 v25, 2, v1
    v_add_u32 v25, 160000, v25
    s_lshl_b32 s36, s28, 5
    v_add_u32 v26, s36, v25
    ds_write_b32 v26, v24
    s_waitcnt lgkmcnt(0)
    s_barrier
    ds_read_b32 v26, v25 offset:0
    ds_read_b32 v27, v25 offset:32
    ds_read_b32 v28, v25 offset:64
    ds_read_b32 v29, v25 offset:96
    s_waitcnt lgkmcnt(2)
    v_add_f32 v26, v26, v27
    s_waitcnt lgkmcnt(0)
    v_add_f32 v28, v28, v29
    v_add_f32 v31, v26, v28
    v_mov_b32 v25, 0x3727c5ac
    v_fmac_f32 v25, 0x3ae38e39, v31
    v_rsq_f32 v31, v25
    ds_read_b128 v[8:11], v4 offset:0
    ds_read_b128 v[12:15], v4 offset:1152
    s_waitcnt lgkmcnt(1)
    v_lshlrev_b32 v16, 16, v8
    v_and_b32 v17, 0xffff0000, v8
    v_lshlrev_b32 v18, 16, v9
    v_and_b32 v19, 0xffff0000, v9
    v_lshlrev_b32 v20, 16, v10
    v_and_b32 v21, 0xffff0000, v10
    v_lshlrev_b32 v22, 16, v11
    v_and_b32 v23, 0xffff0000, v11
    s_waitcnt lgkmcnt(0)
    v_lshlrev_b32 v56, 16, v12
    v_and_b32 v57, 0xffff0000, v12
    v_lshlrev_b32 v58, 16, v13
    v_and_b32 v59, 0xffff0000, v13
    v_lshlrev_b32 v60, 16, v14
    v_and_b32 v61, 0xffff0000, v14
    v_lshlrev_b32 v62, 16, v15
    v_and_b32 v63, 0xffff0000, v15
    v_mul_f32 v32, v32, v31
    v_mul_f32 v33, v33, v31
    v_mul_f32 v34, v34, v31
    v_mul_f32 v35, v35, v31
    v_mul_f32 v36, v36, v31
    v_mul_f32 v37, v37, v31
    v_mul_f32 v38, v38, v31
    v_mul_f32 v39, v39, v31
    v_fma_f32 v32, v32, v16, v56
    v_fma_f32 v33, v33, v17, v57
    v_fma_f32 v34, v34, v18, v58
    v_fma_f32 v35, v35, v19, v59
    v_fma_f32 v36, v36, v20, v60
    v_fma_f32 v37, v37, v21, v61
    v_fma_f32 v38, v38, v22, v62
    v_fma_f32 v39, v39, v23, v63
    v_mul_f32 v32, 0x3e0293ee, v32
    v_mul_f32 v33, 0x3e0293ee, v33
    v_mul_f32 v34, 0x3e0293ee, v34
    v_mul_f32 v35, 0x3e0293ee, v35
    v_mul_f32 v36, 0x3e0293ee, v36
    v_mul_f32 v37, 0x3e0293ee, v37
    v_mul_f32 v38, 0x3e0293ee, v38
    v_mul_f32 v39, 0x3e0293ee, v39
    v_cvt_pk_bf16_f32 v8, v32, v33
    v_cvt_pk_bf16_f32 v9, v34, v35
    v_cvt_pk_bf16_f32 v10, v36, v37
    v_cvt_pk_bf16_f32 v11, v38, v39
    s_add_u32 s36, s33, 65536
    buffer_store_dwordx4 v[8:11], v6, s[20:23], s36 offen sc1
    s_nop 1
    ds_read_b128 v[8:11], v4 offset:512
    ds_read_b128 v[12:15], v4 offset:1664
    s_waitcnt lgkmcnt(1)
    v_lshlrev_b32 v16, 16, v8
    v_and_b32 v17, 0xffff0000, v8
    v_lshlrev_b32 v18, 16, v9
    v_and_b32 v19, 0xffff0000, v9
    v_lshlrev_b32 v20, 16, v10
    v_and_b32 v21, 0xffff0000, v10
    v_lshlrev_b32 v22, 16, v11
    v_and_b32 v23, 0xffff0000, v11
    s_waitcnt lgkmcnt(0)
    v_lshlrev_b32 v56, 16, v12
    v_and_b32 v57, 0xffff0000, v12
    v_lshlrev_b32 v58, 16, v13
    v_and_b32 v59, 0xffff0000, v13
    v_lshlrev_b32 v60, 16, v14
    v_and_b32 v61, 0xffff0000, v14
    v_lshlrev_b32 v62, 16, v15
    v_and_b32 v63, 0xffff0000, v15
    v_mul_f32 v40, v40, v31
    v_mul_f32 v41, v41, v31
    v_mul_f32 v42, v42, v31
    v_mul_f32 v43, v43, v31
    v_mul_f32 v44, v44, v31
    v_mul_f32 v45, v45, v31
    v_mul_f32 v46, v46, v31
    v_mul_f32 v47, v47, v31
    v_fma_f32 v40, v40, v16, v56
    v_fma_f32 v41, v41, v17, v57
    v_fma_f32 v42, v42, v18, v58
    v_fma_f32 v43, v43, v19, v59
    v_fma_f32 v44, v44, v20, v60
    v_fma_f32 v45, v45, v21, v61
    v_fma_f32 v46, v46, v22, v62
    v_fma_f32 v47, v47, v23, v63
    v_mul_f32 v40, 0x3e0293ee, v40
    v_mul_f32 v41, 0x3e0293ee, v41
    v_mul_f32 v42, 0x3e0293ee, v42
    v_mul_f32 v43, 0x3e0293ee, v43
    v_mul_f32 v44, 0x3e0293ee, v44
    v_mul_f32 v45, 0x3e0293ee, v45
    v_mul_f32 v46, 0x3e0293ee, v46
    v_mul_f32 v47, 0x3e0293ee, v47
    v_cvt_pk_bf16_f32 v8, v40, v41
    v_cvt_pk_bf16_f32 v9, v42, v43
    v_cvt_pk_bf16_f32 v10, v44, v45
    v_cvt_pk_bf16_f32 v11, v46, v47
    s_add_u32 s36, s33, 81920
    buffer_store_dwordx4 v[8:11], v6, s[20:23], s36 offen sc1
    s_nop 1
    ds_read_b128 v[8:11], v3 offset:0
    ds_read_b128 v[12:15], v3 offset:1152
    s_waitcnt lgkmcnt(1)
    v_lshlrev_b32 v16, 16, v8
    v_and_b32 v17, 0xffff0000, v8
    v_lshlrev_b32 v18, 16, v9
    v_and_b32 v19, 0xffff0000, v9
    v_lshlrev_b32 v20, 16, v10
    v_and_b32 v21, 0xffff0000, v10
    v_lshlrev_b32 v22, 16, v11
    v_and_b32 v23, 0xffff0000, v11
    s_waitcnt lgkmcnt(0)
    v_lshlrev_b32 v56, 16, v12
    v_and_b32 v57, 0xffff0000, v12
    v_lshlrev_b32 v58, 16, v13
    v_and_b32 v59, 0xffff0000, v13
    v_lshlrev_b32 v60, 16, v14
    v_and_b32 v61, 0xffff0000, v14
    v_lshlrev_b32 v62, 16, v15
    v_and_b32 v63, 0xffff0000, v15
    v_mul_f32 v48, v48, v31
    v_mul_f32 v49, v49, v31
    v_mul_f32 v50, v50, v31
    v_mul_f32 v51, v51, v31
    v_mul_f32 v52, v52, v31
    v_mul_f32 v53, v53, v31
    v_mul_f32 v54, v54, v31
    v_mul_f32 v55, v55, v31
    v_fma_f32 v48, v48, v16, v56
    v_fma_f32 v49, v49, v17, v57
    v_fma_f32 v50, v50, v18, v58
    v_fma_f32 v51, v51, v19, v59
    v_fma_f32 v52, v52, v20, v60
    v_fma_f32 v53, v53, v21, v61
    v_fma_f32 v54, v54, v22, v62
    v_fma_f32 v55, v55, v23, v63
    v_mul_f32 v48, 0x3e0293ee, v48
    v_mul_f32 v49, 0x3e0293ee, v49
    v_mul_f32 v50, 0x3e0293ee, v50
    v_mul_f32 v51, 0x3e0293ee, v51
    v_mul_f32 v52, 0x3e0293ee, v52
    v_mul_f32 v53, 0x3e0293ee, v53
    v_mul_f32 v54, 0x3e0293ee, v54
    v_mul_f32 v55, 0x3e0293ee, v55
    v_cvt_pk_bf16_f32 v8, v48, v49
    v_cvt_pk_bf16_f32 v9, v50, v51
    v_cvt_pk_bf16_f32 v10, v52, v53
    v_cvt_pk_bf16_f32 v11, v54, v55
    s_add_u32 s36, s33, 98304
    s_add_u32 s36, s36, s35
    buffer_store_dwordx4 v[8:11], v6, s[20:23], s36 offen sc1
    s_waitcnt vmcnt(0)
    s_barrier
    s_cmp_lg_u32 s28, 0
    s_cbranch_scc1 mega_kernel_sigas
    s_lshl_b32 s90, s30, 9
    s_lshr_b32 s91, s29, 2
    s_lshl_b32 s91, s91, 7
    s_add_u32 s90, s90, s91
    s_add_u32 s90, s90, 82640896
    s_mov_b64 s[92:93], exec
    s_mov_b64 exec, 1
    v_mov_b32 v250, 1
    v_mov_b32 v251, 0
    buffer_atomic_add v250, v251, s[20:23], s90 offen
    s_mov_b64 exec, s[92:93]
mega_kernel_sigas:
    s_load_dwordx4 s[4:7], s[0:1], 24
    s_load_dwordx4 s[12:15], s[0:1], 8
    s_load_dwordx2 s[20:21], s[0:1], 104
    v_and_b32 v1, 63, v0
    v_lshrrev_b32 v2, 6, v0
    s_nop 0
    v_readfirstlane_b32 s28, v2
    s_and_b32 s29, s2, 3
    s_lshl_b32 s29, s29, 2
    s_bfe_u32 s30, s2, 0x20003
    s_or_b32 s29, s29, s30
    s_bfe_u32 s30, s2, 0x10002
    s_lshl_b32 s30, s30, 3
    s_lshr_b32 s38, s2, 5
    s_or_b32 s30, s30, s38
    s_lshl_b32 s31, s30, 2
    s_add_u32 s31, s31, s28
    s_mul_i32 s32, s28, 9216
    s_lshl_b32 s34, s28, 13
    s_lshl_b32 s33, s29, 9
    v_lshrrev_b32 v2, 3, v1
    s_mov_b32 s38, 8192
    v_mul_lo_u32 v19, v2, s38
    v_bfe_u32 v2, v1, 4, 1
    v_lshlrev_b32 v2, 2, v2
    v_and_b32 v3, 7, v1
    v_xor_b32 v2, v2, v3
    v_lshlrev_b32 v2, 4, v2
    v_add_u32 v19, v19, v2
    s_mul_i32 s38, s28, 589824
    v_add_u32 v19, s38, v19
    s_mov_b32 s44, 0
    s_mov_b32 s45, 64512
    s_mov_b32 s46, 129024
    s_mov_b32 s47, 193536
    s_mov_b32 s48, 262144
    s_mov_b32 s49, 326656
    s_mov_b32 s50, 391168
    s_mov_b32 s51, 455680
    s_mov_b32 s52, 524288
    s_waitcnt lgkmcnt(0)
    s_mov_b32 s8, s4
    s_mov_b32 s9, s5
    s_mov_b32 s10, 0x480000
    s_mov_b32 s11, 0x20000
    s_mov_b32 s24, s6
    s_mov_b32 s25, s7
    s_mov_b32 s26, 0x480000
    s_mov_b32 s27, 0x20000
    s_mov_b32 s16, s14
    s_mov_b32 s17, s15
    s_mov_b32 s18, 0x800000
    s_mov_b32 s19, 0x20000
    s_mov_b32 s14, 0x800000
    s_mov_b32 s15, 0x20000
    s_mov_b32 s22, 0x4ed8000
    s_mov_b32 s23, 0x20000
    v_lshrrev_b32 v2, 5, v1
    v_lshlrev_b32 v2, 3, v2
    v_bfe_u32 v3, v1, 2, 2
    v_add_u32 v2, v2, v3
    v_lshlrev_b32 v10, 7, v2
    v_lshrrev_b32 v3, 1, v3
    v_lshlrev_b32 v3, 6, v3
    v_add_u32 v10, v10, v3
    v_bfe_u32 v2, v1, 4, 1
    v_lshlrev_b32 v2, 5, v2
    v_and_b32 v3, 1, v1
    v_lshlrev_b32 v3, 4, v3
    v_add_u32 v2, v2, v3
    v_bfe_u32 v3, v1, 1, 1
    v_lshlrev_b32 v3, 3, v3
    v_add_u32 v2, v2, v3
    v_add_u32 v10, v10, v2
    v_xor_b32 v11, 64, v10
    v_and_b32 v2, 3, v1
    v_bfe_u32 v3, v1, 2, 1
    v_bfe_u32 v4, v1, 3, 1
    v_bfe_u32 v5, v1, 4, 1
    v_lshlrev_b32 v3, 1, v3
    v_lshlrev_b32 v5, 2, v5
    v_add3_u32 v3, v3, v4, v5
    v_mul_u32_u24 v3, 1088, v3
    v_lshlrev_b32 v4, 8, v2
    v_lshrrev_b32 v5, 5, v1
    v_xor_b32 v5, v5, v2
    v_lshlrev_b32 v5, 4, v5
    v_add3_u32 v12, v3, v4, v5
    v_xor_b32 v5, 32, v5
    v_add3_u32 v13, v3, v4, v5
    v_lshrrev_b32 v2, 4, v1
    v_and_b32 v3, 15, v1
    v_xor_b32 v3, v3, v2
    v_lshlrev_b32 v3, 4, v3
    v_lshlrev_b32 v2, 8, v2
    s_lshl_b32 s38, s28, 11
    v_add3_u32 v21, v2, v3, s38
    v_lshrrev_b32 v2, 3, v1
    s_mov_b32 s38, 256
    v_mul_lo_u32 v22, v2, s38
    v_bfe_u32 v2, v1, 4, 1
    v_lshlrev_b32 v2, 2, v2
    v_and_b32 v3, 7, v1
    v_xor_b32 v2, v2, v3
    v_lshlrev_b32 v2, 4, v2
    v_add_u32 v22, v22, v2
    s_mul_i32 s38, s28, 0
    v_add_u32 v22, s38, v22
    s_lshr_b32 s36, s28, 1
    s_and_b32 s37, s28, 1
    s_lshl_b32 s38, s36, 7
    s_lshl_b32 s76, s37, 12
    s_add_u32 s38, s38, s76
    v_add_u32 v22, s38, v22
    s_lshl_b32 s75, s36, 12
    s_lshl_b32 s76, s37, 11
    s_add_u32 s75, s75, s76
    s_mul_i32 s74, s28, 2176
    s_add_u32 s74, s74, 8192
    s_lshl_b32 s66, s29, 11
    s_add_u32 s66, s66, 1536
    s_lshl_b32 s66, s66, 8
    v_lshrrev_b32 v2, 3, v1
    s_mov_b32 s38, 1152
    v_mul_lo_u32 v20, v2, s38
    v_bfe_u32 v2, v1, 4, 1
    v_lshlrev_b32 v2, 2, v2
    v_and_b32 v3, 7, v1
    v_xor_b32 v2, v2, v3
    v_lshlrev_b32 v2, 4, v2
    v_add_u32 v20, v20, v2
    s_mul_i32 s38, s28, 73728
    v_add_u32 v20, s38, v20
    s_mul_i32 s38, s29, 294912
    v_add_u32 v20, s38, v20
    s_mov_b32 s54, 0
    s_mov_b32 s55, 8192
    s_mov_b32 s56, 16384
    s_mov_b32 s57, 24576
    s_mov_b32 s58, 36864
    s_mov_b32 s59, 45056
    s_mov_b32 s60, 53248
    s_mov_b32 s61, 61440
    v_lshlrev_b32 v9, 4, v1
    s_lshl_b32 s70, s29, 6
    s_add_u32 s70, s70, s31
    s_mul_i32 s70, s70, 36864
    s_add_u32 s70, s70, 7143424
    v_mov_b32 v112, 0
    v_mov_b32 v113, 0
    v_mov_b32 v114, 0
    v_mov_b32 v115, 0
    v_mov_b32 v116, 0
    v_mov_b32 v117, 0
    v_mov_b32 v118, 0
    v_mov_b32 v119, 0
    v_mov_b32 v120, 0
    v_mov_b32 v121, 0
    v_mov_b32 v122, 0
    v_mov_b32 v123, 0
    v_mov_b32 v124, 0
    v_mov_b32 v125, 0
    v_mov_b32 v126, 0
    v_mov_b32 v127, 0
    v_mov_b32 v128, 0
    v_mov_b32 v129, 0
    v_mov_b32 v130, 0
    v_mov_b32 v131, 0
    v_mov_b32 v132, 0
    v_mov_b32 v133, 0
    v_mov_b32 v134, 0
    v_mov_b32 v135, 0
    v_mov_b32 v136, 0
    v_mov_b32 v137, 0
    v_mov_b32 v138, 0
    v_mov_b32 v139, 0
    v_mov_b32 v140, 0
    v_mov_b32 v141, 0
    v_mov_b32 v142, 0
    v_mov_b32 v143, 0
    v_mov_b32 v144, 0
    v_mov_b32 v145, 0
    v_mov_b32 v146, 0
    v_mov_b32 v147, 0
    v_mov_b32 v148, 0
    v_mov_b32 v149, 0
    v_mov_b32 v150, 0
    v_mov_b32 v151, 0
    v_mov_b32 v152, 0
    v_mov_b32 v153, 0
    v_mov_b32 v154, 0
    v_mov_b32 v155, 0
    v_mov_b32 v156, 0
    v_mov_b32 v157, 0
    v_mov_b32 v158, 0
    v_mov_b32 v159, 0
    v_mov_b32 v160, 0
    v_mov_b32 v161, 0
    v_mov_b32 v162, 0
    v_mov_b32 v163, 0
    v_mov_b32 v164, 0
    v_mov_b32 v165, 0
    v_mov_b32 v166, 0
    v_mov_b32 v167, 0
    v_mov_b32 v168, 0
    v_mov_b32 v169, 0
    v_mov_b32 v170, 0
    v_mov_b32 v171, 0
    v_mov_b32 v172, 0
    v_mov_b32 v173, 0
    v_mov_b32 v174, 0
    v_mov_b32 v175, 0
    v_mov_b32 v176, 0
    v_mov_b32 v177, 0
    v_mov_b32 v178, 0
    v_mov_b32 v179, 0
    v_mov_b32 v180, 0
    v_mov_b32 v181, 0
    v_mov_b32 v182, 0
    v_mov_b32 v183, 0
    v_mov_b32 v184, 0
    v_mov_b32 v185, 0
    v_mov_b32 v186, 0
    v_mov_b32 v187, 0
    v_mov_b32 v188, 0
    v_mov_b32 v189, 0
    v_mov_b32 v190, 0
    v_mov_b32 v191, 0
    v_mov_b32 v192, 0
    v_mov_b32 v193, 0
    v_mov_b32 v194, 0
    v_mov_b32 v195, 0
    v_mov_b32 v196, 0
    v_mov_b32 v197, 0
    v_mov_b32 v198, 0
    v_mov_b32 v199, 0
    v_mov_b32 v200, 0
    v_mov_b32 v201, 0
    v_mov_b32 v202, 0
    v_mov_b32 v203, 0
    v_mov_b32 v204, 0
    v_mov_b32 v205, 0
    v_mov_b32 v206, 0
    v_mov_b32 v207, 0
    v_mov_b32 v208, 0
    v_mov_b32 v209, 0
    v_mov_b32 v210, 0
    v_mov_b32 v211, 0
    v_mov_b32 v212, 0
    v_mov_b32 v213, 0
    v_mov_b32 v214, 0
    v_mov_b32 v215, 0
    v_mov_b32 v216, 0
    v_mov_b32 v217, 0
    v_mov_b32 v218, 0
    v_mov_b32 v219, 0
    v_mov_b32 v220, 0
    v_mov_b32 v221, 0
    v_mov_b32 v222, 0
    v_mov_b32 v223, 0
    v_mov_b32 v224, 0
    v_mov_b32 v225, 0
    v_mov_b32 v226, 0
    v_mov_b32 v227, 0
    v_mov_b32 v228, 0
    v_mov_b32 v229, 0
    v_mov_b32 v230, 0
    v_mov_b32 v231, 0
    v_mov_b32 v232, 0
    v_mov_b32 v233, 0
    v_mov_b32 v234, 0
    v_mov_b32 v235, 0
    v_mov_b32 v236, 0
    v_mov_b32 v237, 0
    v_mov_b32 v238, 0
    v_mov_b32 v239, 0
    v_mov_b32 v64, 0
    v_accvgpr_write_b32 a224, 0
    v_mov_b32 v65, 0
    v_accvgpr_write_b32 a225, 0
    v_mov_b32 v66, 0
    v_accvgpr_write_b32 a226, 0
    v_mov_b32 v67, 0
    v_accvgpr_write_b32 a227, 0
    v_mov_b32 v68, 0
    v_accvgpr_write_b32 a228, 0
    v_mov_b32 v69, 0
    v_accvgpr_write_b32 a229, 0
    v_mov_b32 v70, 0
    v_accvgpr_write_b32 a230, 0
    v_mov_b32 v71, 0
    v_accvgpr_write_b32 a231, 0
    v_mov_b32 v72, 0
    v_accvgpr_write_b32 a232, 0
    v_mov_b32 v73, 0
    v_accvgpr_write_b32 a233, 0
    v_mov_b32 v74, 0
    v_accvgpr_write_b32 a234, 0
    v_mov_b32 v75, 0
    v_accvgpr_write_b32 a235, 0
    v_mov_b32 v76, 0
    v_accvgpr_write_b32 a236, 0
    v_mov_b32 v77, 0
    v_accvgpr_write_b32 a237, 0
    v_mov_b32 v78, 0
    v_accvgpr_write_b32 a238, 0
    v_mov_b32 v79, 0
    v_accvgpr_write_b32 a239, 0
    v_mov_b32 v80, 0
    v_accvgpr_write_b32 a240, 0
    v_mov_b32 v81, 0
    v_accvgpr_write_b32 a241, 0
    v_mov_b32 v82, 0
    v_accvgpr_write_b32 a242, 0
    v_mov_b32 v83, 0
    v_accvgpr_write_b32 a243, 0
    v_mov_b32 v84, 0
    v_accvgpr_write_b32 a244, 0
    v_mov_b32 v85, 0
    v_accvgpr_write_b32 a245, 0
    v_mov_b32 v86, 0
    v_accvgpr_write_b32 a246, 0
    v_mov_b32 v87, 0
    v_accvgpr_write_b32 a247, 0
    v_mov_b32 v88, 0
    v_accvgpr_write_b32 a248, 0
    v_mov_b32 v89, 0
    v_accvgpr_write_b32 a249, 0
    v_mov_b32 v90, 0
    v_accvgpr_write_b32 a250, 0
    v_mov_b32 v91, 0
    v_accvgpr_write_b32 a251, 0
    v_mov_b32 v92, 0
    v_accvgpr_write_b32 a252, 0
    v_mov_b32 v93, 0
    v_accvgpr_write_b32 a253, 0
    v_mov_b32 v94, 0
    v_accvgpr_write_b32 a254, 0
    v_mov_b32 v95, 0
    v_accvgpr_write_b32 a255, 0
    v_mov_b32 v23, 0
    v_mov_b32 v24, 0
    s_mov_b32 s39, 0xff800000
    s_mov_b32 s40, 0xff800000
    s_mov_b32 s41, 0xff7fffff
    s_mov_b32 s42, 0xff7fffff
    s_lshl_b32 s90, s30, 9
    s_lshl_b32 s91, s28, 7
    s_add_u32 s90, s90, s91
    s_add_u32 s90, s90, 82640896
    s_mov_b32 s91, 0
    v_mov_b32 v251, 0
mega_kernel_wta:
    buffer_load_dword v250, v251, s[20:23], s90 offen sc1
    s_waitcnt vmcnt(0)
    v_readfirstlane_b32 s94, v250
    s_add_u32 s91, s91, 1
    s_cmp_ge_u32 s94, 4
    s_cbranch_scc1 mega_kernel_wua
    s_cmp_lt_u32 s91, 400000
    s_cbranch_scc0 mega_kernel_wua
    s_sleep 1
    s_branch mega_kernel_wta
mega_kernel_wua:
    s_add_u32 m0, s32, 0
    v_add_u32 v18, s33, v19
    buffer_load_dwordx4 v18, s[8:11], s44 offen offset:0 lds
    buffer_load_dwordx4 v18, s[8:11], s45 offen offset:1024 lds
    buffer_load_dwordx4 v18, s[8:11], s46 offen offset:2048 lds
    buffer_load_dwordx4 v18, s[8:11], s47 offen offset:3072 lds
    s_add_u32 m0, s32, 4096
    s_nop 0
    buffer_load_dwordx4 v18, s[8:11], s48 offen offset:0 lds
    buffer_load_dwordx4 v18, s[8:11], s49 offen offset:1024 lds
    buffer_load_dwordx4 v18, s[8:11], s50 offen offset:2048 lds
    buffer_load_dwordx4 v18, s[8:11], s51 offen offset:3072 lds
    s_add_u32 m0, s32, 8192
    s_nop 0
    buffer_load_dwordx4 v18, s[8:11], s52 offen offset:0 lds
    v_lshlrev_b32 v3, 4, v1
    s_mul_i32 s43, s31, 36864
    s_add_u32 s43, s43, 65536
    buffer_load_dwordx4 a[0:3], v3, s[20:23], s43 offen offset:0 sc1
    buffer_load_dwordx4 a[4:7], v3, s[20:23], s43 offen offset:1024 sc1
    buffer_load_dwordx4 a[8:11], v3, s[20:23], s43 offen offset:2048 sc1
    buffer_load_dwordx4 a[12:15], v3, s[20:23], s43 offen offset:3072 sc1
    s_add_u32 s43, s43, 4096
    buffer_load_dwordx4 a[16:19], v3, s[20:23], s43 offen offset:0 sc1
    buffer_load_dwordx4 a[20:23], v3, s[20:23], s43 offen offset:1024 sc1
    buffer_load_dwordx4 a[24:27], v3, s[20:23], s43 offen offset:2048 sc1
    buffer_load_dwordx4 a[28:31], v3, s[20:23], s43 offen offset:3072 sc1
    s_add_u32 s43, s43, 4096
    buffer_load_dwordx4 a[32:35], v3, s[20:23], s43 offen offset:0 sc1
    buffer_load_dwordx4 a[36:39], v3, s[20:23], s43 offen offset:1024 sc1
    buffer_load_dwordx4 a[40:43], v3, s[20:23], s43 offen offset:2048 sc1
    buffer_load_dwordx4 a[44:47], v3, s[20:23], s43 offen offset:3072 sc1
    s_add_u32 s43, s43, 4096
    s_add_u32 m0, s32, 36864
    s_add_u32 s38, s33, 2359296
    v_add_u32 v18, s38, v19
    buffer_load_dwordx4 v18, s[8:11], s44 offen offset:0 lds
    buffer_load_dwordx4 v18, s[8:11], s45 offen offset:1024 lds
    buffer_load_dwordx4 v18, s[8:11], s46 offen offset:2048 lds
    buffer_load_dwordx4 v18, s[8:11], s47 offen offset:3072 lds
    s_add_u32 m0, s32, 40960
    s_nop 0
    buffer_load_dwordx4 v18, s[8:11], s48 offen offset:0 lds
    buffer_load_dwordx4 v18, s[8:11], s49 offen offset:1024 lds
    buffer_load_dwordx4 v18, s[8:11], s50 offen offset:2048 lds
    buffer_load_dwordx4 v18, s[8:11], s51 offen offset:3072 lds
    s_add_u32 m0, s32, 45056
    s_nop 0
    buffer_load_dwordx4 v18, s[8:11], s52 offen offset:0 lds
    s_waitcnt vmcnt(21)
    s_barrier
    v_mov_b32 v14, v10
    v_mov_b32 v15, v11
    ds_read_b64_tr_b16 a[208:209], v14 offset:0
    ds_read_b64_tr_b16 a[210:211], v14 offset:512
    ds_read_b64_tr_b16 a[212:213], v14 offset:2048
    ds_read_b64_tr_b16 a[214:215], v14 offset:2560
    ds_read_b64_tr_b16 a[216:217], v14 offset:4096
    ds_read_b64_tr_b16 a[218:219], v14 offset:4608
    ds_read_b64_tr_b16 a[220:221], v14 offset:6144
    ds_read_b64_tr_b16 a[222:223], v14 offset:6656
    s_mov_b32 s35, 0
    s_mov_b32 s62, 36864
    s_mov_b32 s63, 73728
    s_add_u32 s36, s33, 128
    s_cmp_lt_u32 s35, 3
    s_cselect_b32 s10, 0x480000, 0
    s_waitcnt lgkmcnt(4)
    s_waitcnt vmcnt(20)
    v_mfma_f32_32x32x16_bf16 v[32:47], a[208:211], a[0:3], 0
    ds_read_b64_tr_b16 a[208:209], v14 offset:8192
    ds_read_b64_tr_b16 a[210:211], v14 offset:8704
    s_add_u32 s37, s32, s63
    s_cmp_lt_u32 s35, 3
    s_cselect_b32 s64, s37, 147456
    buffer_load_dwordx4 a[48:51], v3, s[20:23], s43 offen offset:0 sc1
    buffer_load_dwordx4 a[52:55], v3, s[20:23], s43 offen offset:1024 sc1
    s_waitcnt vmcnt(21)
    v_mfma_f32_32x32x16_bf16 v[32:47], a[212:215], a[4:7], v[32:47]
    ds_read_b64_tr_b16 a[212:213], v14 offset:10240
    ds_read_b64_tr_b16 a[214:215], v14 offset:10752
    buffer_load_dwordx4 a[56:59], v3, s[20:23], s43 offen offset:2048 sc1
    buffer_load_dwordx4 a[60:63], v3, s[20:23], s43 offen offset:3072 sc1
    s_add_u32 s43, s43, 4096
    s_waitcnt lgkmcnt(4)
    s_waitcnt vmcnt(22)
    v_mfma_f32_32x32x16_bf16 v[32:47], a[216:219], a[8:11], v[32:47]
    ds_read_b64_tr_b16 a[216:217], v14 offset:12288
    ds_read_b64_tr_b16 a[218:219], v14 offset:12800
    buffer_load_dwordx4 a[64:67], v3, s[20:23], s43 offen offset:0 sc1
    buffer_load_dwordx4 a[68:71], v3, s[20:23], s43 offen offset:1024 sc1
    s_waitcnt vmcnt(23)
    v_mfma_f32_32x32x16_bf16 v[32:47], a[220:223], a[12:15], v[32:47]
    ds_read_b64_tr_b16 a[220:221], v14 offset:14336
    ds_read_b64_tr_b16 a[222:223], v14 offset:14848
    buffer_load_dwordx4 a[72:75], v3, s[20:23], s43 offen offset:2048 sc1
    buffer_load_dwordx4 a[76:79], v3, s[20:23], s43 offen offset:3072 sc1
    s_add_u32 s43, s43, 4096
    s_waitcnt lgkmcnt(4)
    s_waitcnt vmcnt(24)
    v_mfma_f32_32x32x16_bf16 v[32:47], a[208:211], a[16:19], v[32:47]
    ds_read_b64_tr_b16 a[208:209], v14 offset:16384
    ds_read_b64_tr_b16 a[210:211], v14 offset:16896
    buffer_load_dwordx4 a[80:83], v3, s[20:23], s43 offen offset:0 sc1
    buffer_load_dwordx4 a[84:87], v3, s[20:23], s43 offen offset:1024 sc1
    s_waitcnt vmcnt(25)
    v_mfma_f32_32x32x16_bf16 v[32:47], a[212:215], a[20:23], v[32:47]
    ds_read_b64_tr_b16 a[212:213], v14 offset:18432
    ds_read_b64_tr_b16 a[214:215], v14 offset:18944
    buffer_load_dwordx4 a[88:91], v3, s[20:23], s43 offen offset:2048 sc1
    buffer_load_dwordx4 a[92:95], v3, s[20:23], s43 offen offset:3072 sc1
    s_add_u32 s43, s43, 4096
    s_waitcnt lgkmcnt(4)
    s_waitcnt vmcnt(26)
    v_mfma_f32_32x32x16_bf16 v[32:47], a[216:219], a[24:27], v[32:47]
    ds_read_b64_tr_b16 a[216:217], v14 offset:20480
    ds_read_b64_tr_b16 a[218:219], v14 offset:20992
    buffer_load_dwordx4 a[96:99], v3, s[20:23], s43 offen offset:0 sc1
    buffer_load_dwordx4 a[100:103], v3, s[20:23], s43 offen offset:1024 sc1
    s_waitcnt vmcnt(27)
    v_mfma_f32_32x32x16_bf16 v[32:47], a[220:223], a[28:31], v[32:47]
    ds_read_b64_tr_b16 a[220:221], v14 offset:22528
    ds_read_b64_tr_b16 a[222:223], v14 offset:23040
    buffer_load_dwordx4 a[104:107], v3, s[20:23], s43 offen offset:2048 sc1
    buffer_load_dwordx4 a[108:111], v3, s[20:23], s43 offen offset:3072 sc1
    s_add_u32 s43, s43, 4096
    s_waitcnt lgkmcnt(4)
    s_waitcnt vmcnt(28)
    v_mfma_f32_32x32x16_bf16 v[32:47], a[208:211], a[32:35], v[32:47]
    ds_read_b64_tr_b16 a[208:209], v14 offset:24576
    ds_read_b64_tr_b16 a[210:211], v14 offset:25088
    buffer_load_dwordx4 a[112:115], v3, s[20:23], s43 offen offset:0 sc1
    buffer_load_dwordx4 a[116:119], v3, s[20:23], s43 offen offset:1024 sc1
    s_waitcnt vmcnt(29)
    v_mfma_f32_32x32x16_bf16 v[32:47], a[212:215], a[36:39], v[32:47]
    ds_read_b64_tr_b16 a[212:213], v14 offset:26624
    ds_read_b64_tr_b16 a[214:215], v14 offset:27136
    buffer_load_dwordx4 a[120:123], v3, s[20:23], s43 offen offset:2048 sc1
    buffer_load_dwordx4 a[124:127], v3, s[20:23], s43 offen offset:3072 sc1
    s_add_u32 s43, s43, 4096
    s_waitcnt lgkmcnt(4)
    s_waitcnt vmcnt(30)
    v_mfma_f32_32x32x16_bf16 v[32:47], a[216:219], a[40:43], v[32:47]
    ds_read_b64_tr_b16 a[216:217], v14 offset:28672
    ds_read_b64_tr_b16 a[218:219], v14 offset:29184
    buffer_load_dwordx4 a[128:131], v3, s[20:23], s43 offen offset:0 sc1
    buffer_load_dwordx4 a[132:135], v3, s[20:23], s43 offen offset:1024 sc1
    s_waitcnt vmcnt(31)
    v_mfma_f32_32x32x16_bf16 v[32:47], a[220:223], a[44:47], v[32:47]
    ds_read_b64_tr_b16 a[220:221], v14 offset:30720
    ds_read_b64_tr_b16 a[222:223], v14 offset:31232
    buffer_load_dwordx4 a[136:139], v3, s[20:23], s43 offen offset:2048 sc1
    buffer_load_dwordx4 a[140:143], v3, s[20:23], s43 offen offset:3072 sc1
    s_waitcnt lgkmcnt(4)
    s_waitcnt vmcnt(23)
    v_mfma_f32_32x32x16_bf16 v[32:47], a[208:211], a[48:51], v[32:47]
    ds_read_b64_tr_b16 a[208:209], v14 offset:32768
    ds_read_b64_tr_b16 a[210:211], v14 offset:33280
    s_add_u32 m0, s64, 0
    v_add_u32 v18, s36, v19
    s_waitcnt vmcnt(22)
    v_mfma_f32_32x32x16_bf16 v[32:47], a[212:215], a[52:55], v[32:47]
    ds_read_b64_tr_b16 a[212:213], v14 offset:34816
    ds_read_b64_tr_b16 a[214:215], v14 offset:35328
    buffer_load_dwordx4 v18, s[8:11], s44 offen offset:0 lds
    s_waitcnt lgkmcnt(4)
    s_waitcnt vmcnt(22)
    v_mfma_f32_32x32x16_bf16 v[32:47], a[216:219], a[56:59], v[32:47]
    ds_read_b64_tr_b16 a[216:217], v15 offset:0
    ds_read_b64_tr_b16 a[218:219], v15 offset:512
    s_waitcnt vmcnt(21)
    v_mfma_f32_32x32x16_bf16 v[32:47], a[220:223], a[60:63], v[32:47]
    ds_read_b64_tr_b16 a[220:221], v15 offset:2048
    ds_read_b64_tr_b16 a[222:223], v15 offset:2560
    buffer_load_dwordx4 v18, s[8:11], s45 offen offset:1024 lds
    s_waitcnt lgkmcnt(4)
    s_waitcnt vmcnt(21)
    v_mfma_f32_32x32x16_bf16 v[32:47], a[208:211], a[64:67], v[32:47]
    ds_read_b64_tr_b16 a[208:209], v15 offset:4096
    ds_read_b64_tr_b16 a[210:211], v15 offset:4608
    s_waitcnt vmcnt(20)
    v_mfma_f32_32x32x16_bf16 v[32:47], a[212:215], a[68:71], v[32:47]
    ds_read_b64_tr_b16 a[212:213], v15 offset:6144
    ds_read_b64_tr_b16 a[214:215], v15 offset:6656
    buffer_load_dwordx4 v18, s[8:11], s46 offen offset:2048 lds
    s_waitcnt lgkmcnt(4)
    v_mfma_f32_32x32x16_bf16 v[48:63], a[216:219], a[0:3], 0
    ds_read_b64_tr_b16 a[216:217], v15 offset:8192
    ds_read_b64_tr_b16 a[218:219], v15 offset:8704
    v_mfma_f32_32x32x16_bf16 v[48:63], a[220:223], a[4:7], v[48:63]
    ds_read_b64_tr_b16 a[220:221], v15 offset:10240
    ds_read_b64_tr_b16 a[222:223], v15 offset:10752
    buffer_load_dwordx4 v18, s[8:11], s47 offen offset:3072 lds
    s_add_u32 m0, s64, 4096
    s_waitcnt lgkmcnt(4)
    v_mfma_f32_32x32x16_bf16 v[48:63], a[208:211], a[8:11], v[48:63]
    ds_read_b64_tr_b16 a[208:209], v15 offset:12288
    ds_read_b64_tr_b16 a[210:211], v15 offset:12800
    v_mfma_f32_32x32x16_bf16 v[48:63], a[212:215], a[12:15], v[48:63]
    ds_read_b64_tr_b16 a[212:213], v15 offset:14336
    ds_read_b64_tr_b16 a[214:215], v15 offset:14848
    buffer_load_dwordx4 v18, s[8:11], s48 offen offset:0 lds
    s_waitcnt lgkmcnt(4)
    v_mfma_f32_32x32x16_bf16 v[48:63], a[216:219], a[16:19], v[48:63]
    ds_read_b64_tr_b16 a[216:217], v15 offset:16384
    ds_read_b64_tr_b16 a[218:219], v15 offset:16896
    buffer_load_dwordx4 v18, s[8:11], s49 offen offset:1024 lds
    v_mfma_f32_32x32x16_bf16 v[48:63], a[220:223], a[20:23], v[48:63]
    ds_read_b64_tr_b16 a[220:221], v15 offset:18432
    ds_read_b64_tr_b16 a[222:223], v15 offset:18944
    s_waitcnt lgkmcnt(4)
    v_mfma_f32_32x32x16_bf16 v[48:63], a[208:211], a[24:27], v[48:63]
    ds_read_b64_tr_b16 a[208:209], v15 offset:20480
    ds_read_b64_tr_b16 a[210:211], v15 offset:20992
    buffer_load_dwordx4 v18, s[8:11], s50 offen offset:2048 lds
    v_mfma_f32_32x32x16_bf16 v[48:63], a[212:215], a[28:31], v[48:63]
    ds_read_b64_tr_b16 a[212:213], v15 offset:22528
    ds_read_b64_tr_b16 a[214:215], v15 offset:23040
    s_waitcnt lgkmcnt(4)
    v_mfma_f32_32x32x16_bf16 v[48:63], a[216:219], a[32:35], v[48:63]
    ds_read_b64_tr_b16 a[216:217], v15 offset:24576
    ds_read_b64_tr_b16 a[218:219], v15 offset:25088
    buffer_load_dwordx4 v18, s[8:11], s51 offen offset:3072 lds
    s_add_u32 m0, s64, 8192
    v_mfma_f32_32x32x16_bf16 v[48:63], a[220:223], a[36:39], v[48:63]
    ds_read_b64_tr_b16 a[220:221], v15 offset:26624
    ds_read_b64_tr_b16 a[222:223], v15 offset:27136
    s_waitcnt lgkmcnt(4)
    v_mfma_f32_32x32x16_bf16 v[48:63], a[208:211], a[40:43], v[48:63]
    ds_read_b64_tr_b16 a[208:209], v15 offset:28672
    ds_read_b64_tr_b16 a[210:211], v15 offset:29184
    buffer_load_dwordx4 v18, s[8:11], s52 offen offset:0 lds
    v_mfma_f32_32x32x16_bf16 v[48:63], a[212:215], a[44:47], v[48:63]
    ds_read_b64_tr_b16 a[212:213], v15 offset:30720
    ds_read_b64_tr_b16 a[214:215], v15 offset:31232
    s_waitcnt lgkmcnt(4)
    v_mfma_f32_32x32x16_bf16 v[48:63], a[216:219], a[48:51], v[48:63]
    ds_read_b64_tr_b16 a[216:217], v15 offset:32768
    ds_read_b64_tr_b16 a[218:219], v15 offset:33280
    v_mfma_f32_32x32x16_bf16 v[48:63], a[220:223], a[52:55], v[48:63]
    ds_read_b64_tr_b16 a[220:221], v15 offset:34816
    ds_read_b64_tr_b16 a[222:223], v15 offset:35328
    s_waitcnt lgkmcnt(4)
    v_mfma_f32_32x32x16_bf16 v[48:63], a[208:211], a[56:59], v[48:63]
    s_waitcnt vmcnt(33)
    s_barrier
    v_add_u32 v14, s62, v10
    v_add_u32 v15, s62, v11
    ds_read_b64_tr_b16 a[208:209], v14 offset:0
    ds_read_b64_tr_b16 a[210:211], v14 offset:512
    v_mfma_f32_32x32x16_bf16 v[48:63], a[212:215], a[60:63], v[48:63]
    ds_read_b64_tr_b16 a[212:213], v14 offset:2048
    ds_read_b64_tr_b16 a[214:215], v14 offset:2560
    s_add_u32 s62, s62, 36864
    s_cmp_eq_u32 s62, 147456
    s_cselect_b32 s62, 0, s62
    s_waitcnt lgkmcnt(4)
    v_mfma_f32_32x32x16_bf16 v[48:63], a[216:219], a[64:67], v[48:63]
    ds_read_b64_tr_b16 a[216:217], v14 offset:4096
    ds_read_b64_tr_b16 a[218:219], v14 offset:4608
    s_add_u32 s63, s63, 36864
    s_cmp_eq_u32 s63, 147456
    s_cselect_b32 s63, 0, s63
    v_mfma_f32_32x32x16_bf16 v[48:63], a[220:223], a[68:71], v[48:63]
    ds_read_b64_tr_b16 a[220:221], v14 offset:6144
    ds_read_b64_tr_b16 a[222:223], v14 offset:6656
    s_waitcnt lgkmcnt(4)
    s_waitcnt vmcnt(26)
    v_mfma_f32_32x32x16_bf16 v[32:47], a[208:211], a[72:75], v[32:47]
    ds_read_b64_tr_b16 a[208:209], v14 offset:8192
    ds_read_b64_tr_b16 a[210:211], v14 offset:8704
    s_add_u32 s37, s32, s63
    s_cmp_lt_u32 s35, 3
    s_cselect_b32 s64, s37, 147456
    s_waitcnt vmcnt(25)
    v_mfma_f32_32x32x16_bf16 v[32:47], a[212:215], a[76:79], v[32:47]
    ds_read_b64_tr_b16 a[212:213], v14 offset:10240
    ds_read_b64_tr_b16 a[214:215], v14 offset:10752
    s_add_u32 m0, s64, 0
    s_add_u32 s38, s36, 2359296
    v_add_u32 v18, s38, v19
    s_waitcnt lgkmcnt(4)
    s_waitcnt vmcnt(24)
    v_mfma_f32_32x32x16_bf16 v[32:47], a[216:219], a[80:83], v[32:47]
    ds_read_b64_tr_b16 a[216:217], v14 offset:12288
    ds_read_b64_tr_b16 a[218:219], v14 offset:12800
    buffer_load_dwordx4 v18, s[8:11], s44 offen offset:0 lds
    s_waitcnt vmcnt(24)
    v_mfma_f32_32x32x16_bf16 v[32:47], a[220:223], a[84:87], v[32:47]
    ds_read_b64_tr_b16 a[220:221], v14 offset:14336
    ds_read_b64_tr_b16 a[222:223], v14 offset:14848
    s_waitcnt lgkmcnt(4)
    s_waitcnt vmcnt(23)
    v_mfma_f32_32x32x16_bf16 v[32:47], a[208:211], a[88:91], v[32:47]
    ds_read_b64_tr_b16 a[208:209], v14 offset:16384
    ds_read_b64_tr_b16 a[210:211], v14 offset:16896
    buffer_load_dwordx4 v18, s[8:11], s45 offen offset:1024 lds
    s_waitcnt vmcnt(23)
    v_mfma_f32_32x32x16_bf16 v[32:47], a[212:215], a[92:95], v[32:47]
    ds_read_b64_tr_b16 a[212:213], v14 offset:18432
    ds_read_b64_tr_b16 a[214:215], v14 offset:18944
    s_waitcnt lgkmcnt(4)
    s_waitcnt vmcnt(22)
    v_mfma_f32_32x32x16_bf16 v[32:47], a[216:219], a[96:99], v[32:47]
    ds_read_b64_tr_b16 a[216:217], v14 offset:20480
    ds_read_b64_tr_b16 a[218:219], v14 offset:20992
    buffer_load_dwordx4 v18, s[8:11], s46 offen offset:2048 lds
    s_waitcnt vmcnt(22)
    v_mfma_f32_32x32x16_bf16 v[32:47], a[220:223], a[100:103], v[32:47]
    ds_read_b64_tr_b16 a[220:221], v14 offset:22528
    ds_read_b64_tr_b16 a[222:223], v14 offset:23040
    s_waitcnt lgkmcnt(4)
    s_waitcnt vmcnt(21)
    v_mfma_f32_32x32x16_bf16 v[32:47], a[208:211], a[104:107], v[32:47]
    ds_read_b64_tr_b16 a[208:209], v14 offset:24576
    ds_read_b64_tr_b16 a[210:211], v14 offset:25088
    buffer_load_dwordx4 v18, s[8:11], s47 offen offset:3072 lds
    s_add_u32 m0, s64, 4096
    s_waitcnt vmcnt(21)
    v_mfma_f32_32x32x16_bf16 v[32:47], a[212:215], a[108:111], v[32:47]
    ds_read_b64_tr_b16 a[212:213], v14 offset:26624
    ds_read_b64_tr_b16 a[214:215], v14 offset:27136
    s_waitcnt lgkmcnt(4)
    s_waitcnt vmcnt(20)
    v_mfma_f32_32x32x16_bf16 v[32:47], a[216:219], a[112:115], v[32:47]
    ds_read_b64_tr_b16 a[216:217], v14 offset:28672
    ds_read_b64_tr_b16 a[218:219], v14 offset:29184
    buffer_load_dwordx4 v18, s[8:11], s48 offen offset:0 lds
    s_waitcnt vmcnt(20)
    v_mfma_f32_32x32x16_bf16 v[32:47], a[220:223], a[116:119], v[32:47]
    ds_read_b64_tr_b16 a[220:221], v14 offset:30720
    ds_read_b64_tr_b16 a[222:223], v14 offset:31232
    s_waitcnt lgkmcnt(4)
    s_waitcnt vmcnt(19)
    v_mfma_f32_32x32x16_bf16 v[32:47], a[208:211], a[120:123], v[32:47]
    ds_read_b64_tr_b16 a[208:209], v14 offset:32768
    ds_read_b64_tr_b16 a[210:211], v14 offset:33280
    buffer_load_dwordx4 v18, s[8:11], s49 offen offset:1024 lds
    s_waitcnt vmcnt(19)
    v_mfma_f32_32x32x16_bf16 v[32:47], a[212:215], a[124:127], v[32:47]
    ds_read_b64_tr_b16 a[212:213], v14 offset:34816
    ds_read_b64_tr_b16 a[214:215], v14 offset:35328
    s_waitcnt lgkmcnt(4)
    s_waitcnt vmcnt(18)
    v_mfma_f32_32x32x16_bf16 v[32:47], a[216:219], a[128:131], v[32:47]
    ds_read_b64_tr_b16 a[216:217], v15 offset:0
    ds_read_b64_tr_b16 a[218:219], v15 offset:512
    buffer_load_dwordx4 v18, s[8:11], s50 offen offset:2048 lds
    s_waitcnt vmcnt(18)
    v_mfma_f32_32x32x16_bf16 v[32:47], a[220:223], a[132:135], v[32:47]
    ds_read_b64_tr_b16 a[220:221], v15 offset:2048
    ds_read_b64_tr_b16 a[222:223], v15 offset:2560
    s_waitcnt lgkmcnt(4)
    s_waitcnt vmcnt(17)
    v_mfma_f32_32x32x16_bf16 v[32:47], a[208:211], a[136:139], v[32:47]
    ds_read_b64_tr_b16 a[208:209], v15 offset:4096
    ds_read_b64_tr_b16 a[210:211], v15 offset:4608
    buffer_load_dwordx4 v18, s[8:11], s51 offen offset:3072 lds
    s_add_u32 m0, s64, 8192
    s_waitcnt vmcnt(17)
    v_mfma_f32_32x32x16_bf16 v[32:47], a[212:215], a[140:143], v[32:47]
    ds_read_b64_tr_b16 a[212:213], v15 offset:6144
    ds_read_b64_tr_b16 a[214:215], v15 offset:6656
    s_waitcnt lgkmcnt(4)
    v_mfma_f32_32x32x16_bf16 v[48:63], a[216:219], a[72:75], v[48:63]
    ds_read_b64_tr_b16 a[216:217], v15 offset:8192
    ds_read_b64_tr_b16 a[218:219], v15 offset:8704
    buffer_load_dwordx4 v18, s[8:11], s52 offen offset:0 lds
    v_mfma_f32_32x32x16_bf16 v[48:63], a[220:223], a[76:79], v[48:63]
    ds_read_b64_tr_b16 a[220:221], v15 offset:10240
    ds_read_b64_tr_b16 a[222:223], v15 offset:10752
    s_waitcnt lgkmcnt(4)
    v_mfma_f32_32x32x16_bf16 v[48:63], a[208:211], a[80:83], v[48:63]
    ds_read_b64_tr_b16 a[208:209], v15 offset:12288
    ds_read_b64_tr_b16 a[210:211], v15 offset:12800
    v_mfma_f32_32x32x16_bf16 v[48:63], a[212:215], a[84:87], v[48:63]
    ds_read_b64_tr_b16 a[212:213], v15 offset:14336
    ds_read_b64_tr_b16 a[214:215], v15 offset:14848
    v_cvt_pk_bf16_f32 v240, v32, v33
    v_cvt_pk_bf16_f32 v241, v34, v35
    s_waitcnt lgkmcnt(4)
    v_mfma_f32_32x32x16_bf16 v[48:63], a[216:219], a[88:91], v[48:63]
    ds_read_b64_tr_b16 a[216:217], v15 offset:16384
    ds_read_b64_tr_b16 a[218:219], v15 offset:16896
    v_cvt_pk_bf16_f32 v242, v36, v37
    v_mfma_f32_32x32x16_bf16 v[48:63], a[220:223], a[92:95], v[48:63]
    ds_read_b64_tr_b16 a[220:221], v15 offset:18432
    ds_read_b64_tr_b16 a[222:223], v15 offset:18944
    v_cvt_pk_bf16_f32 v243, v38, v39
    s_waitcnt lgkmcnt(4)
    v_mfma_f32_32x32x16_bf16 v[48:63], a[208:211], a[96:99], v[48:63]
    ds_read_b64_tr_b16 a[208:209], v15 offset:20480
    ds_read_b64_tr_b16 a[210:211], v15 offset:20992
    v_cvt_pk_bf16_f32 v244, v40, v41
    v_mfma_f32_32x32x16_bf16 v[48:63], a[212:215], a[100:103], v[48:63]
    ds_read_b64_tr_b16 a[212:213], v15 offset:22528
    ds_read_b64_tr_b16 a[214:215], v15 offset:23040
    v_cvt_pk_bf16_f32 v245, v42, v43
    s_waitcnt lgkmcnt(4)
    v_mfma_f32_32x32x16_bf16 v[48:63], a[216:219], a[104:107], v[48:63]
    ds_read_b64_tr_b16 a[216:217], v15 offset:24576
    ds_read_b64_tr_b16 a[218:219], v15 offset:25088
    v_cvt_pk_bf16_f32 v246, v44, v45
    v_mfma_f32_32x32x16_bf16 v[48:63], a[220:223], a[108:111], v[48:63]
    ds_read_b64_tr_b16 a[220:221], v15 offset:26624
    ds_read_b64_tr_b16 a[222:223], v15 offset:27136
    v_cvt_pk_bf16_f32 v247, v46, v47
    s_waitcnt lgkmcnt(4)
    v_mfma_f32_32x32x16_bf16 v[48:63], a[208:211], a[112:115], v[48:63]
    ds_read_b64_tr_b16 a[208:209], v15 offset:28672
    ds_read_b64_tr_b16 a[210:211], v15 offset:29184
    v_accvgpr_write_b32 a192, v240
    v_accvgpr_write_b32 a193, v241
    v_mfma_f32_32x32x16_bf16 v[48:63], a[212:215], a[116:119], v[48:63]
    ds_read_b64_tr_b16 a[212:213], v15 offset:30720
    ds_read_b64_tr_b16 a[214:215], v15 offset:31232
    v_accvgpr_write_b32 a194, v242
    s_waitcnt lgkmcnt(4)
    v_mfma_f32_32x32x16_bf16 v[48:63], a[216:219], a[120:123], v[48:63]
    ds_read_b64_tr_b16 a[216:217], v15 offset:32768
    ds_read_b64_tr_b16 a[218:219], v15 offset:33280
    v_accvgpr_write_b32 a195, v243
    v_mfma_f32_32x32x16_bf16 v[48:63], a[220:223], a[124:127], v[48:63]
    ds_read_b64_tr_b16 a[220:221], v15 offset:34816
    ds_read_b64_tr_b16 a[222:223], v15 offset:35328
    v_accvgpr_write_b32 a196, v244
    s_waitcnt lgkmcnt(4)
    v_mfma_f32_32x32x16_bf16 v[48:63], a[208:211], a[128:131], v[48:63]
    s_waitcnt vmcnt(9)
    s_barrier
    v_add_u32 v14, s62, v10
    v_add_u32 v15, s62, v11
    ds_read_b64_tr_b16 a[208:209], v14 offset:0
    ds_read_b64_tr_b16 a[210:211], v14 offset:512
    v_accvgpr_write_b32 a197, v245
    v_mfma_f32_32x32x16_bf16 v[48:63], a[212:215], a[132:135], v[48:63]
    ds_read_b64_tr_b16 a[212:213], v14 offset:2048
    ds_read_b64_tr_b16 a[214:215], v14 offset:2560
    v_accvgpr_write_b32 a198, v246
    s_add_u32 s62, s62, 36864
    s_cmp_eq_u32 s62, 147456
    s_cselect_b32 s62, 0, s62
    s_waitcnt lgkmcnt(4)
    v_mfma_f32_32x32x16_bf16 v[48:63], a[216:219], a[136:139], v[48:63]
    ds_read_b64_tr_b16 a[216:217], v14 offset:4096
    ds_read_b64_tr_b16 a[218:219], v14 offset:4608
    v_accvgpr_write_b32 a199, v247
    s_add_u32 s63, s63, 36864
    s_cmp_eq_u32 s63, 147456
    s_cselect_b32 s63, 0, s63
    v_mfma_f32_32x32x16_bf16 v[48:63], a[220:223], a[140:143], v[48:63]
    ds_read_b64_tr_b16 a[220:221], v14 offset:6144
    ds_read_b64_tr_b16 a[222:223], v14 offset:6656
    s_add_u32 s33, s33, 128
    s_add_u32 s35, s35, 1
mega_kernel_att_q:
    s_add_u32 s36, s33, 128
    s_cmp_lt_u32 s35, 3
    s_cselect_b32 s10, 0x480000, 0
    s_waitcnt lgkmcnt(4)
    v_mfma_f32_32x32x16_bf16 v[32:47], a[208:211], a[0:3], 0
    ds_read_b64_tr_b16 a[208:209], v14 offset:8192
    ds_read_b64_tr_b16 a[210:211], v14 offset:8704
    s_add_u32 s37, s32, s63
    s_cmp_lt_u32 s35, 3
    s_cselect_b32 s64, s37, 147456
    v_mfma_f32_32x32x16_bf16 v[32:47], a[212:215], a[4:7], v[32:47]
    ds_read_b64_tr_b16 a[212:213], v14 offset:10240
    ds_read_b64_tr_b16 a[214:215], v14 offset:10752
    s_add_u32 m0, s64, 0
    v_add_u32 v18, s36, v19
    s_waitcnt lgkmcnt(4)
    v_mfma_f32_32x32x16_bf16 v[32:47], a[216:219], a[8:11], v[32:47]
    ds_read_b64_tr_b16 a[216:217], v14 offset:12288
    ds_read_b64_tr_b16 a[218:219], v14 offset:12800
    buffer_load_dwordx4 v18, s[8:11], s44 offen offset:0 lds
    v_mfma_f32_32x32x16_bf16 v[32:47], a[220:223], a[12:15], v[32:47]
    ds_read_b64_tr_b16 a[220:221], v14 offset:14336
    ds_read_b64_tr_b16 a[222:223], v14 offset:14848
    v_cvt_pk_bf16_f32 v240, v48, v49
    v_cvt_pk_bf16_f32 v241, v50, v51
    s_waitcnt lgkmcnt(4)
    v_mfma_f32_32x32x16_bf16 v[32:47], a[208:211], a[16:19], v[32:47]
    ds_read_b64_tr_b16 a[208:209], v14 offset:16384
    ds_read_b64_tr_b16 a[210:211], v14 offset:16896
    buffer_load_dwordx4 v18, s[8:11], s45 offen offset:1024 lds
    v_cvt_pk_bf16_f32 v242, v52, v53
    v_mfma_f32_32x32x16_bf16 v[32:47], a[212:215], a[20:23], v[32:47]
    ds_read_b64_tr_b16 a[212:213], v14 offset:18432
    ds_read_b64_tr_b16 a[214:215], v14 offset:18944
    v_cvt_pk_bf16_f32 v243, v54, v55
    s_waitcnt lgkmcnt(4)
    v_mfma_f32_32x32x16_bf16 v[32:47], a[216:219], a[24:27], v[32:47]
    ds_read_b64_tr_b16 a[216:217], v14 offset:20480
    ds_read_b64_tr_b16 a[218:219], v14 offset:20992
    buffer_load_dwordx4 v18, s[8:11], s46 offen offset:2048 lds
    v_cvt_pk_bf16_f32 v244, v56, v57
    v_mfma_f32_32x32x16_bf16 v[32:47], a[220:223], a[28:31], v[32:47]
    ds_read_b64_tr_b16 a[220:221], v14 offset:22528
    ds_read_b64_tr_b16 a[222:223], v14 offset:23040
    v_cvt_pk_bf16_f32 v245, v58, v59
    s_waitcnt lgkmcnt(4)
    v_mfma_f32_32x32x16_bf16 v[32:47], a[208:211], a[32:35], v[32:47]
    ds_read_b64_tr_b16 a[208:209], v14 offset:24576
    ds_read_b64_tr_b16 a[210:211], v14 offset:25088
    buffer_load_dwordx4 v18, s[8:11], s47 offen offset:3072 lds
    s_add_u32 m0, s64, 4096
    v_cvt_pk_bf16_f32 v246, v60, v61
    v_mfma_f32_32x32x16_bf16 v[32:47], a[212:215], a[36:39], v[32:47]
    ds_read_b64_tr_b16 a[212:213], v14 offset:26624
    ds_read_b64_tr_b16 a[214:215], v14 offset:27136
    v_cvt_pk_bf16_f32 v247, v62, v63
    s_waitcnt lgkmcnt(4)
    v_mfma_f32_32x32x16_bf16 v[32:47], a[216:219], a[40:43], v[32:47]
    ds_read_b64_tr_b16 a[216:217], v14 offset:28672
    ds_read_b64_tr_b16 a[218:219], v14 offset:29184
    buffer_load_dwordx4 v18, s[8:11], s48 offen offset:0 lds
    v_accvgpr_write_b32 a200, v240
    v_accvgpr_write_b32 a201, v241
    v_mfma_f32_32x32x16_bf16 v[32:47], a[220:223], a[44:47], v[32:47]
    ds_read_b64_tr_b16 a[220:221], v14 offset:30720
    ds_read_b64_tr_b16 a[222:223], v14 offset:31232
    v_accvgpr_write_b32 a202, v242
    s_waitcnt lgkmcnt(4)
    v_mfma_f32_32x32x16_bf16 v[32:47], a[208:211], a[48:51], v[32:47]
    ds_read_b64_tr_b16 a[208:209], v14 offset:32768
    ds_read_b64_tr_b16 a[210:211], v14 offset:33280
    buffer_load_dwordx4 v18, s[8:11], s49 offen offset:1024 lds
    v_accvgpr_write_b32 a203, v243
    v_mfma_f32_32x32x16_bf16 v[32:47], a[212:215], a[52:55], v[32:47]
    ds_read_b64_tr_b16 a[212:213], v14 offset:34816
    ds_read_b64_tr_b16 a[214:215], v14 offset:35328
    v_accvgpr_write_b32 a204, v244
    s_waitcnt lgkmcnt(4)
    v_mfma_f32_32x32x16_bf16 v[32:47], a[216:219], a[56:59], v[32:47]
    ds_read_b64_tr_b16 a[216:217], v15 offset:0
    ds_read_b64_tr_b16 a[218:219], v15 offset:512
    buffer_load_dwordx4 v18, s[8:11], s50 offen offset:2048 lds
    v_accvgpr_write_b32 a205, v245
    v_mfma_f32_32x32x16_bf16 v[32:47], a[220:223], a[60:63], v[32:47]
    ds_read_b64_tr_b16 a[220:221], v15 offset:2048
    ds_read_b64_tr_b16 a[222:223], v15 offset:2560
    v_accvgpr_write_b32 a206, v246
    s_waitcnt lgkmcnt(4)
    v_mfma_f32_32x32x16_bf16 v[32:47], a[208:211], a[64:67], v[32:47]
    ds_read_b64_tr_b16 a[208:209], v15 offset:4096
    ds_read_b64_tr_b16 a[210:211], v15 offset:4608
    buffer_load_dwordx4 v18, s[8:11], s51 offen offset:3072 lds
    s_add_u32 m0, s64, 8192
    v_accvgpr_write_b32 a207, v247
    v_mfma_f32_32x32x16_bf16 v[32:47], a[212:215], a[68:71], v[32:47]
    ds_read_b64_tr_b16 a[212:213], v15 offset:6144
    ds_read_b64_tr_b16 a[214:215], v15 offset:6656
    s_waitcnt lgkmcnt(4)
    v_mfma_f32_32x32x16_bf16 v[48:63], a[216:219], a[0:3], 0
    ds_read_b64_tr_b16 a[216:217], v15 offset:8192
    ds_read_b64_tr_b16 a[218:219], v15 offset:8704
    buffer_load_dwordx4 v18, s[8:11], s52 offen offset:0 lds
    v_accvgpr_mov_b32 a144, a160
    v_accvgpr_mov_b32 a145, a161
    v_accvgpr_mov_b32 a146, a162
    v_mfma_f32_32x32x16_bf16 v[48:63], a[220:223], a[4:7], v[48:63]
    ds_read_b64_tr_b16 a[220:221], v15 offset:10240
    ds_read_b64_tr_b16 a[222:223], v15 offset:10752
    v_accvgpr_mov_b32 a147, a163
    v_accvgpr_mov_b32 a148, a164
    v_accvgpr_mov_b32 a149, a165
    s_waitcnt lgkmcnt(4)
    v_mfma_f32_32x32x16_bf16 v[48:63], a[208:211], a[8:11], v[48:63]
    ds_read_b64_tr_b16 a[208:209], v15 offset:12288
    ds_read_b64_tr_b16 a[210:211], v15 offset:12800
    v_accvgpr_mov_b32 a150, a166
    v_accvgpr_mov_b32 a151, a167
    v_mfma_f32_32x32x16_bf16 v[48:63], a[212:215], a[12:15], v[48:63]
    ds_read_b64_tr_b16 a[212:213], v15 offset:14336
    ds_read_b64_tr_b16 a[214:215], v15 offset:14848
    v_accvgpr_mov_b32 a152, a168
    v_accvgpr_mov_b32 a153, a169
    v_accvgpr_mov_b32 a154, a170
    s_cmp_lg_u32 s35, 3
    s_cbranch_scc1 mega_kernel_att_g0
    s_add_u32 m0, s74, 0
    s_add_u32 s38, s66, 0
    buffer_load_dwordx4 v21, s[12:15], s38 offen lds
    s_add_u32 m0, s74, 64
    s_nop 0
    buffer_load_dwordx4 v21, s[12:15], s38 offen offset:1024 lds
    s_add_u32 m0, s75, 18432
    s_add_u32 s38, s66, 0
    buffer_load_dwordx4 v22, s[16:19], s38 offen lds
    s_add_u32 s38, s38, 1024
    buffer_load_dwordx4 v22, s[16:19], s38 offen offset:1024 lds
    s_add_u32 m0, s74, 18432
    s_add_u32 s38, s66, 8192
    buffer_load_dwordx4 v21, s[12:15], s38 offen lds
    s_add_u32 m0, s74, 18496
    s_nop 0
    buffer_load_dwordx4 v21, s[12:15], s38 offen offset:1024 lds
mega_kernel_att_g0:
    s_waitcnt lgkmcnt(4)
    v_mfma_f32_32x32x16_bf16 v[48:63], a[216:219], a[16:19], v[48:63]
    ds_read_b64_tr_b16 a[216:217], v15 offset:16384
    ds_read_b64_tr_b16 a[218:219], v15 offset:16896
    v_accvgpr_mov_b32 a155, a171
    v_accvgpr_mov_b32 a156, a172
    v_accvgpr_mov_b32 a157, a173
    v_mfma_f32_32x32x16_bf16 v[48:63], a[220:223], a[20:23], v[48:63]
    ds_read_b64_tr_b16 a[220:221], v15 offset:18432
    ds_read_b64_tr_b16 a[222:223], v15 offset:18944
    v_accvgpr_mov_b32 a158, a174
    v_accvgpr_mov_b32 a159, a175
    s_waitcnt lgkmcnt(4)
    v_mfma_f32_32x32x16_bf16 v[48:63], a[208:211], a[24:27], v[48:63]
    ds_read_b64_tr_b16 a[208:209], v15 offset:20480
    ds_read_b64_tr_b16 a[210:211], v15 offset:20992
    v_accvgpr_mov_b32 a160, a176
    v_accvgpr_mov_b32 a161, a177
    v_accvgpr_mov_b32 a162, a178
    v_mfma_f32_32x32x16_bf16 v[48:63], a[212:215], a[28:31], v[48:63]
    ds_read_b64_tr_b16 a[212:213], v15 offset:22528
    ds_read_b64_tr_b16 a[214:215], v15 offset:23040
    v_accvgpr_mov_b32 a163, a179
    v_accvgpr_mov_b32 a164, a180
    v_accvgpr_mov_b32 a165, a181
    s_waitcnt lgkmcnt(4)
    v_mfma_f32_32x32x16_bf16 v[48:63], a[216:219], a[32:35], v[48:63]
    ds_read_b64_tr_b16 a[216:217], v15 offset:24576
    ds_read_b64_tr_b16 a[218:219], v15 offset:25088
    v_accvgpr_mov_b32 a166, a182
    v_accvgpr_mov_b32 a167, a183
    v_mfma_f32_32x32x16_bf16 v[48:63], a[220:223], a[36:39], v[48:63]
    ds_read_b64_tr_b16 a[220:221], v15 offset:26624
    ds_read_b64_tr_b16 a[222:223], v15 offset:27136
    v_accvgpr_mov_b32 a168, a184
    v_accvgpr_mov_b32 a169, a185
    v_accvgpr_mov_b32 a170, a186
    s_waitcnt lgkmcnt(4)
    v_mfma_f32_32x32x16_bf16 v[48:63], a[208:211], a[40:43], v[48:63]
    ds_read_b64_tr_b16 a[208:209], v15 offset:28672
    ds_read_b64_tr_b16 a[210:211], v15 offset:29184
    v_accvgpr_mov_b32 a171, a187
    v_accvgpr_mov_b32 a172, a188
    v_accvgpr_mov_b32 a173, a189
    v_mfma_f32_32x32x16_bf16 v[48:63], a[212:215], a[44:47], v[48:63]
    ds_read_b64_tr_b16 a[212:213], v15 offset:30720
    ds_read_b64_tr_b16 a[214:215], v15 offset:31232
    v_accvgpr_mov_b32 a174, a190
    v_accvgpr_mov_b32 a175, a191
    s_waitcnt lgkmcnt(4)
    v_mfma_f32_32x32x16_bf16 v[48:63], a[216:219], a[48:51], v[48:63]
    ds_read_b64_tr_b16 a[216:217], v15 offset:32768
    ds_read_b64_tr_b16 a[218:219], v15 offset:33280
    v_accvgpr_mov_b32 a176, a192
    v_accvgpr_mov_b32 a177, a193
    v_accvgpr_mov_b32 a178, a194
    v_mfma_f32_32x32x16_bf16 v[48:63], a[220:223], a[52:55], v[48:63]
    ds_read_b64_tr_b16 a[220:221], v15 offset:34816
    ds_read_b64_tr_b16 a[222:223], v15 offset:35328
    v_accvgpr_mov_b32 a179, a195
    v_accvgpr_mov_b32 a180, a196
    v_accvgpr_mov_b32 a181, a197
    s_waitcnt lgkmcnt(4)
    v_mfma_f32_32x32x16_bf16 v[48:63], a[208:211], a[56:59], v[48:63]
    s_waitcnt vmcnt(9)
    s_barrier
    v_add_u32 v14, s62, v10
    v_add_u32 v15, s62, v11
    ds_read_b64_tr_b16 a[208:209], v14 offset:0
    ds_read_b64_tr_b16 a[210:211], v14 offset:512
    v_accvgpr_mov_b32 a182, a198
    v_accvgpr_mov_b32 a183, a199
    v_mfma_f32_32x32x16_bf16 v[48:63], a[212:215], a[60:63], v[48:63]
    ds_read_b64_tr_b16 a[212:213], v14 offset:2048
    ds_read_b64_tr_b16 a[214:215], v14 offset:2560
    v_accvgpr_mov_b32 a184, a200
    v_accvgpr_mov_b32 a185, a201
    v_accvgpr_mov_b32 a186, a202
    s_add_u32 s62, s62, 36864
    s_cmp_eq_u32 s62, 147456
    s_cselect_b32 s62, 0, s62
    s_waitcnt lgkmcnt(4)
    v_mfma_f32_32x32x16_bf16 v[48:63], a[216:219], a[64:67], v[48:63]
    ds_read_b64_tr_b16 a[216:217], v14 offset:4096
    ds_read_b64_tr_b16 a[218:219], v14 offset:4608
    v_accvgpr_mov_b32 a187, a203
    v_accvgpr_mov_b32 a188, a204
    v_accvgpr_mov_b32 a189, a205
    s_add_u32 s63, s63, 36864
    s_cmp_eq_u32 s63, 147456
    s_cselect_b32 s63, 0, s63
    v_mfma_f32_32x32x16_bf16 v[48:63], a[220:223], a[68:71], v[48:63]
    ds_read_b64_tr_b16 a[220:221], v14 offset:6144
    ds_read_b64_tr_b16 a[222:223], v14 offset:6656
    v_accvgpr_mov_b32 a190, a206
    v_accvgpr_mov_b32 a191, a207
    s_waitcnt lgkmcnt(4)
    v_mfma_f32_32x32x16_bf16 v[32:47], a[208:211], a[72:75], v[32:47]
    ds_read_b64_tr_b16 a[208:209], v14 offset:8192
    ds_read_b64_tr_b16 a[210:211], v14 offset:8704
    s_add_u32 s37, s32, s63
    s_cmp_lt_u32 s35, 3
    s_cselect_b32 s64, s37, 147456
    v_mfma_f32_32x32x16_bf16 v[32:47], a[212:215], a[76:79], v[32:47]
    ds_read_b64_tr_b16 a[212:213], v14 offset:10240
    ds_read_b64_tr_b16 a[214:215], v14 offset:10752
    s_add_u32 m0, s64, 0
    s_add_u32 s38, s36, 2359296
    v_add_u32 v18, s38, v19
    s_waitcnt lgkmcnt(4)
    v_mfma_f32_32x32x16_bf16 v[32:47], a[216:219], a[80:83], v[32:47]
    ds_read_b64_tr_b16 a[216:217], v14 offset:12288
    ds_read_b64_tr_b16 a[218:219], v14 offset:12800
    buffer_load_dwordx4 v18, s[8:11], s44 offen offset:0 lds
    v_mfma_f32_32x32x16_bf16 v[32:47], a[220:223], a[84:87], v[32:47]
    ds_read_b64_tr_b16 a[220:221], v14 offset:14336
    ds_read_b64_tr_b16 a[222:223], v14 offset:14848
    s_waitcnt lgkmcnt(4)
    v_mfma_f32_32x32x16_bf16 v[32:47], a[208:211], a[88:91], v[32:47]
    ds_read_b64_tr_b16 a[208:209], v14 offset:16384
    ds_read_b64_tr_b16 a[210:211], v14 offset:16896
    buffer_load_dwordx4 v18, s[8:11], s45 offen offset:1024 lds
    v_mfma_f32_32x32x16_bf16 v[32:47], a[212:215], a[92:95], v[32:47]
    ds_read_b64_tr_b16 a[212:213], v14 offset:18432
    ds_read_b64_tr_b16 a[214:215], v14 offset:18944
    s_waitcnt lgkmcnt(4)
    v_mfma_f32_32x32x16_bf16 v[32:47], a[216:219], a[96:99], v[32:47]
    ds_read_b64_tr_b16 a[216:217], v14 offset:20480
    ds_read_b64_tr_b16 a[218:219], v14 offset:20992
    buffer_load_dwordx4 v18, s[8:11], s46 offen offset:2048 lds
    v_mfma_f32_32x32x16_bf16 v[32:47], a[220:223], a[100:103], v[32:47]
    ds_read_b64_tr_b16 a[220:221], v14 offset:22528
    ds_read_b64_tr_b16 a[222:223], v14 offset:23040
    s_waitcnt lgkmcnt(4)
    v_mfma_f32_32x32x16_bf16 v[32:47], a[208:211], a[104:107], v[32:47]
    ds_read_b64_tr_b16 a[208:209], v14 offset:24576
    ds_read_b64_tr_b16 a[210:211], v14 offset:25088
    buffer_load_dwordx4 v18, s[8:11], s47 offen offset:3072 lds
    s_add_u32 m0, s64, 4096
    v_mfma_f32_32x32x16_bf16 v[32:47], a[212:215], a[108:111], v[32:47]
    ds_read_b64_tr_b16 a[212:213], v14 offset:26624
    ds_read_b64_tr_b16 a[214:215], v14 offset:27136
    s_waitcnt lgkmcnt(4)
    v_mfma_f32_32x32x16_bf16 v[32:47], a[216:219], a[112:115], v[32:47]
    ds_read_b64_tr_b16 a[216:217], v14 offset:28672
    ds_read_b64_tr_b16 a[218:219], v14 offset:29184
    buffer_load_dwordx4 v18, s[8:11], s48 offen offset:0 lds
    v_mfma_f32_32x32x16_bf16 v[32:47], a[220:223], a[116:119], v[32:47]
    ds_read_b64_tr_b16 a[220:221], v14 offset:30720
    ds_read_b64_tr_b16 a[222:223], v14 offset:31232
    s_waitcnt lgkmcnt(4)
    v_mfma_f32_32x32x16_bf16 v[32:47], a[208:211], a[120:123], v[32:47]
    ds_read_b64_tr_b16 a[208:209], v14 offset:32768
    ds_read_b64_tr_b16 a[210:211], v14 offset:33280
    buffer_load_dwordx4 v18, s[8:11], s49 offen offset:1024 lds
    v_mfma_f32_32x32x16_bf16 v[32:47], a[212:215], a[124:127], v[32:47]
    ds_read_b64_tr_b16 a[212:213], v14 offset:34816
    ds_read_b64_tr_b16 a[214:215], v14 offset:35328
    s_waitcnt lgkmcnt(4)
    v_mfma_f32_32x32x16_bf16 v[32:47], a[216:219], a[128:131], v[32:47]
    ds_read_b64_tr_b16 a[216:217], v15 offset:0
    ds_read_b64_tr_b16 a[218:219], v15 offset:512
    buffer_load_dwordx4 v18, s[8:11], s50 offen offset:2048 lds
    v_mfma_f32_32x32x16_bf16 v[32:47], a[220:223], a[132:135], v[32:47]
    ds_read_b64_tr_b16 a[220:221], v15 offset:2048
    ds_read_b64_tr_b16 a[222:223], v15 offset:2560
    s_waitcnt lgkmcnt(4)
    v_mfma_f32_32x32x16_bf16 v[32:47], a[208:211], a[136:139], v[32:47]
    ds_read_b64_tr_b16 a[208:209], v15 offset:4096
    ds_read_b64_tr_b16 a[210:211], v15 offset:4608
    buffer_load_dwordx4 v18, s[8:11], s51 offen offset:3072 lds
    s_add_u32 m0, s64, 8192
    v_mfma_f32_32x32x16_bf16 v[32:47], a[212:215], a[140:143], v[32:47]
    ds_read_b64_tr_b16 a[212:213], v15 offset:6144
    ds_read_b64_tr_b16 a[214:215], v15 offset:6656
    s_waitcnt lgkmcnt(4)
    v_mfma_f32_32x32x16_bf16 v[48:63], a[216:219], a[72:75], v[48:63]
    ds_read_b64_tr_b16 a[216:217], v15 offset:8192
    ds_read_b64_tr_b16 a[218:219], v15 offset:8704
    buffer_load_dwordx4 v18, s[8:11], s52 offen offset:0 lds
    v_mfma_f32_32x32x16_bf16 v[48:63], a[220:223], a[76:79], v[48:63]
    ds_read_b64_tr_b16 a[220:221], v15 offset:10240
    ds_read_b64_tr_b16 a[222:223], v15 offset:10752
    s_waitcnt lgkmcnt(4)
    v_mfma_f32_32x32x16_bf16 v[48:63], a[208:211], a[80:83], v[48:63]
    ds_read_b64_tr_b16 a[208:209], v15 offset:12288
    ds_read_b64_tr_b16 a[210:211], v15 offset:12800
    s_cmp_lg_u32 s35, 3
    s_cbranch_scc1 mega_kernel_att_g1
    s_add_u32 m0, s75, 36864
    s_add_u32 s38, s66, 8192
    buffer_load_dwordx4 v22, s[16:19], s38 offen lds
    s_add_u32 s38, s38, 1024
    buffer_load_dwordx4 v22, s[16:19], s38 offen offset:1024 lds
    s_add_u32 m0, s74, 36864
    s_add_u32 s38, s66, 16384
    buffer_load_dwordx4 v21, s[12:15], s38 offen lds
    s_add_u32 m0, s74, 36928
    s_nop 0
    buffer_load_dwordx4 v21, s[12:15], s38 offen offset:1024 lds
    s_add_u32 m0, s75, 55296
    s_add_u32 s38, s66, 16384
    buffer_load_dwordx4 v22, s[16:19], s38 offen lds
    s_add_u32 s38, s38, 1024
    buffer_load_dwordx4 v22, s[16:19], s38 offen offset:1024 lds
    s_add_u32 m0, s74, 55296
    s_add_u32 s38, s66, 24576
    buffer_load_dwordx4 v21, s[12:15], s38 offen lds
    s_add_u32 m0, s74, 55360
    s_nop 0
    buffer_load_dwordx4 v21, s[12:15], s38 offen offset:1024 lds
mega_kernel_att_g1:
    v_mfma_f32_32x32x16_bf16 v[48:63], a[212:215], a[84:87], v[48:63]
    ds_read_b64_tr_b16 a[212:213], v15 offset:14336
    ds_read_b64_tr_b16 a[214:215], v15 offset:14848
    v_cvt_pk_bf16_f32 v240, v32, v33
    v_cvt_pk_bf16_f32 v241, v34, v35
    s_waitcnt lgkmcnt(4)
    v_mfma_f32_32x32x16_bf16 v[48:63], a[216:219], a[88:91], v[48:63]
    ds_read_b64_tr_b16 a[216:217], v15 offset:16384
    ds_read_b64_tr_b16 a[218:219], v15 offset:16896
    v_cvt_pk_bf16_f32 v242, v36, v37
    v_mfma_f32_32x32x16_bf16 v[48:63], a[220:223], a[92:95], v[48:63]
    ds_read_b64_tr_b16 a[220:221], v15 offset:18432
    ds_read_b64_tr_b16 a[222:223], v15 offset:18944
    v_cvt_pk_bf16_f32 v243, v38, v39
    s_waitcnt lgkmcnt(4)
    v_mfma_f32_32x32x16_bf16 v[48:63], a[208:211], a[96:99], v[48:63]
    ds_read_b64_tr_b16 a[208:209], v15 offset:20480
    ds_read_b64_tr_b16 a[210:211], v15 offset:20992
    v_cvt_pk_bf16_f32 v244, v40, v41
    v_mfma_f32_32x32x16_bf16 v[48:63], a[212:215], a[100:103], v[48:63]
    ds_read_b64_tr_b16 a[212:213], v15 offset:22528
    ds_read_b64_tr_b16 a[214:215], v15 offset:23040
    v_cvt_pk_bf16_f32 v245, v42, v43
    s_waitcnt lgkmcnt(4)
    v_mfma_f32_32x32x16_bf16 v[48:63], a[216:219], a[104:107], v[48:63]
    ds_read_b64_tr_b16 a[216:217], v15 offset:24576
    ds_read_b64_tr_b16 a[218:219], v15 offset:25088
    v_cvt_pk_bf16_f32 v246, v44, v45
    v_mfma_f32_32x32x16_bf16 v[48:63], a[220:223], a[108:111], v[48:63]
    ds_read_b64_tr_b16 a[220:221], v15 offset:26624
    ds_read_b64_tr_b16 a[222:223], v15 offset:27136
    v_cvt_pk_bf16_f32 v247, v46, v47
    s_waitcnt lgkmcnt(4)
    v_mfma_f32_32x32x16_bf16 v[48:63], a[208:211], a[112:115], v[48:63]
    ds_read_b64_tr_b16 a[208:209], v15 offset:28672
    ds_read_b64_tr_b16 a[210:211], v15 offset:29184
    v_accvgpr_write_b32 a192, v240
    v_accvgpr_write_b32 a193, v241
    v_mfma_f32_32x32x16_bf16 v[48:63], a[212:215], a[116:119], v[48:63]
    ds_read_b64_tr_b16 a[212:213], v15 offset:30720
    ds_read_b64_tr_b16 a[214:215], v15 offset:31232
    v_accvgpr_write_b32 a194, v242
    s_waitcnt lgkmcnt(4)
    v_mfma_f32_32x32x16_bf16 v[48:63], a[216:219], a[120:123], v[48:63]
    ds_read_b64_tr_b16 a[216:217], v15 offset:32768
    ds_read_b64_tr_b16 a[218:219], v15 offset:33280
    v_accvgpr_write_b32 a195, v243
    v_mfma_f32_32x32x16_bf16 v[48:63], a[220:223], a[124:127], v[48:63]
    ds_read_b64_tr_b16 a[220:221], v15 offset:34816
    ds_read_b64_tr_b16 a[222:223], v15 offset:35328
    v_accvgpr_write_b32 a196, v244
    s_waitcnt lgkmcnt(4)
    v_mfma_f32_32x32x16_bf16 v[48:63], a[208:211], a[128:131], v[48:63]
    s_waitcnt vmcnt(9)
    s_barrier
    v_add_u32 v14, s62, v10
    v_add_u32 v15, s62, v11
    ds_read_b64_tr_b16 a[208:209], v14 offset:0
    ds_read_b64_tr_b16 a[210:211], v14 offset:512
    v_accvgpr_write_b32 a197, v245
    v_mfma_f32_32x32x16_bf16 v[48:63], a[212:215], a[132:135], v[48:63]
    ds_read_b64_tr_b16 a[212:213], v14 offset:2048
    ds_read_b64_tr_b16 a[214:215], v14 offset:2560
    v_accvgpr_write_b32 a198, v246
    s_add_u32 s62, s62, 36864
    s_cmp_eq_u32 s62, 147456
    s_cselect_b32 s62, 0, s62
    s_waitcnt lgkmcnt(4)
    v_mfma_f32_32x32x16_bf16 v[48:63], a[216:219], a[136:139], v[48:63]
    ds_read_b64_tr_b16 a[216:217], v14 offset:4096
    ds_read_b64_tr_b16 a[218:219], v14 offset:4608
    v_accvgpr_write_b32 a199, v247
    s_add_u32 s63, s63, 36864
    s_cmp_eq_u32 s63, 147456
    s_cselect_b32 s63, 0, s63
    v_mfma_f32_32x32x16_bf16 v[48:63], a[220:223], a[140:143], v[48:63]
    ds_read_b64_tr_b16 a[220:221], v14 offset:6144
    ds_read_b64_tr_b16 a[222:223], v14 offset:6656
    s_add_u32 s33, s33, 128
    s_add_u32 s35, s35, 1
    s_cmp_lt_u32 s35, 4
    s_cbranch_scc1 mega_kernel_att_q
    s_and_b32 s77, s30, 7
    s_mul_i32 s76, s29, 294912
    s_mul_i32 s78, s77, 36864
    s_add_u32 s78, s78, s76
    s_lshl_b32 s79, s28, 13
    s_add_u32 s78, s78, s79
    v_lshlrev_b32 v4, 7, v1
    buffer_load_dword v252, v4, s[24:27], s78 offen
    s_add_u32 s78, s78, 32768
    buffer_load_dword v253, v4, s[24:27], s78 offen
    s_load_dwordx4 s[80:83], s[0:1], 48
    s_load_dwordx2 s[84:85], s[0:1], 64
    s_lshl_b32 s86, s2, 2
    s_add_u32 s86, s86, s28
    s_mul_hi_u32 s87, s86, 13256072
    s_mul_i32 s38, s87, 324
    s_sub_u32 s86, s86, s38
    s_waitcnt lgkmcnt(0)
    s_cmp_eq_u32 s87, 1
    s_waitcnt lgkmcnt(0)
    s_cselect_b32 s80, s82, s80
    s_cselect_b32 s81, s83, s81
    s_cmp_eq_u32 s87, 2
    s_cselect_b32 s80, s84, s80
    s_cselect_b32 s81, s85, s81
    s_cmp_eq_u32 s87, 3
    s_cselect_b32 s82, 0, 0x510000
    s_mov_b32 s83, 0x20000
    s_lshl_b32 s84, s86, 14
    v_lshlrev_b32 v8, 4, v1
    v_mov_b32 v16, v12
    v_mov_b32 v17, v13
    ds_read_b128 a[0:3], v16 offset:8192
    ds_read_b128 a[4:7], v17 offset:8192
    ds_read_b128 a[8:11], v16 offset:8256
    ds_read_b128 a[12:15], v17 offset:8256
    ds_read_b128 a[16:19], v16 offset:8320
    ds_read_b128 a[20:23], v17 offset:8320
    ds_read_b128 a[24:27], v16 offset:8384
    ds_read_b128 a[28:31], v17 offset:8384
    v_cvt_pk_bf16_f32 v240, v48, v49
    v_cvt_pk_bf16_f32 v241, v50, v51
    v_cvt_pk_bf16_f32 v242, v52, v53
    v_cvt_pk_bf16_f32 v243, v54, v55
    v_cvt_pk_bf16_f32 v244, v56, v57
    v_cvt_pk_bf16_f32 v245, v58, v59
    v_cvt_pk_bf16_f32 v246, v60, v61
    v_cvt_pk_bf16_f32 v247, v62, v63
    v_accvgpr_write_b32 a200, v240
    v_accvgpr_write_b32 a201, v241
    v_accvgpr_write_b32 a202, v242
    v_accvgpr_write_b32 a203, v243
    v_accvgpr_write_b32 a204, v244
    v_accvgpr_write_b32 a205, v245
    v_accvgpr_write_b32 a206, v246
    v_accvgpr_write_b32 a207, v247
    v_mov_b32 v48, 0
    v_mov_b32 v49, 0
    v_mov_b32 v50, 0
    v_mov_b32 v51, 0
    v_mov_b32 v52, 0xf0000000
    v_mov_b32 v53, 0xf0000000
    v_mov_b32 v54, 0xf0000000
    v_mov_b32 v55, 0xf0000000
    v_mov_b32 v56, 0xf0000000
    v_mov_b32 v57, 0xf0000000
    v_mov_b32 v58, 0xf0000000
    v_mov_b32 v59, 0xf0000000
    v_mov_b32 v60, 0xf0000000
    v_mov_b32 v61, 0xf0000000
    v_mov_b32 v62, 0xf0000000
    v_mov_b32 v63, 0xf0000000
    v_mov_b32 v104, 0
    v_mov_b32 v105, 0
    s_mov_b32 s35, 0
    v_add_u32 v14, 18432, v10
    v_add_u32 v15, 18432, v11
    v_add_u32 v16, 18432, v12
    v_add_u32 v17, 18432, v13
    s_mov_b32 s72, 36864
    s_mov_b32 s73, 55296
    s_add_u32 s67, s66, 24576
    s_add_u32 s68, s67, 1024
    s_add_u32 s69, s66, 32768
    s_waitcnt lgkmcnt(0)
mega_kernel_att_att:
    s_waitcnt lgkmcnt(0)
    v_mfma_f32_32x32x16_bf16 v[32:47], a[0:3], a[144:147], v[64:79]
    s_add_u32 s73, s73, 18432
    s_cmp_eq_u32 s73, 147456
    s_cselect_b32 s73, 0, s73
    v_exp_f32 v52, v52
    v_mfma_f32_32x32x16_bf16 v[32:47], a[4:7], a[148:151], v[32:47]
    v_exp_f32 v53, v53
    v_exp_f32 v54, v54
    v_exp_f32 v55, v55
    v_mfma_f32_32x32x16_bf16 v[32:47], a[8:11], a[152:155], v[32:47]
    v_cvt_pk_bf16_f32 v106, v52, v53
    v_cvt_pk_bf16_f32 v107, v54, v55
    v_exp_f32 v56, v56
    v_exp_f32 v57, v57
    v_mfma_f32_32x32x16_bf16 v[32:47], a[12:15], a[156:159], v[32:47]
    v_exp_f32 v58, v58
    v_exp_f32 v59, v59
    v_cvt_pk_bf16_f32 v108, v56, v57
    v_cvt_pk_bf16_f32 v109, v58, v59
    v_mfma_f32_32x32x16_bf16 v[32:47], a[16:19], a[160:163], v[32:47]
    v_exp_f32 v60, v60
    v_exp_f32 v61, v61
    v_exp_f32 v62, v62
    v_mfma_f32_32x32x16_bf16 v[32:47], a[20:23], a[164:167], v[32:47]
    v_exp_f32 v63, v63
    v_cvt_pk_bf16_f32 v110, v60, v61
    v_cvt_pk_bf16_f32 v111, v62, v63
    v_add_f32 v24, v24, v48
    v_add_f32 v24, v24, v49
    v_mfma_f32_32x32x16_bf16 v[32:47], a[24:27], a[168:171], v[32:47]
    v_add_f32 v24, v24, v50
    v_add_f32 v24, v24, v51
    v_add_f32 v24, v24, v52
    v_add_f32 v24, v24, v53
    v_add_f32 v24, v24, v54
    v_add_f32 v24, v24, v55
    v_mfma_f32_32x32x16_bf16 v[32:47], a[28:31], a[172:175], v[32:47]
    s_waitcnt vmcnt(11)
    s_barrier
    v_add_f32 v24, v24, v56
    v_add_f32 v24, v24, v57
    v_mfma_f32_32x32x16_bf16 v[176:191], a[224:227], v[104:107], v[176:191]
    ds_read_b64_tr_b16 a[224:225], v14 offset:0
    ds_read_b64_tr_b16 a[226:227], v14 offset:512
    v_add_f32 v24, v24, v58
    v_add_f32 v24, v24, v59
    v_add_f32 v24, v24, v60
    v_add_f32 v24, v24, v61
    v_mfma_f32_32x32x16_bf16 v[192:207], a[228:231], v[104:107], v[192:207]
    ds_read_b64_tr_b16 a[228:229], v15 offset:0
    ds_read_b64_tr_b16 a[230:231], v15 offset:512
    v_add_f32 v24, v24, v62
    v_add_f32 v24, v24, v63
    v_max3_f32 v25, v32, v33, v34
    v_max3_f32 v27, v35, v36, v37
    v_mfma_f32_32x32x16_bf16 v[208:223], a[232:235], v[104:107], v[208:223]
    ds_read_b64_tr_b16 a[232:233], v14 offset:4096
    ds_read_b64_tr_b16 a[234:235], v14 offset:4608
    v_max3_f32 v25, v25, v38, v39
    v_max3_f32 v27, v27, v40, v41
    v_max3_f32 v25, v25, v42, v43
    v_max3_f32 v27, v27, v44, v45
    v_mfma_f32_32x32x16_bf16 v[224:239], a[236:239], v[104:107], v[224:239]
    ds_read_b64_tr_b16 a[236:237], v15 offset:4096
    ds_read_b64_tr_b16 a[238:239], v15 offset:4608
    v_max3_f32 v25, v25, v46, v47
    v_max_f32 v25, v25, v27
    v_cmp_lt_f32 vcc, s39, v25
    v_mfma_f32_32x32x16_bf16 v[176:191], a[240:243], v[108:111], v[176:191]
    ds_read_b64_tr_b16 a[240:241], v14 offset:2048
    ds_read_b64_tr_b16 a[242:243], v14 offset:2560
    s_cbranch_vccnz mega_kernel_att_slowA
mega_kernel_att_backA:
    v_exp_f32 v32, v32
    v_mfma_f32_32x32x16_bf16 v[192:207], a[244:247], v[108:111], v[192:207]
    ds_read_b64_tr_b16 a[244:245], v15 offset:2048
    ds_read_b64_tr_b16 a[246:247], v15 offset:2560
    v_exp_f32 v33, v33
    v_exp_f32 v34, v34
    v_mfma_f32_32x32x16_bf16 v[208:223], a[248:251], v[108:111], v[208:223]
    ds_read_b64_tr_b16 a[248:249], v14 offset:6144
    ds_read_b64_tr_b16 a[250:251], v14 offset:6656
    v_exp_f32 v35, v35
    v_cvt_pk_bf16_f32 v96, v32, v33
    v_cvt_pk_bf16_f32 v97, v34, v35
    v_mfma_f32_32x32x16_bf16 v[224:239], a[252:255], v[108:111], v[224:239]
    ds_read_b64_tr_b16 a[252:253], v15 offset:6144
    ds_read_b64_tr_b16 a[254:255], v15 offset:6656
    v_exp_f32 v36, v36
    v_exp_f32 v37, v37
    v_mfma_f32_32x32x16_bf16 v[48:63], a[0:3], a[176:179], v[80:95]
    ds_read_b128 a[0:3], v16 offset:8192
    v_exp_f32 v38, v38
    v_exp_f32 v39, v39
    v_cvt_pk_bf16_f32 v98, v36, v37
    v_mfma_f32_32x32x16_bf16 v[48:63], a[4:7], a[180:183], v[48:63]
    ds_read_b128 a[4:7], v17 offset:8192
    v_cvt_pk_bf16_f32 v99, v38, v39
    v_exp_f32 v40, v40
    v_exp_f32 v41, v41
    v_mfma_f32_32x32x16_bf16 v[48:63], a[8:11], a[184:187], v[48:63]
    ds_read_b128 a[8:11], v16 offset:8256
    v_exp_f32 v42, v42
    v_exp_f32 v43, v43
    v_cvt_pk_bf16_f32 v100, v40, v41
    v_mfma_f32_32x32x16_bf16 v[48:63], a[12:15], a[188:191], v[48:63]
    ds_read_b128 a[12:15], v17 offset:8256
    v_cvt_pk_bf16_f32 v101, v42, v43
    v_exp_f32 v44, v44
    v_exp_f32 v45, v45
    v_mfma_f32_32x32x16_bf16 v[48:63], a[16:19], a[192:195], v[48:63]
    ds_read_b128 a[16:19], v16 offset:8320
    v_exp_f32 v46, v46
    v_exp_f32 v47, v47
    v_cvt_pk_bf16_f32 v102, v44, v45
    v_mfma_f32_32x32x16_bf16 v[48:63], a[20:23], a[196:199], v[48:63]
    ds_read_b128 a[20:23], v17 offset:8320
    v_cvt_pk_bf16_f32 v103, v46, v47
    v_add_f32 v23, v23, v32
    v_add_f32 v23, v23, v33
    v_add_f32 v23, v23, v34
    v_add_f32 v23, v23, v35
    v_mfma_f32_32x32x16_bf16 v[48:63], a[24:27], a[200:203], v[48:63]
    ds_read_b128 a[24:27], v16 offset:8384
    v_add_f32 v23, v23, v36
    v_add_f32 v23, v23, v37
    v_add_f32 v23, v23, v38
    v_add_f32 v23, v23, v39
    v_add_f32 v23, v23, v40
    v_mfma_f32_32x32x16_bf16 v[48:63], a[28:31], a[204:207], v[48:63]
    ds_read_b128 a[28:31], v17 offset:8384
    v_add_u32 v14, s72, v10
    v_add_u32 v15, s72, v11
    v_add_f32 v23, v23, v41
    v_add_f32 v23, v23, v42
    v_add_f32 v23, v23, v43
    s_waitcnt lgkmcnt(8)
    v_mfma_f32_32x32x16_bf16 v[112:127], a[224:227], v[96:99], v[112:127]
    s_cmp_lt_u32 s35, 13
    s_cselect_b32 s14, 0x800000, 0
    v_add_f32 v23, v23, v44
    v_add_f32 v23, v23, v45
    v_add_f32 v23, v23, v46
    v_add_f32 v23, v23, v47
    v_mfma_f32_32x32x16_bf16 v[128:143], a[228:231], v[96:99], v[128:143]
    s_add_u32 m0, s73, s75
    s_mov_b32 s18, s14
    v_max3_f32 v26, v48, v49, v50
    v_max3_f32 v27, v51, v52, v53
    v_max3_f32 v26, v26, v54, v55
    v_max3_f32 v27, v27, v56, v57
    v_mfma_f32_32x32x16_bf16 v[144:159], a[232:235], v[96:99], v[144:159]
    buffer_load_dwordx4 v22, s[16:19], s67 offen lds
    buffer_load_dwordx4 v22, s[16:19], s68 offen offset:1024 lds
    v_max3_f32 v26, v26, v58, v59
    v_max3_f32 v27, v27, v60, v61
    v_max3_f32 v26, v26, v62, v63
    v_max_f32 v26, v26, v27
    v_mfma_f32_32x32x16_bf16 v[160:175], a[236:239], v[96:99], v[160:175]
    s_add_u32 m0, s73, s74
    s_add_u32 s76, s73, 64
    v_cmp_lt_f32 vcc, s40, v26
    v_mfma_f32_32x32x16_bf16 v[112:127], a[240:243], v[100:103], v[112:127]
    s_cbranch_vccnz mega_kernel_att_slowB
mega_kernel_att_backB:
    buffer_load_dwordx4 v21, s[12:15], s69 offen lds
    s_add_u32 m0, s76, s74
    v_exp_f32 v48, v48
    v_mfma_f32_32x32x16_bf16 v[128:143], a[244:247], v[100:103], v[128:143]
    s_add_u32 s67, s67, 8192
    buffer_load_dwordx4 v21, s[12:15], s69 offen offset:1024 lds
    v_exp_f32 v49, v49
    v_exp_f32 v50, v50
    v_mfma_f32_32x32x16_bf16 v[144:159], a[248:251], v[100:103], v[144:159]
    s_add_u32 s68, s68, 8192
    s_add_u32 s69, s69, 8192
    v_add_u32 v16, s72, v12
    v_add_u32 v17, s72, v13
    v_exp_f32 v51, v51
    v_mfma_f32_32x32x16_bf16 v[160:175], a[252:255], v[100:103], v[160:175]
    buffer_load_dwordx4 v[28:31], v8, s[80:83], s84 offen
    s_add_u32 s84, s84, 1024
    s_add_u32 s72, s72, 18432
    s_cmp_eq_u32 s72, 147456
    s_cselect_b32 s72, 0, s72
    v_cvt_pk_bf16_f32 v104, v48, v49
    v_cvt_pk_bf16_f32 v105, v50, v51
    s_add_u32 s35, s35, 1
    s_cmp_lt_u32 s35, 16
    s_cbranch_scc1 mega_kernel_att_att
    s_add_u32 m0, s34, 73728
    v_mov_b32 v18, v20
    buffer_load_dwordx4 v18, s[24:27], s54 offen offset:0 lds
    buffer_load_dwordx4 v18, s[24:27], s55 offen offset:1024 lds
    buffer_load_dwordx4 v18, s[24:27], s56 offen offset:2048 lds
    buffer_load_dwordx4 v18, s[24:27], s57 offen offset:3072 lds
    s_add_u32 m0, s34, 77824
    s_nop 0
    buffer_load_dwordx4 v18, s[24:27], s58 offen offset:0 lds
    buffer_load_dwordx4 v18, s[24:27], s59 offen offset:1024 lds
    buffer_load_dwordx4 v18, s[24:27], s60 offen offset:2048 lds
    buffer_load_dwordx4 v18, s[24:27], s61 offen offset:3072 lds
    s_add_u32 m0, s34, 110592
    v_add_u32 v18, 128, v20
    buffer_load_dwordx4 v18, s[24:27], s54 offen offset:0 lds
    buffer_load_dwordx4 v18, s[24:27], s55 offen offset:1024 lds
    buffer_load_dwordx4 v18, s[24:27], s56 offen offset:2048 lds
    buffer_load_dwordx4 v18, s[24:27], s57 offen offset:3072 lds
    s_add_u32 m0, s34, 114688
    s_nop 0
    buffer_load_dwordx4 v18, s[24:27], s58 offen offset:0 lds
    buffer_load_dwordx4 v18, s[24:27], s59 offen offset:1024 lds
    buffer_load_dwordx4 v18, s[24:27], s60 offen offset:2048 lds
    buffer_load_dwordx4 v18, s[24:27], s61 offen offset:3072 lds
    v_exp_f32 v52, v52
    v_exp_f32 v53, v53
    v_exp_f32 v54, v54
    v_exp_f32 v55, v55
    v_cvt_pk_bf16_f32 v106, v52, v53
    v_cvt_pk_bf16_f32 v107, v54, v55
    v_exp_f32 v56, v56
    v_exp_f32 v57, v57
    v_exp_f32 v58, v58
    v_exp_f32 v59, v59
    v_cvt_pk_bf16_f32 v108, v56, v57
    v_cvt_pk_bf16_f32 v109, v58, v59
    v_exp_f32 v60, v60
    v_exp_f32 v61, v61
    v_exp_f32 v62, v62
    v_exp_f32 v63, v63
    v_cvt_pk_bf16_f32 v110, v60, v61
    v_cvt_pk_bf16_f32 v111, v62, v63
    v_mfma_f32_32x32x16_bf16 v[176:191], a[224:227], v[104:107], v[176:191]
    v_add_f32 v24, v24, v48
    v_add_f32 v24, v24, v49
    v_add_f32 v24, v24, v50
    v_add_f32 v24, v24, v51
    v_add_f32 v24, v24, v52
    v_add_f32 v24, v24, v53
    v_mfma_f32_32x32x16_bf16 v[192:207], a[228:231], v[104:107], v[192:207]
    v_add_f32 v24, v24, v54
    v_add_f32 v24, v24, v55
    v_add_f32 v24, v24, v56
    v_add_f32 v24, v24, v57
    v_add_f32 v24, v24, v58
    v_add_f32 v24, v24, v59
    v_mfma_f32_32x32x16_bf16 v[208:223], a[232:235], v[104:107], v[208:223]
    v_add_f32 v24, v24, v60
    v_add_f32 v24, v24, v61
    v_add_f32 v24, v24, v62
    v_add_f32 v24, v24, v63
    v_mov_b32 v27, v23
    s_nop 1
    v_permlane32_swap_b32 v27, v23
    v_mfma_f32_32x32x16_bf16 v[224:239], a[236:239], v[104:107], v[224:239]
    v_add_f32 v23, v23, v27
    v_rcp_f32 v23, v23
    s_nop 0
    v_mul_f32 v112, v112, v23
    v_mul_f32 v113, v113, v23
    v_cvt_pk_bf16_f32 v112, v112, v113
    v_mfma_f32_32x32x16_bf16 v[176:191], a[240:243], v[108:111], v[176:191]
    v_mul_f32 v114, v114, v23
    v_mul_f32 v115, v115, v23
    v_cvt_pk_bf16_f32 v113, v114, v115
    v_mul_f32 v116, v116, v23
    v_mul_f32 v117, v117, v23
    v_cvt_pk_bf16_f32 v114, v116, v117
    v_mfma_f32_32x32x16_bf16 v[192:207], a[244:247], v[108:111], v[192:207]
    v_mul_f32 v118, v118, v23
    v_mul_f32 v119, v119, v23
    v_cvt_pk_bf16_f32 v115, v118, v119
    v_mul_f32 v120, v120, v23
    v_mul_f32 v121, v121, v23
    v_cvt_pk_bf16_f32 v116, v120, v121
    v_mfma_f32_32x32x16_bf16 v[208:223], a[248:251], v[108:111], v[208:223]
    v_mul_f32 v122, v122, v23
    v_mul_f32 v123, v123, v23
    v_cvt_pk_bf16_f32 v117, v122, v123
    v_mul_f32 v124, v124, v23
    v_mul_f32 v125, v125, v23
    v_cvt_pk_bf16_f32 v118, v124, v125
    v_mfma_f32_32x32x16_bf16 v[224:239], a[252:255], v[108:111], v[224:239]
    v_mul_f32 v126, v126, v23
    v_mul_f32 v127, v127, v23
    v_cvt_pk_bf16_f32 v119, v126, v127
    v_mul_f32 v128, v128, v23
    v_mul_f32 v129, v129, v23
    v_cvt_pk_bf16_f32 v120, v128, v129
    v_mul_f32 v130, v130, v23
    v_mul_f32 v131, v131, v23
    v_cvt_pk_bf16_f32 v121, v130, v131
    v_mul_f32 v132, v132, v23
    v_mul_f32 v133, v133, v23
    v_cvt_pk_bf16_f32 v122, v132, v133
    v_mul_f32 v134, v134, v23
    v_mul_f32 v135, v135, v23
    v_cvt_pk_bf16_f32 v123, v134, v135
    v_mul_f32 v136, v136, v23
    v_mul_f32 v137, v137, v23
    v_cvt_pk_bf16_f32 v124, v136, v137
    v_mul_f32 v138, v138, v23
    v_mul_f32 v139, v139, v23
    v_cvt_pk_bf16_f32 v125, v138, v139
    v_mul_f32 v140, v140, v23
    v_mul_f32 v141, v141, v23
    v_cvt_pk_bf16_f32 v126, v140, v141
    v_mul_f32 v142, v142, v23
    v_mul_f32 v143, v143, v23
    v_cvt_pk_bf16_f32 v127, v142, v143
    v_mul_f32 v144, v144, v23
    v_mul_f32 v145, v145, v23
    v_cvt_pk_bf16_f32 v128, v144, v145
    v_mul_f32 v146, v146, v23
    v_mul_f32 v147, v147, v23
    v_cvt_pk_bf16_f32 v129, v146, v147
    v_mul_f32 v148, v148, v23
    v_mul_f32 v149, v149, v23
    v_cvt_pk_bf16_f32 v130, v148, v149
    v_mul_f32 v150, v150, v23
    v_mul_f32 v151, v151, v23
    v_cvt_pk_bf16_f32 v131, v150, v151
    v_mul_f32 v152, v152, v23
    v_mul_f32 v153, v153, v23
    v_cvt_pk_bf16_f32 v132, v152, v153
    v_mul_f32 v154, v154, v23
    v_mul_f32 v155, v155, v23
    v_cvt_pk_bf16_f32 v133, v154, v155
    v_mul_f32 v156, v156, v23
    v_mul_f32 v157, v157, v23
    v_cvt_pk_bf16_f32 v134, v156, v157
    v_mul_f32 v158, v158, v23
    v_mul_f32 v159, v159, v23
    v_cvt_pk_bf16_f32 v135, v158, v159
    v_mul_f32 v160, v160, v23
    v_mul_f32 v161, v161, v23
    v_cvt_pk_bf16_f32 v136, v160, v161
    v_mul_f32 v162, v162, v23
    v_mul_f32 v163, v163, v23
    v_cvt_pk_bf16_f32 v137, v162, v163
    v_mul_f32 v164, v164, v23
    v_mul_f32 v165, v165, v23
    v_cvt_pk_bf16_f32 v138, v164, v165
    v_mul_f32 v166, v166, v23
    v_mul_f32 v167, v167, v23
    v_cvt_pk_bf16_f32 v139, v166, v167
    v_mul_f32 v168, v168, v23
    v_mul_f32 v169, v169, v23
    v_cvt_pk_bf16_f32 v140, v168, v169
    v_mul_f32 v170, v170, v23
    v_mul_f32 v171, v171, v23
    v_cvt_pk_bf16_f32 v141, v170, v171
    v_mul_f32 v172, v172, v23
    v_mul_f32 v173, v173, v23
    v_cvt_pk_bf16_f32 v142, v172, v173
    v_mul_f32 v174, v174, v23
    v_mul_f32 v175, v175, v23
    v_cvt_pk_bf16_f32 v143, v174, v175
    v_mov_b32 v27, v24
    s_nop 1
    v_permlane32_swap_b32 v27, v24
    v_add_f32 v24, v24, v27
    v_rcp_f32 v24, v24
    s_nop 0
    v_mul_f32 v176, v176, v24
    v_mul_f32 v177, v177, v24
    v_cvt_pk_bf16_f32 v176, v176, v177
    v_mul_f32 v178, v178, v24
    v_mul_f32 v179, v179, v24
    v_cvt_pk_bf16_f32 v177, v178, v179
    v_mul_f32 v180, v180, v24
    v_mul_f32 v181, v181, v24
    v_cvt_pk_bf16_f32 v178, v180, v181
    v_mul_f32 v182, v182, v24
    v_mul_f32 v183, v183, v24
    v_cvt_pk_bf16_f32 v179, v182, v183
    v_mul_f32 v184, v184, v24
    v_mul_f32 v185, v185, v24
    v_cvt_pk_bf16_f32 v180, v184, v185
    v_mul_f32 v186, v186, v24
    v_mul_f32 v187, v187, v24
    v_cvt_pk_bf16_f32 v181, v186, v187
    v_mul_f32 v188, v188, v24
    v_mul_f32 v189, v189, v24
    v_cvt_pk_bf16_f32 v182, v188, v189
    v_mul_f32 v190, v190, v24
    v_mul_f32 v191, v191, v24
    v_cvt_pk_bf16_f32 v183, v190, v191
    v_mul_f32 v192, v192, v24
    v_mul_f32 v193, v193, v24
    v_cvt_pk_bf16_f32 v184, v192, v193
    v_mul_f32 v194, v194, v24
    v_mul_f32 v195, v195, v24
    v_cvt_pk_bf16_f32 v185, v194, v195
    v_mul_f32 v196, v196, v24
    v_mul_f32 v197, v197, v24
    v_cvt_pk_bf16_f32 v186, v196, v197
    v_mul_f32 v198, v198, v24
    v_mul_f32 v199, v199, v24
    v_cvt_pk_bf16_f32 v187, v198, v199
    v_mul_f32 v200, v200, v24
    v_mul_f32 v201, v201, v24
    v_cvt_pk_bf16_f32 v188, v200, v201
    v_mul_f32 v202, v202, v24
    v_mul_f32 v203, v203, v24
    v_cvt_pk_bf16_f32 v189, v202, v203
    v_mul_f32 v204, v204, v24
    v_mul_f32 v205, v205, v24
    v_cvt_pk_bf16_f32 v190, v204, v205
    v_mul_f32 v206, v206, v24
    v_mul_f32 v207, v207, v24
    v_cvt_pk_bf16_f32 v191, v206, v207
    v_mul_f32 v208, v208, v24
    v_mul_f32 v209, v209, v24
    v_cvt_pk_bf16_f32 v192, v208, v209
    v_mul_f32 v210, v210, v24
    v_mul_f32 v211, v211, v24
    v_cvt_pk_bf16_f32 v193, v210, v211
    v_mul_f32 v212, v212, v24
    v_mul_f32 v213, v213, v24
    v_cvt_pk_bf16_f32 v194, v212, v213
    v_mul_f32 v214, v214, v24
    v_mul_f32 v215, v215, v24
    v_cvt_pk_bf16_f32 v195, v214, v215
    v_mul_f32 v216, v216, v24
    v_mul_f32 v217, v217, v24
    v_cvt_pk_bf16_f32 v196, v216, v217
    v_mul_f32 v218, v218, v24
    v_mul_f32 v219, v219, v24
    v_cvt_pk_bf16_f32 v197, v218, v219
    v_mul_f32 v220, v220, v24
    v_mul_f32 v221, v221, v24
    v_cvt_pk_bf16_f32 v198, v220, v221
    v_mul_f32 v222, v222, v24
    v_mul_f32 v223, v223, v24
    v_cvt_pk_bf16_f32 v199, v222, v223
    v_mul_f32 v224, v224, v24
    v_mul_f32 v225, v225, v24
    v_cvt_pk_bf16_f32 v200, v224, v225
    v_mul_f32 v226, v226, v24
    v_mul_f32 v227, v227, v24
    v_cvt_pk_bf16_f32 v201, v226, v227
    v_mul_f32 v228, v228, v24
    v_mul_f32 v229, v229, v24
    v_cvt_pk_bf16_f32 v202, v228, v229
    v_mul_f32 v230, v230, v24
    v_mul_f32 v231, v231, v24
    v_cvt_pk_bf16_f32 v203, v230, v231
    v_mul_f32 v232, v232, v24
    v_mul_f32 v233, v233, v24
    v_cvt_pk_bf16_f32 v204, v232, v233
    v_mul_f32 v234, v234, v24
    v_mul_f32 v235, v235, v24
    v_cvt_pk_bf16_f32 v205, v234, v235
    v_mul_f32 v236, v236, v24
    v_mul_f32 v237, v237, v24
    v_cvt_pk_bf16_f32 v206, v236, v237
    v_mul_f32 v238, v238, v24
    v_mul_f32 v239, v239, v24
    v_cvt_pk_bf16_f32 v207, v238, v239
    s_waitcnt vmcnt(8)
    s_barrier
    v_add_u32 v14, 73728, v10
    v_add_u32 v15, 73728, v11
    ds_read_b64_tr_b16 a[208:209], v14 offset:0
    ds_read_b64_tr_b16 a[210:211], v14 offset:512
    ds_read_b64_tr_b16 a[212:213], v14 offset:2048
    ds_read_b64_tr_b16 a[214:215], v14 offset:2560
    ds_read_b64_tr_b16 a[216:217], v14 offset:4096
    ds_read_b64_tr_b16 a[218:219], v14 offset:4608
    ds_read_b64_tr_b16 a[220:221], v14 offset:6144
    ds_read_b64_tr_b16 a[222:223], v14 offset:6656
    s_mov_b32 s35, 0
    s_mov_b32 s62, 110592
    s_mov_b32 s63, 0
    s_mov_b32 s65, 256
    s_mov_b32 s71, 0x7ff00000
    v_and_b32 v8, 31, v0
    v_lshlrev_b32 v8, 7, v8
    s_lshr_b32 s36, s29, 2
    s_cmp_eq_u32 s36, s28
    s_cselect_b32 s36, 2, 100
    s_mov_b32 s37, 0x7ff00000
    buffer_load_dword v7, v8, s[20:23], s37 offen
mega_kernel_att_down:
    s_add_u32 s64, s34, s63
    s_cmp_lt_u32 s35, 7
    s_cselect_b32 s26, 0x480000, 0
    s_waitcnt lgkmcnt(4)
    v_mfma_f32_32x32x16_bf16 v[32:47], a[208:211], v[112:115], 0
    ds_read_b64_tr_b16 a[208:209], v14 offset:8192
    ds_read_b64_tr_b16 a[210:211], v14 offset:8704
    s_add_u32 m0, s64, 0
    v_add_u32 v18, s65, v20
    v_mfma_f32_32x32x16_bf16 v[32:47], a[212:215], v[116:119], v[32:47]
    ds_read_b64_tr_b16 a[212:213], v14 offset:10240
    ds_read_b64_tr_b16 a[214:215], v14 offset:10752
    s_waitcnt lgkmcnt(4)
    v_mfma_f32_32x32x16_bf16 v[32:47], a[216:219], v[120:123], v[32:47]
    ds_read_b64_tr_b16 a[216:217], v14 offset:12288
    ds_read_b64_tr_b16 a[218:219], v14 offset:12800
    buffer_load_dwordx4 v18, s[24:27], s54 offen offset:0 lds
    v_mfma_f32_32x32x16_bf16 v[32:47], a[220:223], v[124:127], v[32:47]
    ds_read_b64_tr_b16 a[220:221], v14 offset:14336
    ds_read_b64_tr_b16 a[222:223], v14 offset:14848
    v_cvt_pk_bf16_f32 v248, v48, v49
    s_waitcnt lgkmcnt(4)
    v_mfma_f32_32x32x16_bf16 v[32:47], a[208:211], v[128:131], v[32:47]
    ds_read_b64_tr_b16 a[208:209], v14 offset:16384
    ds_read_b64_tr_b16 a[210:211], v14 offset:16896
    buffer_load_dwordx4 v18, s[24:27], s55 offen offset:1024 lds
    v_cvt_pk_bf16_f32 v249, v50, v51
    v_mfma_f32_32x32x16_bf16 v[32:47], a[212:215], v[132:135], v[32:47]
    ds_read_b64_tr_b16 a[212:213], v14 offset:18432
    ds_read_b64_tr_b16 a[214:215], v14 offset:18944
    v_cvt_pk_bf16_f32 v250, v52, v53
    s_waitcnt lgkmcnt(4)
    v_mfma_f32_32x32x16_bf16 v[32:47], a[216:219], v[136:139], v[32:47]
    ds_read_b64_tr_b16 a[216:217], v14 offset:20480
    ds_read_b64_tr_b16 a[218:219], v14 offset:20992
    buffer_load_dwordx4 v18, s[24:27], s56 offen offset:2048 lds
    v_cvt_pk_bf16_f32 v251, v54, v55
    v_mfma_f32_32x32x16_bf16 v[32:47], a[220:223], v[140:143], v[32:47]
    ds_read_b64_tr_b16 a[220:221], v14 offset:22528
    ds_read_b64_tr_b16 a[222:223], v14 offset:23040
    buffer_store_dwordx4 v[248:251], v9, s[20:23], s71 offen sc1
    s_waitcnt lgkmcnt(4)
    v_mfma_f32_32x32x16_bf16 v[32:47], a[208:211], v[176:179], v[32:47]
    ds_read_b64_tr_b16 a[208:209], v14 offset:24576
    ds_read_b64_tr_b16 a[210:211], v14 offset:25088
    buffer_load_dwordx4 v18, s[24:27], s57 offen offset:3072 lds
    s_add_u32 m0, s64, 4096
    v_cvt_pk_bf16_f32 v252, v56, v57
    v_mfma_f32_32x32x16_bf16 v[32:47], a[212:215], v[180:183], v[32:47]
    ds_read_b64_tr_b16 a[212:213], v14 offset:26624
    ds_read_b64_tr_b16 a[214:215], v14 offset:27136
    v_cvt_pk_bf16_f32 v253, v58, v59
    s_waitcnt lgkmcnt(4)
    v_mfma_f32_32x32x16_bf16 v[32:47], a[216:219], v[184:187], v[32:47]
    ds_read_b64_tr_b16 a[216:217], v14 offset:28672
    ds_read_b64_tr_b16 a[218:219], v14 offset:29184
    buffer_load_dwordx4 v18, s[24:27], s58 offen offset:0 lds
    v_cvt_pk_bf16_f32 v254, v60, v61
    v_mfma_f32_32x32x16_bf16 v[32:47], a[220:223], v[188:191], v[32:47]
    ds_read_b64_tr_b16 a[220:221], v14 offset:30720
    ds_read_b64_tr_b16 a[222:223], v14 offset:31232
    v_cvt_pk_bf16_f32 v255, v62, v63
    s_waitcnt lgkmcnt(4)
    v_mfma_f32_32x32x16_bf16 v[32:47], a[208:211], v[192:195], v[32:47]
    ds_read_b64_tr_b16 a[208:209], v15 offset:0
    ds_read_b64_tr_b16 a[210:211], v15 offset:512
    buffer_load_dwordx4 v18, s[24:27], s59 offen offset:1024 lds
    buffer_store_dwordx4 v[252:255], v9, s[20:23], s71 offen offset:1024 sc1
    v_mfma_f32_32x32x16_bf16 v[32:47], a[212:215], v[196:199], v[32:47]
    ds_read_b64_tr_b16 a[212:213], v15 offset:2048
    ds_read_b64_tr_b16 a[214:215], v15 offset:2560
    s_waitcnt lgkmcnt(4)
    v_mfma_f32_32x32x16_bf16 v[32:47], a[216:219], v[200:203], v[32:47]
    ds_read_b64_tr_b16 a[216:217], v15 offset:4096
    ds_read_b64_tr_b16 a[218:219], v15 offset:4608
    buffer_load_dwordx4 v18, s[24:27], s60 offen offset:2048 lds
    v_mfma_f32_32x32x16_bf16 v[32:47], a[220:223], v[204:207], v[32:47]
    ds_read_b64_tr_b16 a[220:221], v15 offset:6144
    ds_read_b64_tr_b16 a[222:223], v15 offset:6656
    s_waitcnt lgkmcnt(4)
    v_mfma_f32_32x32x16_bf16 v[48:63], a[208:211], v[112:115], 0
    ds_read_b64_tr_b16 a[208:209], v15 offset:8192
    ds_read_b64_tr_b16 a[210:211], v15 offset:8704
    buffer_load_dwordx4 v18, s[24:27], s61 offen offset:3072 lds
    v_mfma_f32_32x32x16_bf16 v[48:63], a[212:215], v[116:119], v[48:63]
    ds_read_b64_tr_b16 a[212:213], v15 offset:10240
    ds_read_b64_tr_b16 a[214:215], v15 offset:10752
    s_waitcnt lgkmcnt(4)
    v_mfma_f32_32x32x16_bf16 v[48:63], a[216:219], v[120:123], v[48:63]
    ds_read_b64_tr_b16 a[216:217], v15 offset:12288
    ds_read_b64_tr_b16 a[218:219], v15 offset:12800
    v_mfma_f32_32x32x16_bf16 v[48:63], a[220:223], v[124:127], v[48:63]
    ds_read_b64_tr_b16 a[220:221], v15 offset:14336
    ds_read_b64_tr_b16 a[222:223], v15 offset:14848
    v_cvt_pk_bf16_f32 v240, v32, v33
    v_cvt_pk_bf16_f32 v241, v34, v35
    s_waitcnt lgkmcnt(4)
    v_mfma_f32_32x32x16_bf16 v[48:63], a[208:211], v[128:131], v[48:63]
    ds_read_b64_tr_b16 a[208:209], v15 offset:16384
    ds_read_b64_tr_b16 a[210:211], v15 offset:16896
    v_cvt_pk_bf16_f32 v242, v36, v37
    s_add_u32 s65, s65, 128
    v_mfma_f32_32x32x16_bf16 v[48:63], a[212:215], v[132:135], v[48:63]
    ds_read_b64_tr_b16 a[212:213], v15 offset:18432
    ds_read_b64_tr_b16 a[214:215], v15 offset:18944
    v_cvt_pk_bf16_f32 v243, v38, v39
    s_waitcnt lgkmcnt(4)
    v_mfma_f32_32x32x16_bf16 v[48:63], a[216:219], v[136:139], v[48:63]
    ds_read_b64_tr_b16 a[216:217], v15 offset:20480
    ds_read_b64_tr_b16 a[218:219], v15 offset:20992
    buffer_store_dwordx4 v[240:243], v9, s[20:23], s70 offen sc1
    s_add_u32 s63, s63, 36864
    s_cmp_eq_u32 s63, 147456
    s_cselect_b32 s63, 0, s63
    v_mfma_f32_32x32x16_bf16 v[48:63], a[220:223], v[140:143], v[48:63]
    ds_read_b64_tr_b16 a[220:221], v15 offset:22528
    ds_read_b64_tr_b16 a[222:223], v15 offset:23040
    v_cvt_pk_bf16_f32 v244, v40, v41
    v_cvt_pk_bf16_f32 v245, v42, v43
    s_waitcnt lgkmcnt(4)
    v_mfma_f32_32x32x16_bf16 v[48:63], a[208:211], v[176:179], v[48:63]
    ds_read_b64_tr_b16 a[208:209], v15 offset:24576
    ds_read_b64_tr_b16 a[210:211], v15 offset:25088
    v_cvt_pk_bf16_f32 v246, v44, v45
    v_mfma_f32_32x32x16_bf16 v[48:63], a[212:215], v[180:183], v[48:63]
    ds_read_b64_tr_b16 a[212:213], v15 offset:26624
    ds_read_b64_tr_b16 a[214:215], v15 offset:27136
    v_cvt_pk_bf16_f32 v247, v46, v47
    s_waitcnt lgkmcnt(4)
    v_mfma_f32_32x32x16_bf16 v[48:63], a[216:219], v[184:187], v[48:63]
    ds_read_b64_tr_b16 a[216:217], v15 offset:28672
    ds_read_b64_tr_b16 a[218:219], v15 offset:29184
    buffer_store_dwordx4 v[244:247], v9, s[20:23], s70 offen offset:1024 sc1
    v_mfma_f32_32x32x16_bf16 v[48:63], a[220:223], v[188:191], v[48:63]
    ds_read_b64_tr_b16 a[220:221], v15 offset:30720
    ds_read_b64_tr_b16 a[222:223], v15 offset:31232
    s_waitcnt lgkmcnt(4)
    v_mfma_f32_32x32x16_bf16 v[48:63], a[208:211], v[192:195], v[48:63]
    s_waitcnt vmcnt(13)
    s_barrier
    v_add_u32 v14, s62, v10
    v_add_u32 v15, s62, v11
    ds_read_b64_tr_b16 a[208:209], v14 offset:0
    ds_read_b64_tr_b16 a[210:211], v14 offset:512
    s_sub_u32 s37, s70, 8192
    s_cmp_ge_u32 s35, s36
    s_cselect_b32 s37, s37, 0x7ff00000
    buffer_load_dword v7, v8, s[20:23], s37 offen
    v_mfma_f32_32x32x16_bf16 v[48:63], a[212:215], v[196:199], v[48:63]
    ds_read_b64_tr_b16 a[212:213], v14 offset:2048
    ds_read_b64_tr_b16 a[214:215], v14 offset:2560
    s_add_u32 s71, s70, 2048
    s_add_u32 s70, s70, 4096
    s_waitcnt lgkmcnt(4)
    v_mfma_f32_32x32x16_bf16 v[48:63], a[216:219], v[200:203], v[48:63]
    ds_read_b64_tr_b16 a[216:217], v14 offset:4096
    ds_read_b64_tr_b16 a[218:219], v14 offset:4608
    s_add_u32 s62, s62, 36864
    s_cmp_eq_u32 s62, 147456
    s_cselect_b32 s62, 0, s62
    v_mfma_f32_32x32x16_bf16 v[48:63], a[220:223], v[204:207], v[48:63]
    ds_read_b64_tr_b16 a[220:221], v14 offset:6144
    ds_read_b64_tr_b16 a[222:223], v14 offset:6656
    s_add_u32 s35, s35, 1
    s_cmp_lt_u32 s35, 9
    s_cbranch_scc1 mega_kernel_att_down
    s_nop 6
    v_cvt_pk_bf16_f32 v248, v48, v49
    v_cvt_pk_bf16_f32 v249, v50, v51
    v_cvt_pk_bf16_f32 v250, v52, v53
    v_cvt_pk_bf16_f32 v251, v54, v55
    buffer_store_dwordx4 v[248:251], v9, s[20:23], s71 offen sc1
    v_cvt_pk_bf16_f32 v252, v56, v57
    v_cvt_pk_bf16_f32 v253, v58, v59
    v_cvt_pk_bf16_f32 v254, v60, v61
    v_cvt_pk_bf16_f32 v255, v62, v63
    buffer_store_dwordx4 v[252:255], v9, s[20:23], s71 offen offset:1024 sc1
    s_waitcnt vmcnt(0)
    s_barrier
    s_cmp_lg_u32 s28, 0
    s_cbranch_scc1 mega_kernel_sigb
    s_lshl_b32 s90, s30, 9
    s_lshr_b32 s91, s29, 2
    s_lshl_b32 s91, s91, 7
    s_add_u32 s90, s90, s91
    s_add_u32 s90, s90, 82649088
    s_mov_b64 s[92:93], exec
    s_mov_b64 exec, 1
    v_mov_b32 v250, 1
    v_mov_b32 v251, 0
    buffer_atomic_add v250, v251, s[20:23], s90 offen
    s_mov_b64 exec, s[92:93]
mega_kernel_sigb:
    s_load_dwordx2 s[4:5], s[0:1], 0
    s_load_dwordx2 s[6:7], s[0:1], 88
    s_load_dwordx2 s[20:21], s[0:1], 104
    v_and_b32 v1, 7, v0
    v_lshrrev_b32 v2, 3, v0
    s_mov_b32 s38, 1152
    v_mul_lo_u32 v5, v1, s38
    v_lshlrev_b32 v4, 4, v2
    v_add_u32 v5, v5, v4
    v_lshrrev_b32 v6, 4, v0
    v_lshlrev_b32 v6, 6, v6
    v_and_b32 v3, 1, v2
    v_lshlrev_b32 v3, 5, v3
    v_add3_u32 v6, v6, v3, v1
    v_lshlrev_b32 v6, 4, v6
    s_lshl_b32 s36, s30, 4
    s_add_u32 s36, s36, s29
    s_mul_i32 s32, s36, 9216
    s_lshr_b32 s33, s36, 2
    s_mul_i32 s33, s33, 36864
    s_and_b32 s36, s36, 3
    s_lshl_b32 s36, s36, 7
    s_add_u32 s33, s33, s36
    s_cmp_eq_u32 s28, 0
    s_cselect_b32 s35, 0, 0x7ff00000
    v_add_u32 v4, 160256, v4
    s_cselect_b32 s36, 1024, 0
    v_add_u32 v3, s36, v4
    s_waitcnt lgkmcnt(0)
    s_mov_b32 s8, s4
    s_mov_b32 s9, s5
    s_mov_b32 s10, 0x240000
    s_mov_b32 s11, 0x20000
    s_mov_b32 s12, s6
    s_mov_b32 s13, s7
    s_mov_b32 s14, 0x240000
    s_mov_b32 s15, 0x20000
    s_mov_b32 s22, 0x4ed8000
    s_mov_b32 s23, 0x20000
    s_add_u32 s36, s32, 0
    buffer_load_dwordx4 a[200:203], v5, s[8:11], s36 offen offset:0
    s_add_u32 s36, s32, 0
    buffer_load_dwordx4 a[204:207], v5, s[8:11], s36 offen offset:512
    s_add_u32 s36, s32, 0
    s_add_u32 s36, s36, s35
    buffer_load_dwordx4 a[208:211], v5, s[8:11], s36 offen offset:1024
    v_lshlrev_b32 v2, 4, v0
    s_mov_b32 s36, 12800
    buffer_load_dwordx4 v[64:67], v2, s[20:23], s36 offen sc1
    s_mov_b32 s36, 26624
    buffer_load_dwordx4 v[68:71], v2, s[20:23], s36 offen sc1
    s_mov_b32 s36, 40448
    buffer_load_dwordx4 v[72:75], v2, s[20:23], s36 offen sc1
    s_mov_b32 s36, 17408
    buffer_load_dwordx4 v[76:79], v2, s[20:23], s36 offen sc1
    s_mov_b32 s36, 31232
    buffer_load_dwordx4 v[80:83], v2, s[20:23], s36 offen sc1
    s_mov_b32 s36, 45056
    buffer_load_dwordx4 v[84:87], v2, s[20:23], s36 offen sc1
    s_mov_b32 s36, 15104
    buffer_load_dwordx4 v[88:91], v2, s[20:23], s36 offen sc1
    s_mov_b32 s36, 28928
    buffer_load_dwordx4 v[92:95], v2, s[20:23], s36 offen sc1
    s_mov_b32 s36, 42752
    buffer_load_dwordx4 v[96:99], v2, s[20:23], s36 offen sc1
    v_lshlrev_b32 v9, 3, v0
    v_add_u32 v9, 160256, v9
    v_cmp_gt_u32 vcc, 144, v0
    s_mov_b64 s[92:93], exec
    s_waitcnt vmcnt(7)
    v_add_f32 v64, v64, v68
    v_add_f32 v65, v65, v69
    v_add_f32 v66, v66, v70
    v_add_f32 v67, v67, v71
    s_waitcnt vmcnt(6)
    v_add_f32 v64, v64, v72
    v_add_f32 v65, v65, v73
    v_add_f32 v66, v66, v74
    v_add_f32 v67, v67, v75
    v_cvt_pk_bf16_f32 v68, v64, v65
    v_cvt_pk_bf16_f32 v69, v66, v67
    s_waitcnt vmcnt(4)
    v_add_f32 v76, v76, v80
    v_add_f32 v77, v77, v81
    v_add_f32 v78, v78, v82
    v_add_f32 v79, v79, v83
    s_waitcnt vmcnt(3)
    v_add_f32 v76, v76, v84
    v_add_f32 v77, v77, v85
    v_add_f32 v78, v78, v86
    v_add_f32 v79, v79, v87
    v_cvt_pk_bf16_f32 v80, v76, v77
    v_cvt_pk_bf16_f32 v81, v78, v79
    v_lshlrev_b32 v76, 16, v80
    v_and_b32 v77, 0xffff0000, v80
    v_lshlrev_b32 v78, 16, v81
    v_and_b32 v79, 0xffff0000, v81
    v_add_f32 v76, 1.0, v76
    v_add_f32 v77, 1.0, v77
    v_add_f32 v78, 1.0, v78
    v_add_f32 v79, 1.0, v79
    v_cvt_pk_bf16_f32 v80, v76, v77
    v_cvt_pk_bf16_f32 v81, v78, v79
    s_waitcnt vmcnt(1)
    v_add_f32 v88, v88, v92
    v_add_f32 v89, v89, v93
    v_add_f32 v90, v90, v94
    v_add_f32 v91, v91, v95
    s_waitcnt vmcnt(0)
    v_add_f32 v88, v88, v96
    v_add_f32 v89, v89, v97
    v_add_f32 v90, v90, v98
    v_add_f32 v91, v91, v99
    v_cvt_pk_bf16_f32 v92, v88, v89
    v_cvt_pk_bf16_f32 v93, v90, v91
    s_and_b64 exec, exec, vcc
    ds_write_b64 v9, v[68:69] offset:0
    ds_write_b64 v9, v[80:81] offset:1152
    ds_write_b64 v9, v[92:93] offset:2304
    s_mov_b64 exec, s[92:93]
    s_waitcnt lgkmcnt(0)
    s_barrier
    s_lshl_b32 s83, s30, 9
    s_add_u32 s83, s83, 82649088
    s_lshr_b32 s82, s29, 2
    v_and_b32 v28, 63, v0
    v_add_u32 v28, s82, v28
    v_and_b32 v28, 3, v28
    v_lshlrev_b32 v28, 7, v28
    s_mov_b32 s84, 0
    s_mov_b32 s85, 0
    s_mov_b32 s86, 0
    s_mov_b32 s87, 0
    s_mov_b32 s60, 0x00003f80
    s_mov_b32 s61, 0x3f800000
    s_cmp_ge_u32 s84, 0x4
    s_cbranch_scc1 mega_kernel_qb0d
    s_mov_b32 s91, 0
mega_kernel_qb0l:
    buffer_load_dword v29, v28, s[20:23], s83 offen sc1
    s_waitcnt vmcnt(0)
    v_readlane_b32 s84, v29, 0
    v_readlane_b32 s85, v29, 1
    v_readlane_b32 s86, v29, 2
    v_readlane_b32 s87, v29, 3
    s_add_u32 s91, s91, 1
    s_cmp_ge_u32 s84, 0x4
    s_cbranch_scc1 mega_kernel_qb0d
    s_cmp_lt_u32 s91, 400000
    s_cbranch_scc0 mega_kernel_qb0d
    s_sleep 1
    s_branch mega_kernel_qb0l
mega_kernel_qb0d:
    s_add_u32 s37, s82, 0
    s_and_b32 s37, s37, 3
    s_mul_i32 s37, s37, 9437184
    s_add_u32 s37, s37, s33
    s_add_u32 s36, s37, 7143424
    buffer_load_dwordx4 v[64:67], v6, s[20:23], s36 offen sc1
    s_add_u32 s36, s37, 7159808
    buffer_load_dwordx4 v[128:131], v6, s[20:23], s36 offen sc1
    s_add_u32 s36, s37, 7176192
    s_add_u32 s36, s36, s35
    buffer_load_dwordx4 v[192:195], v6, s[20:23], s36 offen sc1
    s_add_u32 s36, s37, 9502720
    buffer_load_dwordx4 v[68:71], v6, s[20:23], s36 offen sc1
    s_add_u32 s36, s37, 9519104
    buffer_load_dwordx4 v[132:135], v6, s[20:23], s36 offen sc1
    s_add_u32 s36, s37, 9535488
    s_add_u32 s36, s36, s35
    buffer_load_dwordx4 v[196:199], v6, s[20:23], s36 offen sc1
    s_add_u32 s36, s37, 11862016
    buffer_load_dwordx4 v[72:75], v6, s[20:23], s36 offen sc1
    s_add_u32 s36, s37, 11878400
    buffer_load_dwordx4 v[136:139], v6, s[20:23], s36 offen sc1
    s_add_u32 s36, s37, 11894784
    s_add_u32 s36, s36, s35
    buffer_load_dwordx4 v[200:203], v6, s[20:23], s36 offen sc1
    s_add_u32 s36, s37, 14221312
    buffer_load_dwordx4 v[76:79], v6, s[20:23], s36 offen sc1
    s_add_u32 s36, s37, 14237696
    buffer_load_dwordx4 v[140:143], v6, s[20:23], s36 offen sc1
    s_add_u32 s36, s37, 14254080
    s_add_u32 s36, s36, s35
    buffer_load_dwordx4 v[204:207], v6, s[20:23], s36 offen sc1
    s_cmp_ge_u32 s85, 0x4
    s_cbranch_scc1 mega_kernel_qb1d
    s_mov_b32 s91, 0
mega_kernel_qb1l:
    buffer_load_dword v29, v28, s[20:23], s83 offen sc1
    s_waitcnt vmcnt(0)
    v_readlane_b32 s85, v29, 1
    v_readlane_b32 s86, v29, 2
    v_readlane_b32 s87, v29, 3
    s_add_u32 s91, s91, 1
    s_cmp_ge_u32 s85, 0x4
    s_cbranch_scc1 mega_kernel_qb1d
    s_cmp_lt_u32 s91, 400000
    s_cbranch_scc0 mega_kernel_qb1d
    s_sleep 1
    s_branch mega_kernel_qb1l
mega_kernel_qb1d:
    s_add_u32 s37, s82, 1
    s_and_b32 s37, s37, 3
    s_mul_i32 s37, s37, 9437184
    s_add_u32 s37, s37, s33
    s_add_u32 s36, s37, 7143424
    buffer_load_dwordx4 v[80:83], v6, s[20:23], s36 offen sc1
    s_add_u32 s36, s37, 7159808
    buffer_load_dwordx4 v[144:147], v6, s[20:23], s36 offen sc1
    s_add_u32 s36, s37, 7176192
    s_add_u32 s36, s36, s35
    buffer_load_dwordx4 v[208:211], v6, s[20:23], s36 offen sc1
    s_add_u32 s36, s37, 9502720
    buffer_load_dwordx4 v[84:87], v6, s[20:23], s36 offen sc1
    s_add_u32 s36, s37, 9519104
    buffer_load_dwordx4 v[148:151], v6, s[20:23], s36 offen sc1
    s_add_u32 s36, s37, 9535488
    s_add_u32 s36, s36, s35
    buffer_load_dwordx4 v[212:215], v6, s[20:23], s36 offen sc1
    s_add_u32 s36, s37, 11862016
    buffer_load_dwordx4 v[88:91], v6, s[20:23], s36 offen sc1
    s_add_u32 s36, s37, 11878400
    buffer_load_dwordx4 v[152:155], v6, s[20:23], s36 offen sc1
    s_add_u32 s36, s37, 11894784
    s_add_u32 s36, s36, s35
    buffer_load_dwordx4 v[216:219], v6, s[20:23], s36 offen sc1
    s_add_u32 s36, s37, 14221312
    buffer_load_dwordx4 v[92:95], v6, s[20:23], s36 offen sc1
    s_add_u32 s36, s37, 14237696
    buffer_load_dwordx4 v[156:159], v6, s[20:23], s36 offen sc1
    s_add_u32 s36, s37, 14254080
    s_add_u32 s36, s36, s35
    buffer_load_dwordx4 v[220:223], v6, s[20:23], s36 offen sc1
    s_cmp_ge_u32 s86, 0x4
    s_cbranch_scc1 mega_kernel_qb2d
    s_mov_b32 s91, 0
mega_kernel_qb2l:
    buffer_load_dword v29, v28, s[20:23], s83 offen sc1
    s_waitcnt vmcnt(0)
    v_readlane_b32 s86, v29, 2
    v_readlane_b32 s87, v29, 3
    s_add_u32 s91, s91, 1
    s_cmp_ge_u32 s86, 0x4
    s_cbranch_scc1 mega_kernel_qb2d
    s_cmp_lt_u32 s91, 400000
    s_cbranch_scc0 mega_kernel_qb2d
    s_sleep 1
    s_branch mega_kernel_qb2l
mega_kernel_qb2d:
    s_add_u32 s37, s82, 2
    s_and_b32 s37, s37, 3
    s_mul_i32 s37, s37, 9437184
    s_add_u32 s37, s37, s33
    s_add_u32 s36, s37, 7143424
    buffer_load_dwordx4 v[96:99], v6, s[20:23], s36 offen sc1
    s_add_u32 s36, s37, 7159808
    buffer_load_dwordx4 v[160:163], v6, s[20:23], s36 offen sc1
    s_add_u32 s36, s37, 7176192
    s_add_u32 s36, s36, s35
    buffer_load_dwordx4 v[224:227], v6, s[20:23], s36 offen sc1
    s_add_u32 s36, s37, 9502720
    buffer_load_dwordx4 v[100:103], v6, s[20:23], s36 offen sc1
    s_add_u32 s36, s37, 9519104
    buffer_load_dwordx4 v[164:167], v6, s[20:23], s36 offen sc1
    s_add_u32 s36, s37, 9535488
    s_add_u32 s36, s36, s35
    buffer_load_dwordx4 v[228:231], v6, s[20:23], s36 offen sc1
    s_add_u32 s36, s37, 11862016
    buffer_load_dwordx4 v[104:107], v6, s[20:23], s36 offen sc1
    s_add_u32 s36, s37, 11878400
    buffer_load_dwordx4 v[168:171], v6, s[20:23], s36 offen sc1
    s_add_u32 s36, s37, 11894784
    s_add_u32 s36, s36, s35
    buffer_load_dwordx4 v[232:235], v6, s[20:23], s36 offen sc1
    s_add_u32 s36, s37, 14221312
    buffer_load_dwordx4 v[108:111], v6, s[20:23], s36 offen sc1
    s_add_u32 s36, s37, 14237696
    buffer_load_dwordx4 v[172:175], v6, s[20:23], s36 offen sc1
    s_add_u32 s36, s37, 14254080
    s_add_u32 s36, s36, s35
    buffer_load_dwordx4 v[236:239], v6, s[20:23], s36 offen sc1
    s_cmp_ge_u32 s87, 0x4
    s_cbranch_scc1 mega_kernel_qb3d
    s_mov_b32 s91, 0
mega_kernel_qb3l:
    buffer_load_dword v29, v28, s[20:23], s83 offen sc1
    s_waitcnt vmcnt(0)
    v_readlane_b32 s87, v29, 3
    s_add_u32 s91, s91, 1
    s_cmp_ge_u32 s87, 0x4
    s_cbranch_scc1 mega_kernel_qb3d
    s_cmp_lt_u32 s91, 400000
    s_cbranch_scc0 mega_kernel_qb3d
    s_sleep 1
    s_branch mega_kernel_qb3l
mega_kernel_qb3d:
    s_add_u32 s37, s82, 3
    s_and_b32 s37, s37, 3
    s_mul_i32 s37, s37, 9437184
    s_add_u32 s37, s37, s33
    s_add_u32 s36, s37, 7143424
    buffer_load_dwordx4 v[112:115], v6, s[20:23], s36 offen sc1
    s_add_u32 s36, s37, 7159808
    buffer_load_dwordx4 v[176:179], v6, s[20:23], s36 offen sc1
    s_add_u32 s36, s37, 7176192
    s_add_u32 s36, s36, s35
    buffer_load_dwordx4 v[240:243], v6, s[20:23], s36 offen sc1
    s_add_u32 s36, s37, 9502720
    buffer_load_dwordx4 v[116:119], v6, s[20:23], s36 offen sc1
    s_add_u32 s36, s37, 9519104
    buffer_load_dwordx4 v[180:183], v6, s[20:23], s36 offen sc1
    s_add_u32 s36, s37, 9535488
    s_add_u32 s36, s36, s35
    buffer_load_dwordx4 v[244:247], v6, s[20:23], s36 offen sc1
    s_add_u32 s36, s37, 11862016
    buffer_load_dwordx4 v[120:123], v6, s[20:23], s36 offen sc1
    s_add_u32 s36, s37, 11878400
    buffer_load_dwordx4 v[184:187], v6, s[20:23], s36 offen sc1
    s_add_u32 s36, s37, 11894784
    s_add_u32 s36, s36, s35
    buffer_load_dwordx4 v[248:251], v6, s[20:23], s36 offen sc1
    s_add_u32 s36, s37, 14221312
    buffer_load_dwordx4 v[124:127], v6, s[20:23], s36 offen sc1
    s_add_u32 s36, s37, 14237696
    buffer_load_dwordx4 v[188:191], v6, s[20:23], s36 offen sc1
    s_add_u32 s36, s37, 14254080
    s_add_u32 s36, s36, s35
    buffer_load_dwordx4 v[252:255], v6, s[20:23], s36 offen sc1
    s_waitcnt vmcnt(47)
    v_lshlrev_b32 v32, 16, v64
    v_and_b32 v33, 0xffff0000, v64
    v_lshlrev_b32 v34, 16, v65
    v_and_b32 v35, 0xffff0000, v65
    v_lshlrev_b32 v36, 16, v66
    v_and_b32 v37, 0xffff0000, v66
    v_lshlrev_b32 v38, 16, v67
    v_and_b32 v39, 0xffff0000, v67
    s_waitcnt vmcnt(46)
    v_lshlrev_b32 v40, 16, v128
    v_and_b32 v41, 0xffff0000, v128
    v_lshlrev_b32 v42, 16, v129
    v_and_b32 v43, 0xffff0000, v129
    v_lshlrev_b32 v44, 16, v130
    v_and_b32 v45, 0xffff0000, v130
    v_lshlrev_b32 v46, 16, v131
    v_and_b32 v47, 0xffff0000, v131
    s_waitcnt vmcnt(45)
    v_lshlrev_b32 v48, 16, v192
    v_and_b32 v49, 0xffff0000, v192
    v_lshlrev_b32 v50, 16, v193
    v_and_b32 v51, 0xffff0000, v193
    v_lshlrev_b32 v52, 16, v194
    v_and_b32 v53, 0xffff0000, v194
    v_lshlrev_b32 v54, 16, v195
    v_and_b32 v55, 0xffff0000, v195
    s_waitcnt vmcnt(44)
    v_dot2_f32_bf16 v32, v68, s60, v32
    v_dot2_f32_bf16 v33, v68, s61, v33
    v_dot2_f32_bf16 v34, v69, s60, v34
    v_dot2_f32_bf16 v35, v69, s61, v35
    v_dot2_f32_bf16 v36, v70, s60, v36
    v_dot2_f32_bf16 v37, v70, s61, v37
    v_dot2_f32_bf16 v38, v71, s60, v38
    v_dot2_f32_bf16 v39, v71, s61, v39
    s_waitcnt vmcnt(43)
    v_dot2_f32_bf16 v40, v132, s60, v40
    v_dot2_f32_bf16 v41, v132, s61, v41
    v_dot2_f32_bf16 v42, v133, s60, v42
    v_dot2_f32_bf16 v43, v133, s61, v43
    v_dot2_f32_bf16 v44, v134, s60, v44
    v_dot2_f32_bf16 v45, v134, s61, v45
    v_dot2_f32_bf16 v46, v135, s60, v46
    v_dot2_f32_bf16 v47, v135, s61, v47
    s_waitcnt vmcnt(42)
    v_dot2_f32_bf16 v48, v196, s60, v48
    v_dot2_f32_bf16 v49, v196, s61, v49
    v_dot2_f32_bf16 v50, v197, s60, v50
    v_dot2_f32_bf16 v51, v197, s61, v51
    v_dot2_f32_bf16 v52, v198, s60, v52
    v_dot2_f32_bf16 v53, v198, s61, v53
    v_dot2_f32_bf16 v54, v199, s60, v54
    v_dot2_f32_bf16 v55, v199, s61, v55
    s_waitcnt vmcnt(41)
    v_dot2_f32_bf16 v32, v72, s60, v32
    v_dot2_f32_bf16 v33, v72, s61, v33
    v_dot2_f32_bf16 v34, v73, s60, v34
    v_dot2_f32_bf16 v35, v73, s61, v35
    v_dot2_f32_bf16 v36, v74, s60, v36
    v_dot2_f32_bf16 v37, v74, s61, v37
    v_dot2_f32_bf16 v38, v75, s60, v38
    v_dot2_f32_bf16 v39, v75, s61, v39
    s_waitcnt vmcnt(40)
    v_dot2_f32_bf16 v40, v136, s60, v40
    v_dot2_f32_bf16 v41, v136, s61, v41
    v_dot2_f32_bf16 v42, v137, s60, v42
    v_dot2_f32_bf16 v43, v137, s61, v43
    v_dot2_f32_bf16 v44, v138, s60, v44
    v_dot2_f32_bf16 v45, v138, s61, v45
    v_dot2_f32_bf16 v46, v139, s60, v46
    v_dot2_f32_bf16 v47, v139, s61, v47
    s_waitcnt vmcnt(39)
    v_dot2_f32_bf16 v48, v200, s60, v48
    v_dot2_f32_bf16 v49, v200, s61, v49
    v_dot2_f32_bf16 v50, v201, s60, v50
    v_dot2_f32_bf16 v51, v201, s61, v51
    v_dot2_f32_bf16 v52, v202, s60, v52
    v_dot2_f32_bf16 v53, v202, s61, v53
    v_dot2_f32_bf16 v54, v203, s60, v54
    v_dot2_f32_bf16 v55, v203, s61, v55
    s_waitcnt vmcnt(38)
    v_dot2_f32_bf16 v32, v76, s60, v32
    v_dot2_f32_bf16 v33, v76, s61, v33
    v_dot2_f32_bf16 v34, v77, s60, v34
    v_dot2_f32_bf16 v35, v77, s61, v35
    v_dot2_f32_bf16 v36, v78, s60, v36
    v_dot2_f32_bf16 v37, v78, s61, v37
    v_dot2_f32_bf16 v38, v79, s60, v38
    v_dot2_f32_bf16 v39, v79, s61, v39
    s_waitcnt vmcnt(37)
    v_dot2_f32_bf16 v40, v140, s60, v40
    v_dot2_f32_bf16 v41, v140, s61, v41
    v_dot2_f32_bf16 v42, v141, s60, v42
    v_dot2_f32_bf16 v43, v141, s61, v43
    v_dot2_f32_bf16 v44, v142, s60, v44
    v_dot2_f32_bf16 v45, v142, s61, v45
    v_dot2_f32_bf16 v46, v143, s60, v46
    v_dot2_f32_bf16 v47, v143, s61, v47
    s_waitcnt vmcnt(36)
    v_dot2_f32_bf16 v48, v204, s60, v48
    v_dot2_f32_bf16 v49, v204, s61, v49
    v_dot2_f32_bf16 v50, v205, s60, v50
    v_dot2_f32_bf16 v51, v205, s61, v51
    v_dot2_f32_bf16 v52, v206, s60, v52
    v_dot2_f32_bf16 v53, v206, s61, v53
    v_dot2_f32_bf16 v54, v207, s60, v54
    v_dot2_f32_bf16 v55, v207, s61, v55
    s_waitcnt vmcnt(35)
    v_dot2_f32_bf16 v32, v80, s60, v32
    v_dot2_f32_bf16 v33, v80, s61, v33
    v_dot2_f32_bf16 v34, v81, s60, v34
    v_dot2_f32_bf16 v35, v81, s61, v35
    v_dot2_f32_bf16 v36, v82, s60, v36
    v_dot2_f32_bf16 v37, v82, s61, v37
    v_dot2_f32_bf16 v38, v83, s60, v38
    v_dot2_f32_bf16 v39, v83, s61, v39
    s_waitcnt vmcnt(34)
    v_dot2_f32_bf16 v40, v144, s60, v40
    v_dot2_f32_bf16 v41, v144, s61, v41
    v_dot2_f32_bf16 v42, v145, s60, v42
    v_dot2_f32_bf16 v43, v145, s61, v43
    v_dot2_f32_bf16 v44, v146, s60, v44
    v_dot2_f32_bf16 v45, v146, s61, v45
    v_dot2_f32_bf16 v46, v147, s60, v46
    v_dot2_f32_bf16 v47, v147, s61, v47
    s_waitcnt vmcnt(33)
    v_dot2_f32_bf16 v48, v208, s60, v48
    v_dot2_f32_bf16 v49, v208, s61, v49
    v_dot2_f32_bf16 v50, v209, s60, v50
    v_dot2_f32_bf16 v51, v209, s61, v51
    v_dot2_f32_bf16 v52, v210, s60, v52
    v_dot2_f32_bf16 v53, v210, s61, v53
    v_dot2_f32_bf16 v54, v211, s60, v54
    v_dot2_f32_bf16 v55, v211, s61, v55
    s_waitcnt vmcnt(32)
    v_dot2_f32_bf16 v32, v84, s60, v32
    v_dot2_f32_bf16 v33, v84, s61, v33
    v_dot2_f32_bf16 v34, v85, s60, v34
    v_dot2_f32_bf16 v35, v85, s61, v35
    v_dot2_f32_bf16 v36, v86, s60, v36
    v_dot2_f32_bf16 v37, v86, s61, v37
    v_dot2_f32_bf16 v38, v87, s60, v38
    v_dot2_f32_bf16 v39, v87, s61, v39
    s_waitcnt vmcnt(31)
    v_dot2_f32_bf16 v40, v148, s60, v40
    v_dot2_f32_bf16 v41, v148, s61, v41
    v_dot2_f32_bf16 v42, v149, s60, v42
    v_dot2_f32_bf16 v43, v149, s61, v43
    v_dot2_f32_bf16 v44, v150, s60, v44
    v_dot2_f32_bf16 v45, v150, s61, v45
    v_dot2_f32_bf16 v46, v151, s60, v46
    v_dot2_f32_bf16 v47, v151, s61, v47
    s_waitcnt vmcnt(30)
    v_dot2_f32_bf16 v48, v212, s60, v48
    v_dot2_f32_bf16 v49, v212, s61, v49
    v_dot2_f32_bf16 v50, v213, s60, v50
    v_dot2_f32_bf16 v51, v213, s61, v51
    v_dot2_f32_bf16 v52, v214, s60, v52
    v_dot2_f32_bf16 v53, v214, s61, v53
    v_dot2_f32_bf16 v54, v215, s60, v54
    v_dot2_f32_bf16 v55, v215, s61, v55
    s_waitcnt vmcnt(29)
    v_dot2_f32_bf16 v32, v88, s60, v32
    v_dot2_f32_bf16 v33, v88, s61, v33
    v_dot2_f32_bf16 v34, v89, s60, v34
    v_dot2_f32_bf16 v35, v89, s61, v35
    v_dot2_f32_bf16 v36, v90, s60, v36
    v_dot2_f32_bf16 v37, v90, s61, v37
    v_dot2_f32_bf16 v38, v91, s60, v38
    v_dot2_f32_bf16 v39, v91, s61, v39
    s_waitcnt vmcnt(28)
    v_dot2_f32_bf16 v40, v152, s60, v40
    v_dot2_f32_bf16 v41, v152, s61, v41
    v_dot2_f32_bf16 v42, v153, s60, v42
    v_dot2_f32_bf16 v43, v153, s61, v43
    v_dot2_f32_bf16 v44, v154, s60, v44
    v_dot2_f32_bf16 v45, v154, s61, v45
    v_dot2_f32_bf16 v46, v155, s60, v46
    v_dot2_f32_bf16 v47, v155, s61, v47
    s_waitcnt vmcnt(27)
    v_dot2_f32_bf16 v48, v216, s60, v48
    v_dot2_f32_bf16 v49, v216, s61, v49
    v_dot2_f32_bf16 v50, v217, s60, v50
    v_dot2_f32_bf16 v51, v217, s61, v51
    v_dot2_f32_bf16 v52, v218, s60, v52
    v_dot2_f32_bf16 v53, v218, s61, v53
    v_dot2_f32_bf16 v54, v219, s60, v54
    v_dot2_f32_bf16 v55, v219, s61, v55
    s_waitcnt vmcnt(26)
    v_dot2_f32_bf16 v32, v92, s60, v32
    v_dot2_f32_bf16 v33, v92, s61, v33
    v_dot2_f32_bf16 v34, v93, s60, v34
    v_dot2_f32_bf16 v35, v93, s61, v35
    v_dot2_f32_bf16 v36, v94, s60, v36
    v_dot2_f32_bf16 v37, v94, s61, v37
    v_dot2_f32_bf16 v38, v95, s60, v38
    v_dot2_f32_bf16 v39, v95, s61, v39
    s_waitcnt vmcnt(25)
    v_dot2_f32_bf16 v40, v156, s60, v40
    v_dot2_f32_bf16 v41, v156, s61, v41
    v_dot2_f32_bf16 v42, v157, s60, v42
    v_dot2_f32_bf16 v43, v157, s61, v43
    v_dot2_f32_bf16 v44, v158, s60, v44
    v_dot2_f32_bf16 v45, v158, s61, v45
    v_dot2_f32_bf16 v46, v159, s60, v46
    v_dot2_f32_bf16 v47, v159, s61, v47
    s_waitcnt vmcnt(24)
    v_dot2_f32_bf16 v48, v220, s60, v48
    v_dot2_f32_bf16 v49, v220, s61, v49
    v_dot2_f32_bf16 v50, v221, s60, v50
    v_dot2_f32_bf16 v51, v221, s61, v51
    v_dot2_f32_bf16 v52, v222, s60, v52
    v_dot2_f32_bf16 v53, v222, s61, v53
    v_dot2_f32_bf16 v54, v223, s60, v54
    v_dot2_f32_bf16 v55, v223, s61, v55
    s_waitcnt vmcnt(23)
    v_dot2_f32_bf16 v32, v96, s60, v32
    v_dot2_f32_bf16 v33, v96, s61, v33
    v_dot2_f32_bf16 v34, v97, s60, v34
    v_dot2_f32_bf16 v35, v97, s61, v35
    v_dot2_f32_bf16 v36, v98, s60, v36
    v_dot2_f32_bf16 v37, v98, s61, v37
    v_dot2_f32_bf16 v38, v99, s60, v38
    v_dot2_f32_bf16 v39, v99, s61, v39
    s_waitcnt vmcnt(22)
    v_dot2_f32_bf16 v40, v160, s60, v40
    v_dot2_f32_bf16 v41, v160, s61, v41
    v_dot2_f32_bf16 v42, v161, s60, v42
    v_dot2_f32_bf16 v43, v161, s61, v43
    v_dot2_f32_bf16 v44, v162, s60, v44
    v_dot2_f32_bf16 v45, v162, s61, v45
    v_dot2_f32_bf16 v46, v163, s60, v46
    v_dot2_f32_bf16 v47, v163, s61, v47
    s_waitcnt vmcnt(21)
    v_dot2_f32_bf16 v48, v224, s60, v48
    v_dot2_f32_bf16 v49, v224, s61, v49
    v_dot2_f32_bf16 v50, v225, s60, v50
    v_dot2_f32_bf16 v51, v225, s61, v51
    v_dot2_f32_bf16 v52, v226, s60, v52
    v_dot2_f32_bf16 v53, v226, s61, v53
    v_dot2_f32_bf16 v54, v227, s60, v54
    v_dot2_f32_bf16 v55, v227, s61, v55
    s_waitcnt vmcnt(20)
    v_dot2_f32_bf16 v32, v100, s60, v32
    v_dot2_f32_bf16 v33, v100, s61, v33
    v_dot2_f32_bf16 v34, v101, s60, v34
    v_dot2_f32_bf16 v35, v101, s61, v35
    v_dot2_f32_bf16 v36, v102, s60, v36
    v_dot2_f32_bf16 v37, v102, s61, v37
    v_dot2_f32_bf16 v38, v103, s60, v38
    v_dot2_f32_bf16 v39, v103, s61, v39
    s_waitcnt vmcnt(19)
    v_dot2_f32_bf16 v40, v164, s60, v40
    v_dot2_f32_bf16 v41, v164, s61, v41
    v_dot2_f32_bf16 v42, v165, s60, v42
    v_dot2_f32_bf16 v43, v165, s61, v43
    v_dot2_f32_bf16 v44, v166, s60, v44
    v_dot2_f32_bf16 v45, v166, s61, v45
    v_dot2_f32_bf16 v46, v167, s60, v46
    v_dot2_f32_bf16 v47, v167, s61, v47
    s_waitcnt vmcnt(18)
    v_dot2_f32_bf16 v48, v228, s60, v48
    v_dot2_f32_bf16 v49, v228, s61, v49
    v_dot2_f32_bf16 v50, v229, s60, v50
    v_dot2_f32_bf16 v51, v229, s61, v51
    v_dot2_f32_bf16 v52, v230, s60, v52
    v_dot2_f32_bf16 v53, v230, s61, v53
    v_dot2_f32_bf16 v54, v231, s60, v54
    v_dot2_f32_bf16 v55, v231, s61, v55
    s_waitcnt vmcnt(17)
    v_dot2_f32_bf16 v32, v104, s60, v32
    v_dot2_f32_bf16 v33, v104, s61, v33
    v_dot2_f32_bf16 v34, v105, s60, v34
    v_dot2_f32_bf16 v35, v105, s61, v35
    v_dot2_f32_bf16 v36, v106, s60, v36
    v_dot2_f32_bf16 v37, v106, s61, v37
    v_dot2_f32_bf16 v38, v107, s60, v38
    v_dot2_f32_bf16 v39, v107, s61, v39
    s_waitcnt vmcnt(16)
    v_dot2_f32_bf16 v40, v168, s60, v40
    v_dot2_f32_bf16 v41, v168, s61, v41
    v_dot2_f32_bf16 v42, v169, s60, v42
    v_dot2_f32_bf16 v43, v169, s61, v43
    v_dot2_f32_bf16 v44, v170, s60, v44
    v_dot2_f32_bf16 v45, v170, s61, v45
    v_dot2_f32_bf16 v46, v171, s60, v46
    v_dot2_f32_bf16 v47, v171, s61, v47
    s_waitcnt vmcnt(15)
    v_dot2_f32_bf16 v48, v232, s60, v48
    v_dot2_f32_bf16 v49, v232, s61, v49
    v_dot2_f32_bf16 v50, v233, s60, v50
    v_dot2_f32_bf16 v51, v233, s61, v51
    v_dot2_f32_bf16 v52, v234, s60, v52
    v_dot2_f32_bf16 v53, v234, s61, v53
    v_dot2_f32_bf16 v54, v235, s60, v54
    v_dot2_f32_bf16 v55, v235, s61, v55
    s_waitcnt vmcnt(14)
    v_dot2_f32_bf16 v32, v108, s60, v32
    v_dot2_f32_bf16 v33, v108, s61, v33
    v_dot2_f32_bf16 v34, v109, s60, v34
    v_dot2_f32_bf16 v35, v109, s61, v35
    v_dot2_f32_bf16 v36, v110, s60, v36
    v_dot2_f32_bf16 v37, v110, s61, v37
    v_dot2_f32_bf16 v38, v111, s60, v38
    v_dot2_f32_bf16 v39, v111, s61, v39
    s_waitcnt vmcnt(13)
    v_dot2_f32_bf16 v40, v172, s60, v40
    v_dot2_f32_bf16 v41, v172, s61, v41
    v_dot2_f32_bf16 v42, v173, s60, v42
    v_dot2_f32_bf16 v43, v173, s61, v43
    v_dot2_f32_bf16 v44, v174, s60, v44
    v_dot2_f32_bf16 v45, v174, s61, v45
    v_dot2_f32_bf16 v46, v175, s60, v46
    v_dot2_f32_bf16 v47, v175, s61, v47
    s_waitcnt vmcnt(12)
    v_dot2_f32_bf16 v48, v236, s60, v48
    v_dot2_f32_bf16 v49, v236, s61, v49
    v_dot2_f32_bf16 v50, v237, s60, v50
    v_dot2_f32_bf16 v51, v237, s61, v51
    v_dot2_f32_bf16 v52, v238, s60, v52
    v_dot2_f32_bf16 v53, v238, s61, v53
    v_dot2_f32_bf16 v54, v239, s60, v54
    v_dot2_f32_bf16 v55, v239, s61, v55
    s_waitcnt vmcnt(11)
    v_dot2_f32_bf16 v32, v112, s60, v32
    v_dot2_f32_bf16 v33, v112, s61, v33
    v_dot2_f32_bf16 v34, v113, s60, v34
    v_dot2_f32_bf16 v35, v113, s61, v35
    v_dot2_f32_bf16 v36, v114, s60, v36
    v_dot2_f32_bf16 v37, v114, s61, v37
    v_dot2_f32_bf16 v38, v115, s60, v38
    v_dot2_f32_bf16 v39, v115, s61, v39
    s_waitcnt vmcnt(10)
    v_dot2_f32_bf16 v40, v176, s60, v40
    v_dot2_f32_bf16 v41, v176, s61, v41
    v_dot2_f32_bf16 v42, v177, s60, v42
    v_dot2_f32_bf16 v43, v177, s61, v43
    v_dot2_f32_bf16 v44, v178, s60, v44
    v_dot2_f32_bf16 v45, v178, s61, v45
    v_dot2_f32_bf16 v46, v179, s60, v46
    v_dot2_f32_bf16 v47, v179, s61, v47
    s_waitcnt vmcnt(9)
    v_dot2_f32_bf16 v48, v240, s60, v48
    v_dot2_f32_bf16 v49, v240, s61, v49
    v_dot2_f32_bf16 v50, v241, s60, v50
    v_dot2_f32_bf16 v51, v241, s61, v51
    v_dot2_f32_bf16 v52, v242, s60, v52
    v_dot2_f32_bf16 v53, v242, s61, v53
    v_dot2_f32_bf16 v54, v243, s60, v54
    v_dot2_f32_bf16 v55, v243, s61, v55
    s_waitcnt vmcnt(8)
    v_dot2_f32_bf16 v32, v116, s60, v32
    v_dot2_f32_bf16 v33, v116, s61, v33
    v_dot2_f32_bf16 v34, v117, s60, v34
    v_dot2_f32_bf16 v35, v117, s61, v35
    v_dot2_f32_bf16 v36, v118, s60, v36
    v_dot2_f32_bf16 v37, v118, s61, v37
    v_dot2_f32_bf16 v38, v119, s60, v38
    v_dot2_f32_bf16 v39, v119, s61, v39
    s_waitcnt vmcnt(7)
    v_dot2_f32_bf16 v40, v180, s60, v40
    v_dot2_f32_bf16 v41, v180, s61, v41
    v_dot2_f32_bf16 v42, v181, s60, v42
    v_dot2_f32_bf16 v43, v181, s61, v43
    v_dot2_f32_bf16 v44, v182, s60, v44
    v_dot2_f32_bf16 v45, v182, s61, v45
    v_dot2_f32_bf16 v46, v183, s60, v46
    v_dot2_f32_bf16 v47, v183, s61, v47
    s_waitcnt vmcnt(6)
    v_dot2_f32_bf16 v48, v244, s60, v48
    v_dot2_f32_bf16 v49, v244, s61, v49
    v_dot2_f32_bf16 v50, v245, s60, v50
    v_dot2_f32_bf16 v51, v245, s61, v51
    v_dot2_f32_bf16 v52, v246, s60, v52
    v_dot2_f32_bf16 v53, v246, s61, v53
    v_dot2_f32_bf16 v54, v247, s60, v54
    v_dot2_f32_bf16 v55, v247, s61, v55
    s_waitcnt vmcnt(5)
    v_dot2_f32_bf16 v32, v120, s60, v32
    v_dot2_f32_bf16 v33, v120, s61, v33
    v_dot2_f32_bf16 v34, v121, s60, v34
    v_dot2_f32_bf16 v35, v121, s61, v35
    v_dot2_f32_bf16 v36, v122, s60, v36
    v_dot2_f32_bf16 v37, v122, s61, v37
    v_dot2_f32_bf16 v38, v123, s60, v38
    v_dot2_f32_bf16 v39, v123, s61, v39
    s_waitcnt vmcnt(4)
    v_dot2_f32_bf16 v40, v184, s60, v40
    v_dot2_f32_bf16 v41, v184, s61, v41
    v_dot2_f32_bf16 v42, v185, s60, v42
    v_dot2_f32_bf16 v43, v185, s61, v43
    v_dot2_f32_bf16 v44, v186, s60, v44
    v_dot2_f32_bf16 v45, v186, s61, v45
    v_dot2_f32_bf16 v46, v187, s60, v46
    v_dot2_f32_bf16 v47, v187, s61, v47
    s_waitcnt vmcnt(3)
    v_dot2_f32_bf16 v48, v248, s60, v48
    v_dot2_f32_bf16 v49, v248, s61, v49
    v_dot2_f32_bf16 v50, v249, s60, v50
    v_dot2_f32_bf16 v51, v249, s61, v51
    v_dot2_f32_bf16 v52, v250, s60, v52
    v_dot2_f32_bf16 v53, v250, s61, v53
    v_dot2_f32_bf16 v54, v251, s60, v54
    v_dot2_f32_bf16 v55, v251, s61, v55
    s_waitcnt vmcnt(2)
    v_dot2_f32_bf16 v32, v124, s60, v32
    v_dot2_f32_bf16 v33, v124, s61, v33
    v_dot2_f32_bf16 v34, v125, s60, v34
    v_dot2_f32_bf16 v35, v125, s61, v35
    v_dot2_f32_bf16 v36, v126, s60, v36
    v_dot2_f32_bf16 v37, v126, s61, v37
    v_dot2_f32_bf16 v38, v127, s60, v38
    v_dot2_f32_bf16 v39, v127, s61, v39
    s_waitcnt vmcnt(1)
    v_dot2_f32_bf16 v40, v188, s60, v40
    v_dot2_f32_bf16 v41, v188, s61, v41
    v_dot2_f32_bf16 v42, v189, s60, v42
    v_dot2_f32_bf16 v43, v189, s61, v43
    v_dot2_f32_bf16 v44, v190, s60, v44
    v_dot2_f32_bf16 v45, v190, s61, v45
    v_dot2_f32_bf16 v46, v191, s60, v46
    v_dot2_f32_bf16 v47, v191, s61, v47
    s_waitcnt vmcnt(0)
    v_dot2_f32_bf16 v48, v252, s60, v48
    v_dot2_f32_bf16 v49, v252, s61, v49
    v_dot2_f32_bf16 v50, v253, s60, v50
    v_dot2_f32_bf16 v51, v253, s61, v51
    v_dot2_f32_bf16 v52, v254, s60, v52
    v_dot2_f32_bf16 v53, v254, s61, v53
    v_dot2_f32_bf16 v54, v255, s60, v54
    v_dot2_f32_bf16 v55, v255, s61, v55
    ds_read_b128 v[8:11], v4 offset:0
    s_waitcnt lgkmcnt(0)
    v_lshlrev_b32 v16, 16, v8
    v_and_b32 v17, 0xffff0000, v8
    v_lshlrev_b32 v18, 16, v9
    v_and_b32 v19, 0xffff0000, v9
    v_lshlrev_b32 v20, 16, v10
    v_and_b32 v21, 0xffff0000, v10
    v_lshlrev_b32 v22, 16, v11
    v_and_b32 v23, 0xffff0000, v11
    v_accvgpr_read_b32 v8, a200
    v_accvgpr_read_b32 v9, a201
    v_accvgpr_read_b32 v10, a202
    v_accvgpr_read_b32 v11, a203
    v_lshlrev_b32 v24, 16, v8
    v_and_b32 v25, 0xffff0000, v8
    v_lshlrev_b32 v26, 16, v9
    v_and_b32 v27, 0xffff0000, v9
    v_lshlrev_b32 v28, 16, v10
    v_and_b32 v29, 0xffff0000, v10
    v_lshlrev_b32 v30, 16, v11
    v_and_b32 v31, 0xffff0000, v11
    v_fma_f32 v32, v32, v16, v24
    v_fma_f32 v33, v33, v17, v25
    v_fma_f32 v34, v34, v18, v26
    v_fma_f32 v35, v35, v19, v27
    v_fma_f32 v36, v36, v20, v28
    v_fma_f32 v37, v37, v21, v29
    v_fma_f32 v38, v38, v22, v30
    v_fma_f32 v39, v39, v23, v31
    v_cvt_pk_bf16_f32 v8, v32, v33
    v_cvt_pk_bf16_f32 v9, v34, v35
    v_cvt_pk_bf16_f32 v10, v36, v37
    v_cvt_pk_bf16_f32 v11, v38, v39
    v_accvgpr_write_b32 a160, v8
    v_accvgpr_write_b32 a161, v9
    v_accvgpr_write_b32 a162, v10
    v_accvgpr_write_b32 a163, v11
    v_lshlrev_b32 v32, 16, v8
    v_and_b32 v33, 0xffff0000, v8
    v_lshlrev_b32 v34, 16, v9
    v_and_b32 v35, 0xffff0000, v9
    v_lshlrev_b32 v36, 16, v10
    v_and_b32 v37, 0xffff0000, v10
    v_lshlrev_b32 v38, 16, v11
    v_and_b32 v39, 0xffff0000, v11
    ds_read_b128 v[8:11], v4 offset:512
    s_waitcnt lgkmcnt(0)
    v_lshlrev_b32 v16, 16, v8
    v_and_b32 v17, 0xffff0000, v8
    v_lshlrev_b32 v18, 16, v9
    v_and_b32 v19, 0xffff0000, v9
    v_lshlrev_b32 v20, 16, v10
    v_and_b32 v21, 0xffff0000, v10
    v_lshlrev_b32 v22, 16, v11
    v_and_b32 v23, 0xffff0000, v11
    v_accvgpr_read_b32 v8, a204
    v_accvgpr_read_b32 v9, a205
    v_accvgpr_read_b32 v10, a206
    v_accvgpr_read_b32 v11, a207
    v_lshlrev_b32 v24, 16, v8
    v_and_b32 v25, 0xffff0000, v8
    v_lshlrev_b32 v26, 16, v9
    v_and_b32 v27, 0xffff0000, v9
    v_lshlrev_b32 v28, 16, v10
    v_and_b32 v29, 0xffff0000, v10
    v_lshlrev_b32 v30, 16, v11
    v_and_b32 v31, 0xffff0000, v11
    v_fma_f32 v40, v40, v16, v24
    v_fma_f32 v41, v41, v17, v25
    v_fma_f32 v42, v42, v18, v26
    v_fma_f32 v43, v43, v19, v27
    v_fma_f32 v44, v44, v20, v28
    v_fma_f32 v45, v45, v21, v29
    v_fma_f32 v46, v46, v22, v30
    v_fma_f32 v47, v47, v23, v31
    v_cvt_pk_bf16_f32 v8, v40, v41
    v_cvt_pk_bf16_f32 v9, v42, v43
    v_cvt_pk_bf16_f32 v10, v44, v45
    v_cvt_pk_bf16_f32 v11, v46, v47
    v_accvgpr_write_b32 a164, v8
    v_accvgpr_write_b32 a165, v9
    v_accvgpr_write_b32 a166, v10
    v_accvgpr_write_b32 a167, v11
    v_lshlrev_b32 v40, 16, v8
    v_and_b32 v41, 0xffff0000, v8
    v_lshlrev_b32 v42, 16, v9
    v_and_b32 v43, 0xffff0000, v9
    v_lshlrev_b32 v44, 16, v10
    v_and_b32 v45, 0xffff0000, v10
    v_lshlrev_b32 v46, 16, v11
    v_and_b32 v47, 0xffff0000, v11
    ds_read_b128 v[8:11], v3 offset:0
    s_waitcnt lgkmcnt(0)
    v_lshlrev_b32 v16, 16, v8
    v_and_b32 v17, 0xffff0000, v8
    v_lshlrev_b32 v18, 16, v9
    v_and_b32 v19, 0xffff0000, v9
    v_lshlrev_b32 v20, 16, v10
    v_and_b32 v21, 0xffff0000, v10
    v_lshlrev_b32 v22, 16, v11
    v_and_b32 v23, 0xffff0000, v11
    v_accvgpr_read_b32 v8, a208
    v_accvgpr_read_b32 v9, a209
    v_accvgpr_read_b32 v10, a210
    v_accvgpr_read_b32 v11, a211
    v_lshlrev_b32 v24, 16, v8
    v_and_b32 v25, 0xffff0000, v8
    v_lshlrev_b32 v26, 16, v9
    v_and_b32 v27, 0xffff0000, v9
    v_lshlrev_b32 v28, 16, v10
    v_and_b32 v29, 0xffff0000, v10
    v_lshlrev_b32 v30, 16, v11
    v_and_b32 v31, 0xffff0000, v11
    v_fma_f32 v48, v48, v16, v24
    v_fma_f32 v49, v49, v17, v25
    v_fma_f32 v50, v50, v18, v26
    v_fma_f32 v51, v51, v19, v27
    v_fma_f32 v52, v52, v20, v28
    v_fma_f32 v53, v53, v21, v29
    v_fma_f32 v54, v54, v22, v30
    v_fma_f32 v55, v55, v23, v31
    v_cvt_pk_bf16_f32 v8, v48, v49
    v_cvt_pk_bf16_f32 v9, v50, v51
    v_cvt_pk_bf16_f32 v10, v52, v53
    v_cvt_pk_bf16_f32 v11, v54, v55
    v_accvgpr_write_b32 a168, v8
    v_accvgpr_write_b32 a169, v9
    v_accvgpr_write_b32 a170, v10
    v_accvgpr_write_b32 a171, v11
    v_lshlrev_b32 v48, 16, v8
    v_and_b32 v49, 0xffff0000, v8
    v_lshlrev_b32 v50, 16, v9
    v_and_b32 v51, 0xffff0000, v9
    v_lshlrev_b32 v52, 16, v10
    v_and_b32 v53, 0xffff0000, v10
    v_lshlrev_b32 v54, 16, v11
    v_and_b32 v55, 0xffff0000, v11
    s_cmp_eq_u32 s28, 0
    s_cselect_b32 s37, 1.0, 0
    v_mov_b32 v24, 0
    v_add_f32 v24, v24, v32
    v_add_f32 v24, v24, v33
    v_add_f32 v24, v24, v34
    v_add_f32 v24, v24, v35
    v_add_f32 v24, v24, v36
    v_add_f32 v24, v24, v37
    v_add_f32 v24, v24, v38
    v_add_f32 v24, v24, v39
    v_add_f32 v24, v24, v40
    v_add_f32 v24, v24, v41
    v_add_f32 v24, v24, v42
    v_add_f32 v24, v24, v43
    v_add_f32 v24, v24, v44
    v_add_f32 v24, v24, v45
    v_add_f32 v24, v24, v46
    v_add_f32 v24, v24, v47
    v_add_f32 v24, v24, v48
    v_add_f32 v24, v24, v49
    v_add_f32 v24, v24, v50
    v_add_f32 v24, v24, v51
    v_add_f32 v24, v24, v52
    v_add_f32 v24, v24, v53
    v_add_f32 v24, v24, v54
    v_add_f32 v24, v24, v55
    s_nop 1
    v_add_f32_dpp v24, v24, v24 row_ror:8 row_mask:0xf bank_mask:0xf
    v_mov_b32 v25, v24
    s_nop 1
    v_permlane16_swap_b32 v25, v24
    v_add_f32 v24, v24, v25
    v_mov_b32 v25, v24
    s_nop 1
    v_permlane32_swap_b32 v25, v24
    v_add_f32 v24, v24, v25
    v_lshlrev_b32 v25, 2, v1
    v_add_u32 v25, 159744, v25
    s_lshl_b32 s36, s28, 5
    v_add_u32 v26, s36, v25
    ds_write_b32 v26, v24
    s_waitcnt lgkmcnt(0)
    s_barrier
    ds_read_b32 v26, v25 offset:0
    ds_read_b32 v27, v25 offset:32
    ds_read_b32 v28, v25 offset:64
    ds_read_b32 v29, v25 offset:96
    s_waitcnt lgkmcnt(2)
    v_add_f32 v26, v26, v27
    s_waitcnt lgkmcnt(0)
    v_add_f32 v28, v28, v29
    v_add_f32 v30, v26, v28
    v_mul_f32 v30, 0x3ae38e39, v30
    v_mov_b32 v24, 0
    v_sub_f32 v32, v32, v30
    v_sub_f32 v33, v33, v30
    v_sub_f32 v34, v34, v30
    v_sub_f32 v35, v35, v30
    v_sub_f32 v36, v36, v30
    v_sub_f32 v37, v37, v30
    v_sub_f32 v38, v38, v30
    v_sub_f32 v39, v39, v30
    v_fmac_f32 v24, v32, v32
    v_fmac_f32 v24, v33, v33
    v_fmac_f32 v24, v34, v34
    v_fmac_f32 v24, v35, v35
    v_fmac_f32 v24, v36, v36
    v_fmac_f32 v24, v37, v37
    v_fmac_f32 v24, v38, v38
    v_fmac_f32 v24, v39, v39
    v_sub_f32 v40, v40, v30
    v_sub_f32 v41, v41, v30
    v_sub_f32 v42, v42, v30
    v_sub_f32 v43, v43, v30
    v_sub_f32 v44, v44, v30
    v_sub_f32 v45, v45, v30
    v_sub_f32 v46, v46, v30
    v_sub_f32 v47, v47, v30
    v_fmac_f32 v24, v40, v40
    v_fmac_f32 v24, v41, v41
    v_fmac_f32 v24, v42, v42
    v_fmac_f32 v24, v43, v43
    v_fmac_f32 v24, v44, v44
    v_fmac_f32 v24, v45, v45
    v_fmac_f32 v24, v46, v46
    v_fmac_f32 v24, v47, v47
    v_sub_f32 v48, v48, v30
    v_sub_f32 v49, v49, v30
    v_sub_f32 v50, v50, v30
    v_sub_f32 v51, v51, v30
    v_sub_f32 v52, v52, v30
    v_sub_f32 v53, v53, v30
    v_sub_f32 v54, v54, v30
    v_sub_f32 v55, v55, v30
    v_mul_f32 v48, s37, v48
    v_mul_f32 v49, s37, v49
    v_mul_f32 v50, s37, v50
    v_mul_f32 v51, s37, v51
    v_mul_f32 v52, s37, v52
    v_mul_f32 v53, s37, v53
    v_mul_f32 v54, s37, v54
    v_mul_f32 v55, s37, v55
    v_fmac_f32 v24, v48, v48
    v_fmac_f32 v24, v49, v49
    v_fmac_f32 v24, v50, v50
    v_fmac_f32 v24, v51, v51
    v_fmac_f32 v24, v52, v52
    v_fmac_f32 v24, v53, v53
    v_fmac_f32 v24, v54, v54
    v_fmac_f32 v24, v55, v55
    s_nop 1
    v_add_f32_dpp v24, v24, v24 row_ror:8 row_mask:0xf bank_mask:0xf
    v_mov_b32 v25, v24
    s_nop 1
    v_permlane16_swap_b32 v25, v24
    v_add_f32 v24, v24, v25
    v_mov_b32 v25, v24
    s_nop 1
    v_permlane32_swap_b32 v25, v24
    v_add_f32 v24, v24, v25
    v_lshlrev_b32 v25, 2, v1
    v_add_u32 v25, 160000, v25
    s_lshl_b32 s36, s28, 5
    v_add_u32 v26, s36, v25
    ds_write_b32 v26, v24
    s_waitcnt lgkmcnt(0)
    s_barrier
    ds_read_b32 v26, v25 offset:0
    ds_read_b32 v27, v25 offset:32
    ds_read_b32 v28, v25 offset:64
    ds_read_b32 v29, v25 offset:96
    s_waitcnt lgkmcnt(2)
    v_add_f32 v26, v26, v27
    s_waitcnt lgkmcnt(0)
    v_add_f32 v28, v28, v29
    v_add_f32 v31, v26, v28
    v_mov_b32 v25, 0x3727c5ac
    v_fmac_f32 v25, 0x3ae38e39, v31
    v_rsq_f32 v31, v25
    ds_read_b128 v[8:11], v4 offset:1152
    ds_read_b128 v[12:15], v4 offset:2304
    s_waitcnt lgkmcnt(1)
    v_lshlrev_b32 v16, 16, v8
    v_and_b32 v17, 0xffff0000, v8
    v_lshlrev_b32 v18, 16, v9
    v_and_b32 v19, 0xffff0000, v9
    v_lshlrev_b32 v20, 16, v10
    v_and_b32 v21, 0xffff0000, v10
    v_lshlrev_b32 v22, 16, v11
    v_and_b32 v23, 0xffff0000, v11
    s_waitcnt lgkmcnt(0)
    v_lshlrev_b32 v56, 16, v12
    v_and_b32 v57, 0xffff0000, v12
    v_lshlrev_b32 v58, 16, v13
    v_and_b32 v59, 0xffff0000, v13
    v_lshlrev_b32 v60, 16, v14
    v_and_b32 v61, 0xffff0000, v14
    v_lshlrev_b32 v62, 16, v15
    v_and_b32 v63, 0xffff0000, v15
    v_mul_f32 v32, v32, v31
    v_mul_f32 v33, v33, v31
    v_mul_f32 v34, v34, v31
    v_mul_f32 v35, v35, v31
    v_mul_f32 v36, v36, v31
    v_mul_f32 v37, v37, v31
    v_mul_f32 v38, v38, v31
    v_mul_f32 v39, v39, v31
    v_fma_f32 v32, v32, v16, v56
    v_fma_f32 v33, v33, v17, v57
    v_fma_f32 v34, v34, v18, v58
    v_fma_f32 v35, v35, v19, v59
    v_fma_f32 v36, v36, v20, v60
    v_fma_f32 v37, v37, v21, v61
    v_fma_f32 v38, v38, v22, v62
    v_fma_f32 v39, v39, v23, v63
    v_cvt_pk_bf16_f32 v8, v32, v33
    v_cvt_pk_bf16_f32 v9, v34, v35
    v_cvt_pk_bf16_f32 v10, v36, v37
    v_cvt_pk_bf16_f32 v11, v38, v39
    s_add_u32 s36, s33, 4784128
    buffer_store_dwordx4 v[8:11], v6, s[20:23], s36 offen sc1
    s_nop 1
    ds_read_b128 v[8:11], v4 offset:1664
    ds_read_b128 v[12:15], v4 offset:2816
    s_waitcnt lgkmcnt(1)
    v_lshlrev_b32 v16, 16, v8
    v_and_b32 v17, 0xffff0000, v8
    v_lshlrev_b32 v18, 16, v9
    v_and_b32 v19, 0xffff0000, v9
    v_lshlrev_b32 v20, 16, v10
    v_and_b32 v21, 0xffff0000, v10
    v_lshlrev_b32 v22, 16, v11
    v_and_b32 v23, 0xffff0000, v11
    s_waitcnt lgkmcnt(0)
    v_lshlrev_b32 v56, 16, v12
    v_and_b32 v57, 0xffff0000, v12
    v_lshlrev_b32 v58, 16, v13
    v_and_b32 v59, 0xffff0000, v13
    v_lshlrev_b32 v60, 16, v14
    v_and_b32 v61, 0xffff0000, v14
    v_lshlrev_b32 v62, 16, v15
    v_and_b32 v63, 0xffff0000, v15
    v_mul_f32 v40, v40, v31
    v_mul_f32 v41, v41, v31
    v_mul_f32 v42, v42, v31
    v_mul_f32 v43, v43, v31
    v_mul_f32 v44, v44, v31
    v_mul_f32 v45, v45, v31
    v_mul_f32 v46, v46, v31
    v_mul_f32 v47, v47, v31
    v_fma_f32 v40, v40, v16, v56
    v_fma_f32 v41, v41, v17, v57
    v_fma_f32 v42, v42, v18, v58
    v_fma_f32 v43, v43, v19, v59
    v_fma_f32 v44, v44, v20, v60
    v_fma_f32 v45, v45, v21, v61
    v_fma_f32 v46, v46, v22, v62
    v_fma_f32 v47, v47, v23, v63
    v_cvt_pk_bf16_f32 v8, v40, v41
    v_cvt_pk_bf16_f32 v9, v42, v43
    v_cvt_pk_bf16_f32 v10, v44, v45
    v_cvt_pk_bf16_f32 v11, v46, v47
    s_add_u32 s36, s33, 4800512
    buffer_store_dwordx4 v[8:11], v6, s[20:23], s36 offen sc1
    s_nop 1
    ds_read_b128 v[8:11], v3 offset:1152
    ds_read_b128 v[12:15], v3 offset:2304
    s_waitcnt lgkmcnt(1)
    v_lshlrev_b32 v16, 16, v8
    v_and_b32 v17, 0xffff0000, v8
    v_lshlrev_b32 v18, 16, v9
    v_and_b32 v19, 0xffff0000, v9
    v_lshlrev_b32 v20, 16, v10
    v_and_b32 v21, 0xffff0000, v10
    v_lshlrev_b32 v22, 16, v11
    v_and_b32 v23, 0xffff0000, v11
    s_waitcnt lgkmcnt(0)
    v_lshlrev_b32 v56, 16, v12
    v_and_b32 v57, 0xffff0000, v12
    v_lshlrev_b32 v58, 16, v13
    v_and_b32 v59, 0xffff0000, v13
    v_lshlrev_b32 v60, 16, v14
    v_and_b32 v61, 0xffff0000, v14
    v_lshlrev_b32 v62, 16, v15
    v_and_b32 v63, 0xffff0000, v15
    v_mul_f32 v48, v48, v31
    v_mul_f32 v49, v49, v31
    v_mul_f32 v50, v50, v31
    v_mul_f32 v51, v51, v31
    v_mul_f32 v52, v52, v31
    v_mul_f32 v53, v53, v31
    v_mul_f32 v54, v54, v31
    v_mul_f32 v55, v55, v31
    v_fma_f32 v48, v48, v16, v56
    v_fma_f32 v49, v49, v17, v57
    v_fma_f32 v50, v50, v18, v58
    v_fma_f32 v51, v51, v19, v59
    v_fma_f32 v52, v52, v20, v60
    v_fma_f32 v53, v53, v21, v61
    v_fma_f32 v54, v54, v22, v62
    v_fma_f32 v55, v55, v23, v63
    v_cvt_pk_bf16_f32 v8, v48, v49
    v_cvt_pk_bf16_f32 v9, v50, v51
    v_cvt_pk_bf16_f32 v10, v52, v53
    v_cvt_pk_bf16_f32 v11, v54, v55
    s_add_u32 s36, s33, 4816896
    s_add_u32 s36, s36, s35
    buffer_store_dwordx4 v[8:11], v6, s[20:23], s36 offen sc1
    s_waitcnt vmcnt(0)
    s_barrier
    s_cmp_lg_u32 s28, 0
    s_cbranch_scc1 mega_kernel_sigcs
    s_lshl_b32 s90, s30, 9
    s_lshr_b32 s91, s29, 2
    s_lshl_b32 s91, s91, 7
    s_add_u32 s90, s90, s91
    s_add_u32 s90, s90, 82657280
    s_mov_b64 s[92:93], exec
    s_mov_b64 exec, 1
    v_mov_b32 v250, 1
    v_mov_b32 v251, 0
    buffer_atomic_add v250, v251, s[20:23], s90 offen
    s_mov_b64 exec, s[92:93]
mega_kernel_sigcs:
    s_load_dwordx4 s[4:7], s[0:1], 48
    s_load_dwordx2 s[16:17], s[0:1], 64
    s_load_dwordx2 s[20:21], s[0:1], 104
    v_and_b32 v1, 63, v0
    v_lshrrev_b32 v2, 6, v0
    s_nop 0
    v_readfirstlane_b32 s28, v2
    s_and_b32 s29, s2, 3
    s_lshl_b32 s29, s29, 2
    s_bfe_u32 s30, s2, 0x20003
    s_or_b32 s29, s29, s30
    s_bfe_u32 s30, s2, 0x10002
    s_lshl_b32 s30, s30, 3
    s_lshr_b32 s38, s2, 5
    s_or_b32 s30, s30, s38
    s_lshl_b32 s31, s30, 2
    s_add_u32 s31, s31, s28
    s_mul_i32 s32, s28, 9216
    s_mul_i32 s36, s29, 288
    s_and_b32 s38, s29, 1
    s_cmp_eq_u32 s38, 0
    s_cselect_b32 s38, 0, 32
    s_cselect_b32 s37, 256, 0
    s_add_u32 s37, s37, s36
    s_add_u32 s36, s36, s38
    s_lshl_b32 s33, s36, 1
    s_lshl_b32 s34, s37, 1
    s_mov_b32 s39, 0xbfb8aa3b
    v_lshrrev_b32 v2, 2, v1
    s_mov_b32 s38, 9216
    v_mul_lo_u32 v16, v2, s38
    v_and_b32 v2, 3, v1
    v_lshlrev_b32 v2, 4, v2
    v_add_u32 v16, v16, v2
    s_mul_i32 s38, s28, 1327104
    v_add_u32 v16, s38, v16
    s_waitcnt lgkmcnt(0)
    s_mov_b32 s8, s4
    s_mov_b32 s9, s5
    s_mov_b32 s10, 0x510000
    s_mov_b32 s11, 0x20000
    s_mov_b32 s12, s6
    s_mov_b32 s13, s7
    s_mov_b32 s14, 0x510000
    s_mov_b32 s15, 0x20000
    s_mov_b32 s18, 0x510000
    s_mov_b32 s19, 0x20000
    s_mov_b32 s22, 0x4ed8000
    s_mov_b32 s23, 0x20000
    s_mov_b32 s24, s4
    s_mov_b32 s25, s5
    s_mov_b32 s26, 0x510000
    s_mov_b32 s27, 0x20000
    v_lshrrev_b32 v2, 5, v1
    v_lshlrev_b32 v2, 3, v2
    v_bfe_u32 v3, v1, 2, 2
    v_add_u32 v2, v2, v3
    v_lshlrev_b32 v10, 7, v2
    v_lshrrev_b32 v3, 1, v3
    v_lshlrev_b32 v3, 6, v3
    v_add_u32 v10, v10, v3
    v_bfe_u32 v2, v1, 4, 1
    v_lshlrev_b32 v2, 5, v2
    v_and_b32 v3, 1, v1
    v_lshlrev_b32 v3, 4, v3
    v_add_u32 v2, v2, v3
    v_bfe_u32 v3, v1, 1, 1
    v_lshlrev_b32 v3, 3, v3
    v_add_u32 v2, v2, v3
    v_add_u32 v10, v10, v2
    v_xor_b32 v11, 64, v10
    v_lshrrev_b32 v2, 5, v1
    v_lshlrev_b32 v2, 3, v2
    v_bfe_u32 v3, v1, 2, 2
    v_add_u32 v2, v2, v3
    v_lshlrev_b32 v12, 6, v2
    v_bfe_u32 v2, v1, 4, 1
    v_lshlrev_b32 v2, 5, v2
    v_and_b32 v3, 1, v1
    v_lshlrev_b32 v3, 4, v3
    v_add_u32 v2, v2, v3
    v_bfe_u32 v3, v1, 1, 1
    v_lshlrev_b32 v3, 3, v3
    v_add_u32 v2, v2, v3
    v_add_u32 v12, v12, v2
    v_lshrrev_b32 v2, 3, v1
    s_mov_b32 s38, 9216
    v_mul_lo_u32 v15, v2, s38
    v_bfe_u32 v2, v1, 4, 1
    v_lshlrev_b32 v2, 2, v2
    v_and_b32 v3, 7, v1
    v_xor_b32 v2, v2, v3
    v_lshlrev_b32 v2, 4, v2
    v_add_u32 v15, v15, v2
    s_mul_i32 s38, s28, 663552
    v_add_u32 v15, s38, v15
    v_lshrrev_b32 v2, 3, v1
    s_mov_b32 s38, 1152
    v_mul_lo_u32 v17, v2, s38
    v_bfe_u32 v2, v1, 4, 1
    v_lshlrev_b32 v2, 2, v2
    v_and_b32 v3, 7, v1
    v_xor_b32 v2, v2, v3
    v_lshlrev_b32 v2, 4, v2
    v_add_u32 v17, v17, v2
    s_mul_i32 s38, s28, 0
    v_add_u32 v17, s38, v17
    v_mov_b32 v9, v15
    s_mov_b32 s40, 0
    s_mov_b32 s60, 0
    s_mov_b32 s41, 72704
    s_mov_b32 s61, 72704
    s_mov_b32 s42, 145408
    s_mov_b32 s62, 145408
    s_mov_b32 s43, 218112
    s_mov_b32 s63, 218112
    s_mov_b32 s44, 294912
    s_mov_b32 s64, 294912
    s_mov_b32 s45, 367616
    s_mov_b32 s65, 367616
    s_mov_b32 s46, 440320
    s_mov_b32 s66, 440320
    s_mov_b32 s47, 513024
    s_mov_b32 s67, 513024
    s_mov_b32 s48, 589824
    s_mov_b32 s68, 589824
    s_mul_i32 s69, s28, 72
    s_sub_u32 s70, s36, 32
    s_add_u32 s71, s69, 0
    s_cmp_lt_u32 s71, 32
    s_cselect_b32 s72, s37, s70
    s_add_u32 s71, s71, s72
    s_mul_i32 s71, s71, 1152
    s_sub_u32 s50, s71, 0
    s_add_u32 s71, s69, 8
    s_cmp_lt_u32 s71, 32
    s_cselect_b32 s72, s37, s70
    s_add_u32 s71, s71, s72
    s_mul_i32 s71, s71, 1152
    s_sub_u32 s51, s71, 1024
    s_add_u32 s71, s69, 16
    s_cmp_lt_u32 s71, 32
    s_cselect_b32 s72, s37, s70
    s_add_u32 s71, s71, s72
    s_mul_i32 s71, s71, 1152
    s_sub_u32 s52, s71, 2048
    s_add_u32 s71, s69, 24
    s_cmp_lt_u32 s71, 32
    s_cselect_b32 s72, s37, s70
    s_add_u32 s71, s71, s72
    s_mul_i32 s71, s71, 1152
    s_sub_u32 s53, s71, 3072
    s_add_u32 s71, s69, 32
    s_cmp_lt_u32 s71, 32
    s_cselect_b32 s72, s37, s70
    s_add_u32 s71, s71, s72
    s_mul_i32 s71, s71, 1152
    s_sub_u32 s54, s71, 0
    s_add_u32 s71, s69, 40
    s_cmp_lt_u32 s71, 32
    s_cselect_b32 s72, s37, s70
    s_add_u32 s71, s71, s72
    s_mul_i32 s71, s71, 1152
    s_sub_u32 s55, s71, 1024
    s_add_u32 s71, s69, 48
    s_cmp_lt_u32 s71, 32
    s_cselect_b32 s72, s37, s70
    s_add_u32 s71, s71, s72
    s_mul_i32 s71, s71, 1152
    s_sub_u32 s56, s71, 2048
    s_add_u32 s71, s69, 56
    s_cmp_lt_u32 s71, 32
    s_cselect_b32 s72, s37, s70
    s_add_u32 s71, s71, s72
    s_mul_i32 s71, s71, 1152
    s_sub_u32 s57, s71, 3072
    s_add_u32 s71, s69, 64
    s_cmp_lt_u32 s71, 32
    s_cselect_b32 s72, s37, s70
    s_add_u32 s71, s71, s72
    s_mul_i32 s71, s71, 1152
    s_sub_u32 s58, s71, 0
    v_lshlrev_b32 v19, 4, v1
    s_lshl_b32 s70, s29, 6
    s_add_u32 s70, s70, s31
    s_mul_i32 s70, s70, 36864
    s_add_u32 s70, s70, 44892160
    s_lshl_b32 s90, s30, 9
    s_lshl_b32 s91, s28, 7
    s_add_u32 s90, s90, s91
    s_add_u32 s90, s90, 82657280
    s_mov_b32 s91, 0
    v_mov_b32 v251, 0
mega_kernel_wtc:
    buffer_load_dword v250, v251, s[20:23], s90 offen sc1
    s_waitcnt vmcnt(0)
    v_readfirstlane_b32 s94, v250
    s_add_u32 s91, s91, 1
    s_cmp_ge_u32 s94, 4
    s_cbranch_scc1 mega_kernel_wuc
    s_cmp_lt_u32 s91, 400000
    s_cbranch_scc0 mega_kernel_wuc
    s_sleep 1
    s_branch mega_kernel_wtc
mega_kernel_wuc:
    s_add_u32 m0, s32, 0
    s_add_u32 s38, s34, 0
    buffer_load_dwordx4 v16, s[8:11], s38 offen offset:0 lds
    s_add_u32 s38, s34, 146432
    buffer_load_dwordx4 v16, s[8:11], s38 offen offset:1024 lds
    s_add_u32 s38, s34, 292864
    buffer_load_dwordx4 v16, s[8:11], s38 offen offset:2048 lds
    s_add_u32 s38, s34, 439296
    buffer_load_dwordx4 v16, s[8:11], s38 offen offset:3072 lds
    s_add_u32 m0, s32, 4096
    s_add_u32 s38, s34, 589824
    buffer_load_dwordx4 v16, s[8:11], s38 offen offset:0 lds
    s_add_u32 s38, s34, 736256
    buffer_load_dwordx4 v16, s[8:11], s38 offen offset:1024 lds
    s_add_u32 s38, s34, 882688
    buffer_load_dwordx4 v16, s[8:11], s38 offen offset:2048 lds
    s_add_u32 s38, s34, 1029120
    buffer_load_dwordx4 v16, s[8:11], s38 offen offset:3072 lds
    s_add_u32 m0, s32, 8192
    s_add_u32 s38, s34, 1179648
    buffer_load_dwordx4 v16, s[8:11], s38 offen offset:0 lds
    v_lshlrev_b32 v8, 4, v1
    s_mul_i32 s79, s31, 36864
    s_add_u32 s79, s79, 4784128
    buffer_load_dwordx4 a[0:3], v8, s[20:23], s79 offen offset:0 sc1
    buffer_load_dwordx4 a[4:7], v8, s[20:23], s79 offen offset:1024 sc1
    buffer_load_dwordx4 a[8:11], v8, s[20:23], s79 offen offset:2048 sc1
    buffer_load_dwordx4 a[12:15], v8, s[20:23], s79 offen offset:3072 sc1
    s_add_u32 s79, s79, 4096
    buffer_load_dwordx4 a[16:19], v8, s[20:23], s79 offen offset:0 sc1
    buffer_load_dwordx4 a[20:23], v8, s[20:23], s79 offen offset:1024 sc1
    buffer_load_dwordx4 a[24:27], v8, s[20:23], s79 offen offset:2048 sc1
    buffer_load_dwordx4 a[28:31], v8, s[20:23], s79 offen offset:3072 sc1
    s_add_u32 s79, s79, 4096
    buffer_load_dwordx4 a[32:35], v8, s[20:23], s79 offen offset:0 sc1
    buffer_load_dwordx4 a[36:39], v8, s[20:23], s79 offen offset:1024 sc1
    buffer_load_dwordx4 a[40:43], v8, s[20:23], s79 offen offset:2048 sc1
    buffer_load_dwordx4 a[44:47], v8, s[20:23], s79 offen offset:3072 sc1
    s_add_u32 s79, s79, 4096
    s_add_u32 m0, s32, 36864
    s_add_u32 s38, s34, 0
    buffer_load_dwordx4 v16, s[12:15], s38 offen offset:0 lds
    s_add_u32 s38, s34, 146432
    buffer_load_dwordx4 v16, s[12:15], s38 offen offset:1024 lds
    s_add_u32 s38, s34, 292864
    buffer_load_dwordx4 v16, s[12:15], s38 offen offset:2048 lds
    s_add_u32 s38, s34, 439296
    buffer_load_dwordx4 v16, s[12:15], s38 offen offset:3072 lds
    s_add_u32 m0, s32, 40960
    s_add_u32 s38, s34, 589824
    buffer_load_dwordx4 v16, s[12:15], s38 offen offset:0 lds
    s_add_u32 s38, s34, 736256
    buffer_load_dwordx4 v16, s[12:15], s38 offen offset:1024 lds
    s_add_u32 s38, s34, 882688
    buffer_load_dwordx4 v16, s[12:15], s38 offen offset:2048 lds
    s_add_u32 s38, s34, 1029120
    buffer_load_dwordx4 v16, s[12:15], s38 offen offset:3072 lds
    s_add_u32 m0, s32, 45056
    s_add_u32 s38, s34, 1179648
    buffer_load_dwordx4 v16, s[12:15], s38 offen offset:0 lds
    s_waitcnt vmcnt(21)
    s_barrier
    v_mov_b32 v13, v12
    ds_read_b64_tr_b16 a[144:145], v13 offset:0
    ds_read_b64_tr_b16 a[146:147], v13 offset:256
    ds_read_b64_tr_b16 a[148:149], v13 offset:1024
    ds_read_b64_tr_b16 a[150:151], v13 offset:1280
    ds_read_b64_tr_b16 a[152:153], v13 offset:2048
    ds_read_b64_tr_b16 a[154:155], v13 offset:2304
    ds_read_b64_tr_b16 a[156:157], v13 offset:3072
    ds_read_b64_tr_b16 a[158:159], v13 offset:3328
    s_waitcnt lgkmcnt(4)
    s_waitcnt vmcnt(20)
    v_mfma_f32_32x32x16_bf16 v[48:63], a[144:147], a[0:3], 0
    ds_read_b64_tr_b16 a[144:145], v13 offset:4096
    ds_read_b64_tr_b16 a[146:147], v13 offset:4352
    buffer_load_dwordx4 a[48:51], v8, s[20:23], s79 offen offset:0 sc1
    buffer_load_dwordx4 a[52:55], v8, s[20:23], s79 offen offset:1024 sc1
    s_waitcnt vmcnt(21)
    v_mfma_f32_32x32x16_bf16 v[48:63], a[148:151], a[4:7], v[48:63]
    ds_read_b64_tr_b16 a[148:149], v13 offset:5120
    ds_read_b64_tr_b16 a[150:151], v13 offset:5376
    buffer_load_dwordx4 a[56:59], v8, s[20:23], s79 offen offset:2048 sc1
    buffer_load_dwordx4 a[60:63], v8, s[20:23], s79 offen offset:3072 sc1
    s_add_u32 s79, s79, 4096
    s_waitcnt lgkmcnt(4)
    s_waitcnt vmcnt(22)
    v_mfma_f32_32x32x16_bf16 v[48:63], a[152:155], a[8:11], v[48:63]
    ds_read_b64_tr_b16 a[152:153], v13 offset:6144
    ds_read_b64_tr_b16 a[154:155], v13 offset:6400
    buffer_load_dwordx4 a[64:67], v8, s[20:23], s79 offen offset:0 sc1
    buffer_load_dwordx4 a[68:71], v8, s[20:23], s79 offen offset:1024 sc1
    s_waitcnt vmcnt(23)
    v_mfma_f32_32x32x16_bf16 v[48:63], a[156:159], a[12:15], v[48:63]
    ds_read_b64_tr_b16 a[156:157], v13 offset:7168
    ds_read_b64_tr_b16 a[158:159], v13 offset:7424
    buffer_load_dwordx4 a[72:75], v8, s[20:23], s79 offen offset:2048 sc1
    buffer_load_dwordx4 a[76:79], v8, s[20:23], s79 offen offset:3072 sc1
    s_add_u32 s79, s79, 4096
    s_waitcnt lgkmcnt(4)
    s_waitcnt vmcnt(24)
    v_mfma_f32_32x32x16_bf16 v[48:63], a[144:147], a[16:19], v[48:63]
    ds_read_b64_tr_b16 a[144:145], v13 offset:8192
    ds_read_b64_tr_b16 a[146:147], v13 offset:8448
    buffer_load_dwordx4 a[80:83], v8, s[20:23], s79 offen offset:0 sc1
    buffer_load_dwordx4 a[84:87], v8, s[20:23], s79 offen offset:1024 sc1
    s_waitcnt vmcnt(25)
    v_mfma_f32_32x32x16_bf16 v[48:63], a[148:151], a[20:23], v[48:63]
    ds_read_b64_tr_b16 a[148:149], v13 offset:9216
    ds_read_b64_tr_b16 a[150:151], v13 offset:9472
    buffer_load_dwordx4 a[88:91], v8, s[20:23], s79 offen offset:2048 sc1
    buffer_load_dwordx4 a[92:95], v8, s[20:23], s79 offen offset:3072 sc1
    s_add_u32 s79, s79, 4096
    s_waitcnt lgkmcnt(4)
    s_waitcnt vmcnt(26)
    v_mfma_f32_32x32x16_bf16 v[48:63], a[152:155], a[24:27], v[48:63]
    ds_read_b64_tr_b16 a[152:153], v13 offset:10240
    ds_read_b64_tr_b16 a[154:155], v13 offset:10496
    buffer_load_dwordx4 a[96:99], v8, s[20:23], s79 offen offset:0 sc1
    buffer_load_dwordx4 a[100:103], v8, s[20:23], s79 offen offset:1024 sc1
    s_waitcnt vmcnt(27)
    v_mfma_f32_32x32x16_bf16 v[48:63], a[156:159], a[28:31], v[48:63]
    ds_read_b64_tr_b16 a[156:157], v13 offset:11264
    ds_read_b64_tr_b16 a[158:159], v13 offset:11520
    buffer_load_dwordx4 a[104:107], v8, s[20:23], s79 offen offset:2048 sc1
    buffer_load_dwordx4 a[108:111], v8, s[20:23], s79 offen offset:3072 sc1
    s_add_u32 s79, s79, 4096
    s_waitcnt lgkmcnt(4)
    s_waitcnt vmcnt(28)
    v_mfma_f32_32x32x16_bf16 v[48:63], a[144:147], a[32:35], v[48:63]
    ds_read_b64_tr_b16 a[144:145], v13 offset:12288
    ds_read_b64_tr_b16 a[146:147], v13 offset:12544
    buffer_load_dwordx4 a[112:115], v8, s[20:23], s79 offen offset:0 sc1
    buffer_load_dwordx4 a[116:119], v8, s[20:23], s79 offen offset:1024 sc1
    s_waitcnt vmcnt(29)
    v_mfma_f32_32x32x16_bf16 v[48:63], a[148:151], a[36:39], v[48:63]
    ds_read_b64_tr_b16 a[148:149], v13 offset:13312
    ds_read_b64_tr_b16 a[150:151], v13 offset:13568
    buffer_load_dwordx4 a[120:123], v8, s[20:23], s79 offen offset:2048 sc1
    buffer_load_dwordx4 a[124:127], v8, s[20:23], s79 offen offset:3072 sc1
    s_add_u32 s79, s79, 4096
    s_waitcnt lgkmcnt(4)
    s_waitcnt vmcnt(30)
    v_mfma_f32_32x32x16_bf16 v[48:63], a[152:155], a[40:43], v[48:63]
    ds_read_b64_tr_b16 a[152:153], v13 offset:14336
    ds_read_b64_tr_b16 a[154:155], v13 offset:14592
    buffer_load_dwordx4 a[128:131], v8, s[20:23], s79 offen offset:0 sc1
    buffer_load_dwordx4 a[132:135], v8, s[20:23], s79 offen offset:1024 sc1
    s_waitcnt vmcnt(31)
    v_mfma_f32_32x32x16_bf16 v[48:63], a[156:159], a[44:47], v[48:63]
    ds_read_b64_tr_b16 a[156:157], v13 offset:15360
    ds_read_b64_tr_b16 a[158:159], v13 offset:15616
    buffer_load_dwordx4 a[136:139], v8, s[20:23], s79 offen offset:2048 sc1
    buffer_load_dwordx4 a[140:143], v8, s[20:23], s79 offen offset:3072 sc1
    s_waitcnt lgkmcnt(4)
    s_waitcnt vmcnt(23)
    v_mfma_f32_32x32x16_bf16 v[48:63], a[144:147], a[48:51], v[48:63]
    ds_read_b64_tr_b16 a[144:145], v13 offset:16384
    ds_read_b64_tr_b16 a[146:147], v13 offset:16640
    s_waitcnt vmcnt(22)
    v_mfma_f32_32x32x16_bf16 v[48:63], a[148:151], a[52:55], v[48:63]
    ds_read_b64_tr_b16 a[148:149], v13 offset:17408
    ds_read_b64_tr_b16 a[150:151], v13 offset:17664
    s_waitcnt lgkmcnt(4)
    s_waitcnt vmcnt(21)
    v_mfma_f32_32x32x16_bf16 v[48:63], a[152:155], a[56:59], v[48:63]
    ds_read_b64_tr_b16 a[152:153], v13 offset:18432
    ds_read_b64_tr_b16 a[154:155], v13 offset:18688
    s_waitcnt vmcnt(20)
    v_mfma_f32_32x32x16_bf16 v[48:63], a[156:159], a[60:63], v[48:63]
    ds_read_b64_tr_b16 a[156:157], v13 offset:19456
    ds_read_b64_tr_b16 a[158:159], v13 offset:19712
    s_waitcnt lgkmcnt(4)
    s_waitcnt vmcnt(19)
    v_mfma_f32_32x32x16_bf16 v[48:63], a[144:147], a[64:67], v[48:63]
    ds_read_b64_tr_b16 a[144:145], v13 offset:20480
    ds_read_b64_tr_b16 a[146:147], v13 offset:20736
    s_waitcnt vmcnt(18)
    v_mfma_f32_32x32x16_bf16 v[48:63], a[148:151], a[68:71], v[48:63]
    ds_read_b64_tr_b16 a[148:149], v13 offset:21504
    ds_read_b64_tr_b16 a[150:151], v13 offset:21760
    s_waitcnt lgkmcnt(4)
    s_waitcnt vmcnt(17)
    v_mfma_f32_32x32x16_bf16 v[48:63], a[152:155], a[72:75], v[48:63]
    ds_read_b64_tr_b16 a[152:153], v13 offset:22528
    ds_read_b64_tr_b16 a[154:155], v13 offset:22784
    s_waitcnt vmcnt(16)
    v_mfma_f32_32x32x16_bf16 v[48:63], a[156:159], a[76:79], v[48:63]
    ds_read_b64_tr_b16 a[156:157], v13 offset:23552
    ds_read_b64_tr_b16 a[158:159], v13 offset:23808
    s_waitcnt lgkmcnt(4)
    s_waitcnt vmcnt(15)
    v_mfma_f32_32x32x16_bf16 v[48:63], a[144:147], a[80:83], v[48:63]
    ds_read_b64_tr_b16 a[144:145], v13 offset:24576
    ds_read_b64_tr_b16 a[146:147], v13 offset:24832
    s_waitcnt vmcnt(14)
    v_mfma_f32_32x32x16_bf16 v[48:63], a[148:151], a[84:87], v[48:63]
    ds_read_b64_tr_b16 a[148:149], v13 offset:25600
    ds_read_b64_tr_b16 a[150:151], v13 offset:25856
    s_waitcnt lgkmcnt(4)
    s_waitcnt vmcnt(13)
    v_mfma_f32_32x32x16_bf16 v[48:63], a[152:155], a[88:91], v[48:63]
    ds_read_b64_tr_b16 a[152:153], v13 offset:26624
    ds_read_b64_tr_b16 a[154:155], v13 offset:26880
    s_add_u32 m0, s32, 73728
    v_add_u32 v18, s33, v15
    s_waitcnt vmcnt(12)
    v_mfma_f32_32x32x16_bf16 v[48:63], a[156:159], a[92:95], v[48:63]
    ds_read_b64_tr_b16 a[156:157], v13 offset:27648
    ds_read_b64_tr_b16 a[158:159], v13 offset:27904
    buffer_load_dwordx4 v18, s[8:11], s40 offen offset:0 lds
    s_waitcnt lgkmcnt(4)
    s_waitcnt vmcnt(12)
    v_mfma_f32_32x32x16_bf16 v[48:63], a[144:147], a[96:99], v[48:63]
    ds_read_b64_tr_b16 a[144:145], v13 offset:28672
    ds_read_b64_tr_b16 a[146:147], v13 offset:28928
    buffer_load_dwordx4 v18, s[8:11], s41 offen offset:1024 lds
    s_waitcnt vmcnt(12)
    v_mfma_f32_32x32x16_bf16 v[48:63], a[148:151], a[100:103], v[48:63]
    ds_read_b64_tr_b16 a[148:149], v13 offset:29696
    ds_read_b64_tr_b16 a[150:151], v13 offset:29952
    buffer_load_dwordx4 v18, s[8:11], s42 offen offset:2048 lds
    s_waitcnt lgkmcnt(4)
    s_waitcnt vmcnt(12)
    v_mfma_f32_32x32x16_bf16 v[48:63], a[152:155], a[104:107], v[48:63]
    ds_read_b64_tr_b16 a[152:153], v13 offset:30720
    ds_read_b64_tr_b16 a[154:155], v13 offset:30976
    buffer_load_dwordx4 v18, s[8:11], s43 offen offset:3072 lds
    s_add_u32 m0, s32, 77824
    s_waitcnt vmcnt(12)
    v_mfma_f32_32x32x16_bf16 v[48:63], a[156:159], a[108:111], v[48:63]
    ds_read_b64_tr_b16 a[156:157], v13 offset:31744
    ds_read_b64_tr_b16 a[158:159], v13 offset:32000
    buffer_load_dwordx4 v18, s[8:11], s44 offen offset:0 lds
    s_waitcnt lgkmcnt(4)
    s_waitcnt vmcnt(12)
    v_mfma_f32_32x32x16_bf16 v[48:63], a[144:147], a[112:115], v[48:63]
    ds_read_b64_tr_b16 a[144:145], v13 offset:32768
    ds_read_b64_tr_b16 a[146:147], v13 offset:33024
    buffer_load_dwordx4 v18, s[8:11], s45 offen offset:1024 lds
    s_waitcnt vmcnt(12)
    v_mfma_f32_32x32x16_bf16 v[48:63], a[148:151], a[116:119], v[48:63]
    ds_read_b64_tr_b16 a[148:149], v13 offset:33792
    ds_read_b64_tr_b16 a[150:151], v13 offset:34048
    buffer_load_dwordx4 v18, s[8:11], s46 offen offset:2048 lds
    s_waitcnt lgkmcnt(4)
    s_waitcnt vmcnt(12)
    v_mfma_f32_32x32x16_bf16 v[48:63], a[152:155], a[120:123], v[48:63]
    ds_read_b64_tr_b16 a[152:153], v13 offset:34816
    ds_read_b64_tr_b16 a[154:155], v13 offset:35072
    buffer_load_dwordx4 v18, s[8:11], s47 offen offset:3072 lds
    s_add_u32 m0, s32, 81920
    s_waitcnt vmcnt(12)
    v_mfma_f32_32x32x16_bf16 v[48:63], a[156:159], a[124:127], v[48:63]
    ds_read_b64_tr_b16 a[156:157], v13 offset:35840
    ds_read_b64_tr_b16 a[158:159], v13 offset:36096
    buffer_load_dwordx4 v18, s[8:11], s48 offen offset:0 lds
    s_waitcnt lgkmcnt(4)
    s_waitcnt vmcnt(12)
    v_mfma_f32_32x32x16_bf16 v[48:63], a[144:147], a[128:131], v[48:63]
    s_barrier
    v_add_u32 v13, 36864, v12
    ds_read_b64_tr_b16 a[144:145], v13 offset:0
    ds_read_b64_tr_b16 a[146:147], v13 offset:256
    s_waitcnt vmcnt(11)
    v_mfma_f32_32x32x16_bf16 v[48:63], a[148:151], a[132:135], v[48:63]
    ds_read_b64_tr_b16 a[148:149], v13 offset:1024
    ds_read_b64_tr_b16 a[150:151], v13 offset:1280
    s_waitcnt lgkmcnt(4)
    s_waitcnt vmcnt(10)
    v_mfma_f32_32x32x16_bf16 v[48:63], a[152:155], a[136:139], v[48:63]
    ds_read_b64_tr_b16 a[152:153], v13 offset:2048
    ds_read_b64_tr_b16 a[154:155], v13 offset:2304
    s_waitcnt vmcnt(9)
    v_mfma_f32_32x32x16_bf16 v[48:63], a[156:159], a[140:143], v[48:63]
    ds_read_b64_tr_b16 a[156:157], v13 offset:3072
    ds_read_b64_tr_b16 a[158:159], v13 offset:3328
    s_waitcnt lgkmcnt(4)
    v_mfma_f32_32x32x16_bf16 v[80:95], a[144:147], a[0:3], 0
    ds_read_b64_tr_b16 a[144:145], v13 offset:4096
    ds_read_b64_tr_b16 a[146:147], v13 offset:4352
    s_add_u32 m0, s32, 110592
    s_add_u32 s38, s33, 2654208
    v_add_u32 v18, s38, v15
    v_mfma_f32_32x32x16_bf16 v[80:95], a[148:151], a[4:7], v[80:95]
    ds_read_b64_tr_b16 a[148:149], v13 offset:5120
    ds_read_b64_tr_b16 a[150:151], v13 offset:5376
    s_waitcnt lgkmcnt(4)
    v_mfma_f32_32x32x16_bf16 v[80:95], a[152:155], a[8:11], v[80:95]
    ds_read_b64_tr_b16 a[152:153], v13 offset:6144
    ds_read_b64_tr_b16 a[154:155], v13 offset:6400
    buffer_load_dwordx4 v18, s[8:11], s40 offen offset:0 lds
    v_mfma_f32_32x32x16_bf16 v[80:95], a[156:159], a[12:15], v[80:95]
    ds_read_b64_tr_b16 a[156:157], v13 offset:7168
    ds_read_b64_tr_b16 a[158:159], v13 offset:7424
    v_mul_f32 v20, s39, v48
    v_mul_f32 v21, s39, v49
    v_mul_f32 v22, s39, v50
    s_waitcnt lgkmcnt(4)
    v_mfma_f32_32x32x16_bf16 v[80:95], a[144:147], a[16:19], v[80:95]
    ds_read_b64_tr_b16 a[144:145], v13 offset:8192
    ds_read_b64_tr_b16 a[146:147], v13 offset:8448
    buffer_load_dwordx4 v18, s[8:11], s41 offen offset:1024 lds
    v_mul_f32 v23, s39, v51
    v_exp_f32 v20, v20
    v_exp_f32 v21, v21
    v_mfma_f32_32x32x16_bf16 v[80:95], a[148:151], a[20:23], v[80:95]
    ds_read_b64_tr_b16 a[148:149], v13 offset:9216
    ds_read_b64_tr_b16 a[150:151], v13 offset:9472
    v_exp_f32 v22, v22
    v_exp_f32 v23, v23
    s_waitcnt lgkmcnt(4)
    v_mfma_f32_32x32x16_bf16 v[80:95], a[152:155], a[24:27], v[80:95]
    ds_read_b64_tr_b16 a[152:153], v13 offset:10240
    ds_read_b64_tr_b16 a[154:155], v13 offset:10496
    buffer_load_dwordx4 v18, s[8:11], s42 offen offset:2048 lds
    v_add_f32 v20, 1.0, v20
    v_add_f32 v21, 1.0, v21
    v_add_f32 v22, 1.0, v22
    v_mfma_f32_32x32x16_bf16 v[80:95], a[156:159], a[28:31], v[80:95]
    ds_read_b64_tr_b16 a[156:157], v13 offset:11264
    ds_read_b64_tr_b16 a[158:159], v13 offset:11520
    v_add_f32 v23, 1.0, v23
    v_rcp_f32 v20, v20
    s_waitcnt lgkmcnt(4)
    v_mfma_f32_32x32x16_bf16 v[80:95], a[144:147], a[32:35], v[80:95]
    ds_read_b64_tr_b16 a[144:145], v13 offset:12288
    ds_read_b64_tr_b16 a[146:147], v13 offset:12544
    buffer_load_dwordx4 v18, s[8:11], s43 offen offset:3072 lds
    s_add_u32 m0, s32, 114688
    v_rcp_f32 v21, v21
    v_rcp_f32 v22, v22
    v_rcp_f32 v23, v23
    v_mfma_f32_32x32x16_bf16 v[80:95], a[148:151], a[36:39], v[80:95]
    ds_read_b64_tr_b16 a[148:149], v13 offset:13312
    ds_read_b64_tr_b16 a[150:151], v13 offset:13568
    v_mul_f32 v48, v48, v20
    v_mul_f32 v49, v49, v21
    v_mul_f32 v50, v50, v22
    s_waitcnt lgkmcnt(4)
    v_mfma_f32_32x32x16_bf16 v[80:95], a[152:155], a[40:43], v[80:95]
    ds_read_b64_tr_b16 a[152:153], v13 offset:14336
    ds_read_b64_tr_b16 a[154:155], v13 offset:14592
    buffer_load_dwordx4 v18, s[8:11], s44 offen offset:0 lds
    v_mul_f32 v51, v51, v23
    v_mul_f32 v20, s39, v52
    v_mfma_f32_32x32x16_bf16 v[80:95], a[156:159], a[44:47], v[80:95]
    ds_read_b64_tr_b16 a[156:157], v13 offset:15360
    ds_read_b64_tr_b16 a[158:159], v13 offset:15616
    v_mul_f32 v21, s39, v53
    v_mul_f32 v22, s39, v54
    v_mul_f32 v23, s39, v55
    s_waitcnt lgkmcnt(4)
    v_mfma_f32_32x32x16_bf16 v[80:95], a[144:147], a[48:51], v[80:95]
    ds_read_b64_tr_b16 a[144:145], v13 offset:16384
    ds_read_b64_tr_b16 a[146:147], v13 offset:16640
    buffer_load_dwordx4 v18, s[8:11], s45 offen offset:1024 lds
    v_exp_f32 v20, v20
    v_exp_f32 v21, v21
    v_mfma_f32_32x32x16_bf16 v[80:95], a[148:151], a[52:55], v[80:95]
    ds_read_b64_tr_b16 a[148:149], v13 offset:17408
    ds_read_b64_tr_b16 a[150:151], v13 offset:17664
    v_exp_f32 v22, v22
    v_exp_f32 v23, v23
    v_add_f32 v20, 1.0, v20
    s_waitcnt lgkmcnt(4)
    v_mfma_f32_32x32x16_bf16 v[80:95], a[152:155], a[56:59], v[80:95]
    ds_read_b64_tr_b16 a[152:153], v13 offset:18432
    ds_read_b64_tr_b16 a[154:155], v13 offset:18688
    buffer_load_dwordx4 v18, s[8:11], s46 offen offset:2048 lds
    v_add_f32 v21, 1.0, v21
    v_add_f32 v22, 1.0, v22
    v_mfma_f32_32x32x16_bf16 v[80:95], a[156:159], a[60:63], v[80:95]
    ds_read_b64_tr_b16 a[156:157], v13 offset:19456
    ds_read_b64_tr_b16 a[158:159], v13 offset:19712
    v_add_f32 v23, 1.0, v23
    v_rcp_f32 v20, v20
    v_rcp_f32 v21, v21
    s_waitcnt lgkmcnt(4)
    v_mfma_f32_32x32x16_bf16 v[80:95], a[144:147], a[64:67], v[80:95]
    ds_read_b64_tr_b16 a[144:145], v13 offset:20480
    ds_read_b64_tr_b16 a[146:147], v13 offset:20736
    buffer_load_dwordx4 v18, s[8:11], s47 offen offset:3072 lds
    s_add_u32 m0, s32, 118784
    v_rcp_f32 v22, v22
    v_rcp_f32 v23, v23
    v_mul_f32 v52, v52, v20
    v_mfma_f32_32x32x16_bf16 v[80:95], a[148:151], a[68:71], v[80:95]
    ds_read_b64_tr_b16 a[148:149], v13 offset:21504
    ds_read_b64_tr_b16 a[150:151], v13 offset:21760
    v_mul_f32 v53, v53, v21
    v_mul_f32 v54, v54, v22
    s_waitcnt lgkmcnt(4)
    v_mfma_f32_32x32x16_bf16 v[80:95], a[152:155], a[72:75], v[80:95]
    ds_read_b64_tr_b16 a[152:153], v13 offset:22528
    ds_read_b64_tr_b16 a[154:155], v13 offset:22784
    buffer_load_dwordx4 v18, s[8:11], s48 offen offset:0 lds
    v_mul_f32 v55, v55, v23
    v_mul_f32 v20, s39, v56
    v_mul_f32 v21, s39, v57
    v_mfma_f32_32x32x16_bf16 v[80:95], a[156:159], a[76:79], v[80:95]
    ds_read_b64_tr_b16 a[156:157], v13 offset:23552
    ds_read_b64_tr_b16 a[158:159], v13 offset:23808
    v_mul_f32 v22, s39, v58
    v_mul_f32 v23, s39, v59
    s_waitcnt lgkmcnt(4)
    v_mfma_f32_32x32x16_bf16 v[80:95], a[144:147], a[80:83], v[80:95]
    ds_read_b64_tr_b16 a[144:145], v13 offset:24576
    ds_read_b64_tr_b16 a[146:147], v13 offset:24832
    v_exp_f32 v20, v20
    v_exp_f32 v21, v21
    v_exp_f32 v22, v22
    v_mfma_f32_32x32x16_bf16 v[80:95], a[148:151], a[84:87], v[80:95]
    ds_read_b64_tr_b16 a[148:149], v13 offset:25600
    ds_read_b64_tr_b16 a[150:151], v13 offset:25856
    v_exp_f32 v23, v23
    v_add_f32 v20, 1.0, v20
    v_add_f32 v21, 1.0, v21
    s_waitcnt lgkmcnt(4)
    v_mfma_f32_32x32x16_bf16 v[80:95], a[152:155], a[88:91], v[80:95]
    ds_read_b64_tr_b16 a[152:153], v13 offset:26624
    ds_read_b64_tr_b16 a[154:155], v13 offset:26880
    v_add_f32 v22, 1.0, v22
    v_add_f32 v23, 1.0, v23
    s_and_b32 s77, s30, 7
    s_mul_i32 s76, s29, 331776
    s_mul_i32 s78, s77, 41472
    s_add_u32 s78, s78, s76
    s_lshl_b32 s79, s28, 13
    s_add_u32 s78, s78, s79
    v_lshlrev_b32 v4, 7, v1
    buffer_load_dword v252, v4, s[16:19], s78 offen
    s_add_u32 s78, s78, 32768
    buffer_load_dword v253, v4, s[16:19], s78 offen
    v_mfma_f32_32x32x16_bf16 v[80:95], a[156:159], a[92:95], v[80:95]
    ds_read_b64_tr_b16 a[156:157], v13 offset:27648
    ds_read_b64_tr_b16 a[158:159], v13 offset:27904
    v_rcp_f32 v20, v20
    v_rcp_f32 v21, v21
    v_rcp_f32 v22, v22
    s_waitcnt lgkmcnt(4)
    v_mfma_f32_32x32x16_bf16 v[80:95], a[144:147], a[96:99], v[80:95]
    ds_read_b64_tr_b16 a[144:145], v13 offset:28672
    ds_read_b64_tr_b16 a[146:147], v13 offset:28928
    v_rcp_f32 v23, v23
    v_mul_f32 v56, v56, v20
    v_mfma_f32_32x32x16_bf16 v[80:95], a[148:151], a[100:103], v[80:95]
    ds_read_b64_tr_b16 a[148:149], v13 offset:29696
    ds_read_b64_tr_b16 a[150:151], v13 offset:29952
    v_mul_f32 v57, v57, v21
    v_mul_f32 v58, v58, v22
    v_mul_f32 v59, v59, v23
    s_waitcnt lgkmcnt(4)
    v_mfma_f32_32x32x16_bf16 v[80:95], a[152:155], a[104:107], v[80:95]
    ds_read_b64_tr_b16 a[152:153], v13 offset:30720
    ds_read_b64_tr_b16 a[154:155], v13 offset:30976
    v_mul_f32 v20, s39, v60
    v_mul_f32 v21, s39, v61
    v_mfma_f32_32x32x16_bf16 v[80:95], a[156:159], a[108:111], v[80:95]
    ds_read_b64_tr_b16 a[156:157], v13 offset:31744
    ds_read_b64_tr_b16 a[158:159], v13 offset:32000
    v_mul_f32 v22, s39, v62
    v_mul_f32 v23, s39, v63
    v_exp_f32 v20, v20
    s_waitcnt lgkmcnt(4)
    v_mfma_f32_32x32x16_bf16 v[80:95], a[144:147], a[112:115], v[80:95]
    ds_read_b64_tr_b16 a[144:145], v13 offset:32768
    ds_read_b64_tr_b16 a[146:147], v13 offset:33024
    v_exp_f32 v21, v21
    v_exp_f32 v22, v22
    v_exp_f32 v23, v23
    v_mfma_f32_32x32x16_bf16 v[80:95], a[148:151], a[116:119], v[80:95]
    ds_read_b64_tr_b16 a[148:149], v13 offset:33792
    ds_read_b64_tr_b16 a[150:151], v13 offset:34048
    v_add_f32 v20, 1.0, v20
    v_add_f32 v21, 1.0, v21
    s_waitcnt lgkmcnt(4)
    v_mfma_f32_32x32x16_bf16 v[80:95], a[152:155], a[120:123], v[80:95]
    ds_read_b64_tr_b16 a[152:153], v13 offset:34816
    ds_read_b64_tr_b16 a[154:155], v13 offset:35072
    v_add_f32 v22, 1.0, v22
    v_add_f32 v23, 1.0, v23
    v_rcp_f32 v20, v20
    v_mfma_f32_32x32x16_bf16 v[80:95], a[156:159], a[124:127], v[80:95]
    ds_read_b64_tr_b16 a[156:157], v13 offset:35840
    ds_read_b64_tr_b16 a[158:159], v13 offset:36096
    v_rcp_f32 v21, v21
    v_rcp_f32 v22, v22
    s_waitcnt lgkmcnt(4)
    v_mfma_f32_32x32x16_bf16 v[80:95], a[144:147], a[128:131], v[80:95]
    s_waitcnt vmcnt(9)
    s_barrier
    v_add_u32 v13, 73728, v10
    v_add_u32 v14, 73728, v11
    ds_read_b64_tr_b16 a[144:145], v13 offset:0
    ds_read_b64_tr_b16 a[146:147], v13 offset:512
    v_rcp_f32 v23, v23
    v_mul_f32 v60, v60, v20
    v_mul_f32 v61, v61, v21
    v_mfma_f32_32x32x16_bf16 v[80:95], a[148:151], a[132:135], v[80:95]
    ds_read_b64_tr_b16 a[148:149], v13 offset:2048
    ds_read_b64_tr_b16 a[150:151], v13 offset:2560
    v_mul_f32 v62, v62, v22
    v_mul_f32 v63, v63, v23
    s_waitcnt lgkmcnt(4)
    v_mfma_f32_32x32x16_bf16 v[80:95], a[152:155], a[136:139], v[80:95]
    ds_read_b64_tr_b16 a[152:153], v13 offset:4096
    ds_read_b64_tr_b16 a[154:155], v13 offset:4608
    v_mfma_f32_32x32x16_bf16 v[80:95], a[156:159], a[140:143], v[80:95]
    ds_read_b64_tr_b16 a[156:157], v13 offset:6144
    ds_read_b64_tr_b16 a[158:159], v13 offset:6656
    s_mov_b32 s35, 0
mega_kernel_ffn_l1:
    s_add_u32 s76, s33, 128
    s_add_u32 s77, s76, 2654208
    s_cmp_lg_u32 s35, 3
    s_cbranch_scc1 mega_kernel_ffn_nosw
    s_mov_b32 s76, 0
    s_mov_b32 s77, 128
    v_mov_b32 v9, v17
    s_mov_b32 s60, s50
    s_mov_b32 s61, s51
    s_mov_b32 s62, s52
    s_mov_b32 s63, s53
    s_mov_b32 s64, s54
    s_mov_b32 s65, s55
    s_mov_b32 s66, s56
    s_mov_b32 s67, s57
    s_mov_b32 s68, s58
    s_mov_b32 s24, s16
    s_mov_b32 s25, s17
mega_kernel_ffn_nosw:
    s_waitcnt lgkmcnt(4)
    v_mfma_f32_32x32x16_bf16 v[32:47], a[144:147], a[0:3], 0
    ds_read_b64_tr_b16 a[144:145], v13 offset:8192
    ds_read_b64_tr_b16 a[146:147], v13 offset:8704
    s_add_u32 m0, s32, 0
    v_add_u32 v18, s33, v15
    v_mfma_f32_32x32x16_bf16 v[32:47], a[148:151], a[4:7], v[32:47]
    ds_read_b64_tr_b16 a[148:149], v13 offset:10240
    ds_read_b64_tr_b16 a[150:151], v13 offset:10752
    s_waitcnt lgkmcnt(4)
    v_mfma_f32_32x32x16_bf16 v[32:47], a[152:155], a[8:11], v[32:47]
    ds_read_b64_tr_b16 a[152:153], v13 offset:12288
    ds_read_b64_tr_b16 a[154:155], v13 offset:12800
    buffer_load_dwordx4 v18, s[12:15], s40 offen offset:0 lds
    v_mul_f32 v48, v48, v80
    v_mul_f32 v49, v49, v81
    v_mfma_f32_32x32x16_bf16 v[32:47], a[156:159], a[12:15], v[32:47]
    ds_read_b64_tr_b16 a[156:157], v13 offset:14336
    ds_read_b64_tr_b16 a[158:159], v13 offset:14848
    v_mul_f32 v50, v50, v82
    v_mul_f32 v51, v51, v83
    v_cvt_pk_bf16_f32 v160, v48, v49
    s_waitcnt lgkmcnt(4)
    v_mfma_f32_32x32x16_bf16 v[32:47], a[144:147], a[16:19], v[32:47]
    ds_read_b64_tr_b16 a[144:145], v13 offset:16384
    ds_read_b64_tr_b16 a[146:147], v13 offset:16896
    buffer_load_dwordx4 v18, s[12:15], s41 offen offset:1024 lds
    v_cvt_pk_bf16_f32 v161, v50, v51
    v_mul_f32 v52, v52, v84
    v_mfma_f32_32x32x16_bf16 v[32:47], a[148:151], a[20:23], v[32:47]
    ds_read_b64_tr_b16 a[148:149], v13 offset:18432
    ds_read_b64_tr_b16 a[150:151], v13 offset:18944
    v_mul_f32 v53, v53, v85
    v_mul_f32 v54, v54, v86
    v_mul_f32 v55, v55, v87
    s_waitcnt lgkmcnt(4)
    v_mfma_f32_32x32x16_bf16 v[32:47], a[152:155], a[24:27], v[32:47]
    ds_read_b64_tr_b16 a[152:153], v13 offset:20480
    ds_read_b64_tr_b16 a[154:155], v13 offset:20992
    buffer_load_dwordx4 v18, s[12:15], s42 offen offset:2048 lds
    v_cvt_pk_bf16_f32 v162, v52, v53
    v_cvt_pk_bf16_f32 v163, v54, v55
    v_mfma_f32_32x32x16_bf16 v[32:47], a[156:159], a[28:31], v[32:47]
    ds_read_b64_tr_b16 a[156:157], v13 offset:22528
    ds_read_b64_tr_b16 a[158:159], v13 offset:23040
    v_mul_f32 v56, v56, v88
    v_mul_f32 v57, v57, v89
    v_mul_f32 v58, v58, v90
    s_waitcnt lgkmcnt(4)
    v_mfma_f32_32x32x16_bf16 v[32:47], a[144:147], a[32:35], v[32:47]
    ds_read_b64_tr_b16 a[144:145], v13 offset:24576
    ds_read_b64_tr_b16 a[146:147], v13 offset:25088
    buffer_load_dwordx4 v18, s[12:15], s43 offen offset:3072 lds
    s_add_u32 m0, s32, 4096
    v_mul_f32 v59, v59, v91
    v_mfma_f32_32x32x16_bf16 v[32:47], a[148:151], a[36:39], v[32:47]
    ds_read_b64_tr_b16 a[148:149], v13 offset:26624
    ds_read_b64_tr_b16 a[150:151], v13 offset:27136
    v_cvt_pk_bf16_f32 v164, v56, v57
    v_cvt_pk_bf16_f32 v165, v58, v59
    v_mul_f32 v60, v60, v92
    s_waitcnt lgkmcnt(4)
    v_mfma_f32_32x32x16_bf16 v[32:47], a[152:155], a[40:43], v[32:47]
    ds_read_b64_tr_b16 a[152:153], v13 offset:28672
    ds_read_b64_tr_b16 a[154:155], v13 offset:29184
    buffer_load_dwordx4 v18, s[12:15], s44 offen offset:0 lds
    v_mul_f32 v61, v61, v93
    v_mul_f32 v62, v62, v94
    v_mfma_f32_32x32x16_bf16 v[32:47], a[156:159], a[44:47], v[32:47]
    ds_read_b64_tr_b16 a[156:157], v13 offset:30720
    ds_read_b64_tr_b16 a[158:159], v13 offset:31232
    v_mul_f32 v63, v63, v95
    v_cvt_pk_bf16_f32 v166, v60, v61
    v_cvt_pk_bf16_f32 v167, v62, v63
    s_waitcnt lgkmcnt(4)
    v_mfma_f32_32x32x16_bf16 v[32:47], a[144:147], a[48:51], v[32:47]
    ds_read_b64_tr_b16 a[144:145], v13 offset:32768
    ds_read_b64_tr_b16 a[146:147], v13 offset:33280
    buffer_load_dwordx4 v18, s[12:15], s45 offen offset:1024 lds
    v_mfma_f32_32x32x16_bf16 v[32:47], a[148:151], a[52:55], v[32:47]
    ds_read_b64_tr_b16 a[148:149], v13 offset:34816
    ds_read_b64_tr_b16 a[150:151], v13 offset:35328
    s_waitcnt lgkmcnt(4)
    v_mfma_f32_32x32x16_bf16 v[32:47], a[152:155], a[56:59], v[32:47]
    ds_read_b64_tr_b16 a[152:153], v14 offset:0
    ds_read_b64_tr_b16 a[154:155], v14 offset:512
    buffer_load_dwordx4 v18, s[12:15], s46 offen offset:2048 lds
    v_mfma_f32_32x32x16_bf16 v[32:47], a[156:159], a[60:63], v[32:47]
    ds_read_b64_tr_b16 a[156:157], v14 offset:2048
    ds_read_b64_tr_b16 a[158:159], v14 offset:2560
    s_waitcnt lgkmcnt(4)
    v_mfma_f32_32x32x16_bf16 v[32:47], a[144:147], a[64:67], v[32:47]
    ds_read_b64_tr_b16 a[144:145], v14 offset:4096
    ds_read_b64_tr_b16 a[146:147], v14 offset:4608
    buffer_load_dwordx4 v18, s[12:15], s47 offen offset:3072 lds
    s_add_u32 m0, s32, 8192
    v_mfma_f32_32x32x16_bf16 v[32:47], a[148:151], a[68:71], v[32:47]
    ds_read_b64_tr_b16 a[148:149], v14 offset:6144
    ds_read_b64_tr_b16 a[150:151], v14 offset:6656
    s_waitcnt lgkmcnt(4)
    v_mfma_f32_32x32x16_bf16 v[48:63], a[152:155], a[0:3], 0
    ds_read_b64_tr_b16 a[152:153], v14 offset:8192
    ds_read_b64_tr_b16 a[154:155], v14 offset:8704
    buffer_load_dwordx4 v18, s[12:15], s48 offen offset:0 lds
    v_mov_b32 v96, v112
    v_mov_b32 v97, v113
    v_mfma_f32_32x32x16_bf16 v[48:63], a[156:159], a[4:7], v[48:63]
    ds_read_b64_tr_b16 a[156:157], v14 offset:10240
    ds_read_b64_tr_b16 a[158:159], v14 offset:10752
    v_mov_b32 v98, v114
    v_mov_b32 v99, v115
    v_mov_b32 v100, v116
    s_waitcnt lgkmcnt(4)
    v_mfma_f32_32x32x16_bf16 v[48:63], a[144:147], a[8:11], v[48:63]
    ds_read_b64_tr_b16 a[144:145], v14 offset:12288
    ds_read_b64_tr_b16 a[146:147], v14 offset:12800
    v_mov_b32 v101, v117
    v_mov_b32 v102, v118
    v_mov_b32 v103, v119
    v_mfma_f32_32x32x16_bf16 v[48:63], a[148:151], a[12:15], v[48:63]
    ds_read_b64_tr_b16 a[148:149], v14 offset:14336
    ds_read_b64_tr_b16 a[150:151], v14 offset:14848
    v_mov_b32 v104, v120
    v_mov_b32 v105, v121
    v_mov_b32 v106, v122
    s_waitcnt lgkmcnt(4)
    v_mfma_f32_32x32x16_bf16 v[48:63], a[152:155], a[16:19], v[48:63]
    ds_read_b64_tr_b16 a[152:153], v14 offset:16384
    ds_read_b64_tr_b16 a[154:155], v14 offset:16896
    v_mov_b32 v107, v123
    v_mov_b32 v108, v124
    v_mov_b32 v109, v125
    v_mfma_f32_32x32x16_bf16 v[48:63], a[156:159], a[20:23], v[48:63]
    ds_read_b64_tr_b16 a[156:157], v14 offset:18432
    ds_read_b64_tr_b16 a[158:159], v14 offset:18944
    v_mov_b32 v110, v126
    v_mov_b32 v111, v127
    v_mov_b32 v112, v128
    s_waitcnt lgkmcnt(4)
    v_mfma_f32_32x32x16_bf16 v[48:63], a[144:147], a[24:27], v[48:63]
    ds_read_b64_tr_b16 a[144:145], v14 offset:20480
    ds_read_b64_tr_b16 a[146:147], v14 offset:20992
    v_mov_b32 v113, v129
    v_mov_b32 v114, v130
    v_mov_b32 v115, v131
    v_mfma_f32_32x32x16_bf16 v[48:63], a[148:151], a[28:31], v[48:63]
    ds_read_b64_tr_b16 a[148:149], v14 offset:22528
    ds_read_b64_tr_b16 a[150:151], v14 offset:23040
    v_mov_b32 v116, v132
    v_mov_b32 v117, v133
    v_mov_b32 v118, v134
    s_waitcnt lgkmcnt(4)
    v_mfma_f32_32x32x16_bf16 v[48:63], a[152:155], a[32:35], v[48:63]
    ds_read_b64_tr_b16 a[152:153], v14 offset:24576
    ds_read_b64_tr_b16 a[154:155], v14 offset:25088
    v_mov_b32 v119, v135
    v_mov_b32 v120, v136
    v_mov_b32 v121, v137
    v_mfma_f32_32x32x16_bf16 v[48:63], a[156:159], a[36:39], v[48:63]
    ds_read_b64_tr_b16 a[156:157], v14 offset:26624
    ds_read_b64_tr_b16 a[158:159], v14 offset:27136
    v_mov_b32 v122, v138
    v_mov_b32 v123, v139
    v_mov_b32 v124, v140
    s_waitcnt lgkmcnt(4)
    v_mfma_f32_32x32x16_bf16 v[48:63], a[144:147], a[40:43], v[48:63]
    ds_read_b64_tr_b16 a[144:145], v14 offset:28672
    ds_read_b64_tr_b16 a[146:147], v14 offset:29184
    v_mov_b32 v125, v141
    v_mov_b32 v126, v142
    v_mov_b32 v127, v143
    v_mfma_f32_32x32x16_bf16 v[48:63], a[148:151], a[44:47], v[48:63]
    ds_read_b64_tr_b16 a[148:149], v14 offset:30720
    ds_read_b64_tr_b16 a[150:151], v14 offset:31232
    v_mov_b32 v128, v144
    v_mov_b32 v129, v145
    v_mov_b32 v130, v146
    s_waitcnt lgkmcnt(4)
    v_mfma_f32_32x32x16_bf16 v[48:63], a[152:155], a[48:51], v[48:63]
    ds_read_b64_tr_b16 a[152:153], v14 offset:32768
    ds_read_b64_tr_b16 a[154:155], v14 offset:33280
    v_mov_b32 v131, v147
    v_mfma_f32_32x32x16_bf16 v[48:63], a[156:159], a[52:55], v[48:63]
    ds_read_b64_tr_b16 a[156:157], v14 offset:34816
    ds_read_b64_tr_b16 a[158:159], v14 offset:35328
    s_waitcnt lgkmcnt(4)
    v_mfma_f32_32x32x16_bf16 v[48:63], a[144:147], a[56:59], v[48:63]
    s_waitcnt vmcnt(9)
    s_barrier
    v_add_u32 v13, 110592, v10
    v_add_u32 v14, 110592, v11
    ds_read_b64_tr_b16 a[144:145], v13 offset:0
    ds_read_b64_tr_b16 a[146:147], v13 offset:512
    v_mfma_f32_32x32x16_bf16 v[48:63], a[148:151], a[60:63], v[48:63]
    ds_read_b64_tr_b16 a[148:149], v13 offset:2048
    ds_read_b64_tr_b16 a[150:151], v13 offset:2560
    s_waitcnt lgkmcnt(4)
    v_mfma_f32_32x32x16_bf16 v[48:63], a[152:155], a[64:67], v[48:63]
    ds_read_b64_tr_b16 a[152:153], v13 offset:4096
    ds_read_b64_tr_b16 a[154:155], v13 offset:4608
    v_mfma_f32_32x32x16_bf16 v[48:63], a[156:159], a[68:71], v[48:63]
    ds_read_b64_tr_b16 a[156:157], v13 offset:6144
    ds_read_b64_tr_b16 a[158:159], v13 offset:6656
    s_waitcnt lgkmcnt(4)
    v_mfma_f32_32x32x16_bf16 v[32:47], a[144:147], a[72:75], v[32:47]
    ds_read_b64_tr_b16 a[144:145], v13 offset:8192
    ds_read_b64_tr_b16 a[146:147], v13 offset:8704
    s_add_u32 m0, s32, 36864
    s_add_u32 s38, s33, 2654208
    v_add_u32 v18, s38, v15
    v_mfma_f32_32x32x16_bf16 v[32:47], a[148:151], a[76:79], v[32:47]
    ds_read_b64_tr_b16 a[148:149], v13 offset:10240
    ds_read_b64_tr_b16 a[150:151], v13 offset:10752
    v_mov_b32 v132, v148
    v_mov_b32 v133, v149
    s_waitcnt lgkmcnt(4)
    v_mfma_f32_32x32x16_bf16 v[32:47], a[152:155], a[80:83], v[32:47]
    ds_read_b64_tr_b16 a[152:153], v13 offset:12288
    ds_read_b64_tr_b16 a[154:155], v13 offset:12800
    buffer_load_dwordx4 v18, s[12:15], s40 offen offset:0 lds
    v_mov_b32 v134, v150
    v_mfma_f32_32x32x16_bf16 v[32:47], a[156:159], a[84:87], v[32:47]
    ds_read_b64_tr_b16 a[156:157], v13 offset:14336
    ds_read_b64_tr_b16 a[158:159], v13 offset:14848
    v_mov_b32 v135, v151
    v_mov_b32 v136, v152
    s_waitcnt lgkmcnt(4)
    v_mfma_f32_32x32x16_bf16 v[32:47], a[144:147], a[88:91], v[32:47]
    ds_read_b64_tr_b16 a[144:145], v13 offset:16384
    ds_read_b64_tr_b16 a[146:147], v13 offset:16896
    buffer_load_dwordx4 v18, s[12:15], s41 offen offset:1024 lds
    v_mov_b32 v137, v153
    v_mfma_f32_32x32x16_bf16 v[32:47], a[148:151], a[92:95], v[32:47]
    ds_read_b64_tr_b16 a[148:149], v13 offset:18432
    ds_read_b64_tr_b16 a[150:151], v13 offset:18944
    v_mov_b32 v138, v154
    v_mov_b32 v139, v155
    s_waitcnt lgkmcnt(4)
    v_mfma_f32_32x32x16_bf16 v[32:47], a[152:155], a[96:99], v[32:47]
    ds_read_b64_tr_b16 a[152:153], v13 offset:20480
    ds_read_b64_tr_b16 a[154:155], v13 offset:20992
    buffer_load_dwordx4 v18, s[12:15], s42 offen offset:2048 lds
    v_mov_b32 v140, v156
    v_mfma_f32_32x32x16_bf16 v[32:47], a[156:159], a[100:103], v[32:47]
    ds_read_b64_tr_b16 a[156:157], v13 offset:22528
    ds_read_b64_tr_b16 a[158:159], v13 offset:23040
    v_mov_b32 v141, v157
    v_mov_b32 v142, v158
    s_waitcnt lgkmcnt(4)
    v_mfma_f32_32x32x16_bf16 v[32:47], a[144:147], a[104:107], v[32:47]
    ds_read_b64_tr_b16 a[144:145], v13 offset:24576
    ds_read_b64_tr_b16 a[146:147], v13 offset:25088
    buffer_load_dwordx4 v18, s[12:15], s43 offen offset:3072 lds
    s_add_u32 m0, s32, 40960
    v_mfma_f32_32x32x16_bf16 v[32:47], a[148:151], a[108:111], v[32:47]
    ds_read_b64_tr_b16 a[148:149], v13 offset:26624
    ds_read_b64_tr_b16 a[150:151], v13 offset:27136
    v_mov_b32 v143, v159
    v_mov_b32 v144, v160
    s_waitcnt lgkmcnt(4)
    v_mfma_f32_32x32x16_bf16 v[32:47], a[152:155], a[112:115], v[32:47]
    ds_read_b64_tr_b16 a[152:153], v13 offset:28672
    ds_read_b64_tr_b16 a[154:155], v13 offset:29184
    buffer_load_dwordx4 v18, s[12:15], s44 offen offset:0 lds
    v_mov_b32 v145, v161
    v_mfma_f32_32x32x16_bf16 v[32:47], a[156:159], a[116:119], v[32:47]
    ds_read_b64_tr_b16 a[156:157], v13 offset:30720
    ds_read_b64_tr_b16 a[158:159], v13 offset:31232
    v_mov_b32 v146, v162
    v_mov_b32 v147, v163
    s_waitcnt lgkmcnt(4)
    v_mfma_f32_32x32x16_bf16 v[32:47], a[144:147], a[120:123], v[32:47]
    ds_read_b64_tr_b16 a[144:145], v13 offset:32768
    ds_read_b64_tr_b16 a[146:147], v13 offset:33280
    buffer_load_dwordx4 v18, s[12:15], s45 offen offset:1024 lds
    v_mov_b32 v148, v164
    v_mfma_f32_32x32x16_bf16 v[32:47], a[148:151], a[124:127], v[32:47]
    ds_read_b64_tr_b16 a[148:149], v13 offset:34816
    ds_read_b64_tr_b16 a[150:151], v13 offset:35328
    v_mov_b32 v149, v165
    v_mov_b32 v150, v166
    s_waitcnt lgkmcnt(4)
    v_mfma_f32_32x32x16_bf16 v[32:47], a[152:155], a[128:131], v[32:47]
    ds_read_b64_tr_b16 a[152:153], v14 offset:0
    ds_read_b64_tr_b16 a[154:155], v14 offset:512
    buffer_load_dwordx4 v18, s[12:15], s46 offen offset:2048 lds
    v_mov_b32 v151, v167
    v_mfma_f32_32x32x16_bf16 v[32:47], a[156:159], a[132:135], v[32:47]
    ds_read_b64_tr_b16 a[156:157], v14 offset:2048
    ds_read_b64_tr_b16 a[158:159], v14 offset:2560
    s_waitcnt lgkmcnt(4)
    v_mfma_f32_32x32x16_bf16 v[32:47], a[144:147], a[136:139], v[32:47]
    ds_read_b64_tr_b16 a[144:145], v14 offset:4096
    ds_read_b64_tr_b16 a[146:147], v14 offset:4608
    buffer_load_dwordx4 v18, s[12:15], s47 offen offset:3072 lds
    s_add_u32 m0, s32, 45056
    v_mfma_f32_32x32x16_bf16 v[32:47], a[148:151], a[140:143], v[32:47]
    ds_read_b64_tr_b16 a[148:149], v14 offset:6144
    ds_read_b64_tr_b16 a[150:151], v14 offset:6656
    s_waitcnt lgkmcnt(4)
    v_mfma_f32_32x32x16_bf16 v[48:63], a[152:155], a[72:75], v[48:63]
    ds_read_b64_tr_b16 a[152:153], v14 offset:8192
    ds_read_b64_tr_b16 a[154:155], v14 offset:8704
    buffer_load_dwordx4 v18, s[12:15], s48 offen offset:0 lds
    v_mfma_f32_32x32x16_bf16 v[48:63], a[156:159], a[76:79], v[48:63]
    ds_read_b64_tr_b16 a[156:157], v14 offset:10240
    ds_read_b64_tr_b16 a[158:159], v14 offset:10752
    s_waitcnt lgkmcnt(4)
    v_mfma_f32_32x32x16_bf16 v[48:63], a[144:147], a[80:83], v[48:63]
    ds_read_b64_tr_b16 a[144:145], v14 offset:12288
    ds_read_b64_tr_b16 a[146:147], v14 offset:12800
    v_mul_f32 v20, s39, v32
    v_mul_f32 v21, s39, v33
    v_mul_f32 v22, s39, v34
    v_mul_f32 v23, s39, v35
    v_mfma_f32_32x32x16_bf16 v[48:63], a[148:151], a[84:87], v[48:63]
    ds_read_b64_tr_b16 a[148:149], v14 offset:14336
    ds_read_b64_tr_b16 a[150:151], v14 offset:14848
    v_exp_f32 v20, v20
    v_exp_f32 v21, v21
    s_waitcnt lgkmcnt(4)
    v_mfma_f32_32x32x16_bf16 v[48:63], a[152:155], a[88:91], v[48:63]
    ds_read_b64_tr_b16 a[152:153], v14 offset:16384
    ds_read_b64_tr_b16 a[154:155], v14 offset:16896
    v_exp_f32 v22, v22
    v_exp_f32 v23, v23
    v_mfma_f32_32x32x16_bf16 v[48:63], a[156:159], a[92:95], v[48:63]
    ds_read_b64_tr_b16 a[156:157], v14 offset:18432
    ds_read_b64_tr_b16 a[158:159], v14 offset:18944
    v_add_f32 v20, 1.0, v20
    v_add_f32 v21, 1.0, v21
    v_add_f32 v22, 1.0, v22
    v_add_f32 v23, 1.0, v23
    s_waitcnt lgkmcnt(4)
    v_mfma_f32_32x32x16_bf16 v[48:63], a[144:147], a[96:99], v[48:63]
    ds_read_b64_tr_b16 a[144:145], v14 offset:20480
    ds_read_b64_tr_b16 a[146:147], v14 offset:20992
    v_rcp_f32 v20, v20
    v_rcp_f32 v21, v21
    v_mfma_f32_32x32x16_bf16 v[48:63], a[148:151], a[100:103], v[48:63]
    ds_read_b64_tr_b16 a[148:149], v14 offset:22528
    ds_read_b64_tr_b16 a[150:151], v14 offset:23040
    v_rcp_f32 v22, v22
    v_rcp_f32 v23, v23
    s_waitcnt lgkmcnt(4)
    v_mfma_f32_32x32x16_bf16 v[48:63], a[152:155], a[104:107], v[48:63]
    ds_read_b64_tr_b16 a[152:153], v14 offset:24576
    ds_read_b64_tr_b16 a[154:155], v14 offset:25088
    v_mul_f32 v32, v32, v20
    v_mul_f32 v33, v33, v21
    v_mul_f32 v34, v34, v22
    v_mul_f32 v35, v35, v23
    v_mfma_f32_32x32x16_bf16 v[48:63], a[156:159], a[108:111], v[48:63]
    ds_read_b64_tr_b16 a[156:157], v14 offset:26624
    ds_read_b64_tr_b16 a[158:159], v14 offset:27136
    v_mul_f32 v20, s39, v36
    v_mul_f32 v21, s39, v37
    v_mul_f32 v22, s39, v38
    v_mul_f32 v23, s39, v39
    s_waitcnt lgkmcnt(4)
    v_mfma_f32_32x32x16_bf16 v[48:63], a[144:147], a[112:115], v[48:63]
    ds_read_b64_tr_b16 a[144:145], v14 offset:28672
    ds_read_b64_tr_b16 a[146:147], v14 offset:29184
    v_exp_f32 v20, v20
    v_exp_f32 v21, v21
    v_mfma_f32_32x32x16_bf16 v[48:63], a[148:151], a[116:119], v[48:63]
    ds_read_b64_tr_b16 a[148:149], v14 offset:30720
    ds_read_b64_tr_b16 a[150:151], v14 offset:31232
    v_exp_f32 v22, v22
    v_exp_f32 v23, v23
    s_waitcnt lgkmcnt(4)
    v_mfma_f32_32x32x16_bf16 v[48:63], a[152:155], a[120:123], v[48:63]
    ds_read_b64_tr_b16 a[152:153], v14 offset:32768
    ds_read_b64_tr_b16 a[154:155], v14 offset:33280
    v_add_f32 v20, 1.0, v20
    v_add_f32 v21, 1.0, v21
    v_add_f32 v22, 1.0, v22
    v_add_f32 v23, 1.0, v23
    v_mfma_f32_32x32x16_bf16 v[48:63], a[156:159], a[124:127], v[48:63]
    ds_read_b64_tr_b16 a[156:157], v14 offset:34816
    ds_read_b64_tr_b16 a[158:159], v14 offset:35328
    v_rcp_f32 v20, v20
    v_rcp_f32 v21, v21
    s_waitcnt lgkmcnt(4)
    v_mfma_f32_32x32x16_bf16 v[48:63], a[144:147], a[128:131], v[48:63]
    s_waitcnt vmcnt(9)
    s_barrier
    v_add_u32 v13, 0, v10
    v_add_u32 v14, 0, v11
    ds_read_b64_tr_b16 a[144:145], v13 offset:0
    ds_read_b64_tr_b16 a[146:147], v13 offset:512
    v_mfma_f32_32x32x16_bf16 v[48:63], a[148:151], a[132:135], v[48:63]
    ds_read_b64_tr_b16 a[148:149], v13 offset:2048
    ds_read_b64_tr_b16 a[150:151], v13 offset:2560
    v_rcp_f32 v22, v22
    v_rcp_f32 v23, v23
    s_waitcnt lgkmcnt(4)
    v_mfma_f32_32x32x16_bf16 v[48:63], a[152:155], a[136:139], v[48:63]
    ds_read_b64_tr_b16 a[152:153], v13 offset:4096
    ds_read_b64_tr_b16 a[154:155], v13 offset:4608
    v_mul_f32 v36, v36, v20
    v_mul_f32 v37, v37, v21
    v_mul_f32 v38, v38, v22
    v_mul_f32 v39, v39, v23
    v_mfma_f32_32x32x16_bf16 v[48:63], a[156:159], a[140:143], v[48:63]
    ds_read_b64_tr_b16 a[156:157], v13 offset:6144
    ds_read_b64_tr_b16 a[158:159], v13 offset:6656
    s_waitcnt lgkmcnt(4)
    v_mfma_f32_32x32x16_bf16 v[64:79], a[144:147], a[0:3], 0
    ds_read_b64_tr_b16 a[144:145], v13 offset:8192
    ds_read_b64_tr_b16 a[146:147], v13 offset:8704
    s_add_u32 m0, s32, 73728
    v_add_u32 v18, s76, v9
    v_mul_f32 v20, s39, v40
    v_mul_f32 v21, s39, v41
    v_mfma_f32_32x32x16_bf16 v[64:79], a[148:151], a[4:7], v[64:79]
    ds_read_b64_tr_b16 a[148:149], v13 offset:10240
    ds_read_b64_tr_b16 a[150:151], v13 offset:10752
    v_mul_f32 v22, s39, v42
    v_mul_f32 v23, s39, v43
    v_exp_f32 v20, v20
    s_waitcnt lgkmcnt(4)
    v_mfma_f32_32x32x16_bf16 v[64:79], a[152:155], a[8:11], v[64:79]
    ds_read_b64_tr_b16 a[152:153], v13 offset:12288
    ds_read_b64_tr_b16 a[154:155], v13 offset:12800
    buffer_load_dwordx4 v18, s[24:27], s60 offen offset:0 lds
    v_exp_f32 v21, v21
    v_mfma_f32_32x32x16_bf16 v[64:79], a[156:159], a[12:15], v[64:79]
    ds_read_b64_tr_b16 a[156:157], v13 offset:14336
    ds_read_b64_tr_b16 a[158:159], v13 offset:14848
    v_exp_f32 v22, v22
    v_exp_f32 v23, v23
    s_waitcnt lgkmcnt(4)
    v_mfma_f32_32x32x16_bf16 v[64:79], a[144:147], a[16:19], v[64:79]
    ds_read_b64_tr_b16 a[144:145], v13 offset:16384
    ds_read_b64_tr_b16 a[146:147], v13 offset:16896
    buffer_load_dwordx4 v18, s[24:27], s61 offen offset:1024 lds
    v_add_f32 v20, 1.0, v20
    v_add_f32 v21, 1.0, v21
    v_add_f32 v22, 1.0, v22
    v_mfma_f32_32x32x16_bf16 v[64:79], a[148:151], a[20:23], v[64:79]
    ds_read_b64_tr_b16 a[148:149], v13 offset:18432
    ds_read_b64_tr_b16 a[150:151], v13 offset:18944
    v_add_f32 v23, 1.0, v23
    v_rcp_f32 v20, v20
    s_waitcnt lgkmcnt(4)
    v_mfma_f32_32x32x16_bf16 v[64:79], a[152:155], a[24:27], v[64:79]
    ds_read_b64_tr_b16 a[152:153], v13 offset:20480
    ds_read_b64_tr_b16 a[154:155], v13 offset:20992
    buffer_load_dwordx4 v18, s[24:27], s62 offen offset:2048 lds
    v_rcp_f32 v21, v21
    v_mfma_f32_32x32x16_bf16 v[64:79], a[156:159], a[28:31], v[64:79]
    ds_read_b64_tr_b16 a[156:157], v13 offset:22528
    ds_read_b64_tr_b16 a[158:159], v13 offset:23040
    v_rcp_f32 v22, v22
    v_rcp_f32 v23, v23
    s_waitcnt lgkmcnt(4)
    v_mfma_f32_32x32x16_bf16 v[64:79], a[144:147], a[32:35], v[64:79]
    ds_read_b64_tr_b16 a[144:145], v13 offset:24576
    ds_read_b64_tr_b16 a[146:147], v13 offset:25088
    buffer_load_dwordx4 v18, s[24:27], s63 offen offset:3072 lds
    s_add_u32 m0, s32, 77824
    v_mul_f32 v40, v40, v20
    v_mul_f32 v41, v41, v21
    v_mfma_f32_32x32x16_bf16 v[64:79], a[148:151], a[36:39], v[64:79]
    ds_read_b64_tr_b16 a[148:149], v13 offset:26624
    ds_read_b64_tr_b16 a[150:151], v13 offset:27136
    v_mul_f32 v42, v42, v22
    v_mul_f32 v43, v43, v23
    v_mul_f32 v20, s39, v44
    v_mul_f32 v21, s39, v45
    s_waitcnt lgkmcnt(4)
    v_mfma_f32_32x32x16_bf16 v[64:79], a[152:155], a[40:43], v[64:79]
    ds_read_b64_tr_b16 a[152:153], v13 offset:28672
    ds_read_b64_tr_b16 a[154:155], v13 offset:29184
    buffer_load_dwordx4 v18, s[24:27], s64 offen offset:0 lds
    v_mul_f32 v22, s39, v46
    v_mul_f32 v23, s39, v47
    v_mfma_f32_32x32x16_bf16 v[64:79], a[156:159], a[44:47], v[64:79]
    ds_read_b64_tr_b16 a[156:157], v13 offset:30720
    ds_read_b64_tr_b16 a[158:159], v13 offset:31232
    v_exp_f32 v20, v20
    v_exp_f32 v21, v21
    s_waitcnt lgkmcnt(4)
    v_mfma_f32_32x32x16_bf16 v[64:79], a[144:147], a[48:51], v[64:79]
    ds_read_b64_tr_b16 a[144:145], v13 offset:32768
    ds_read_b64_tr_b16 a[146:147], v13 offset:33280
    buffer_load_dwordx4 v18, s[24:27], s65 offen offset:1024 lds
    v_exp_f32 v22, v22
    v_mfma_f32_32x32x16_bf16 v[64:79], a[148:151], a[52:55], v[64:79]
    ds_read_b64_tr_b16 a[148:149], v13 offset:34816
    ds_read_b64_tr_b16 a[150:151], v13 offset:35328
    v_exp_f32 v23, v23
    v_add_f32 v20, 1.0, v20
    v_add_f32 v21, 1.0, v21
    s_waitcnt lgkmcnt(4)
    v_mfma_f32_32x32x16_bf16 v[64:79], a[152:155], a[56:59], v[64:79]
    ds_read_b64_tr_b16 a[152:153], v14 offset:0
    ds_read_b64_tr_b16 a[154:155], v14 offset:512
    buffer_load_dwordx4 v18, s[24:27], s66 offen offset:2048 lds
    v_add_f32 v22, 1.0, v22
    v_add_f32 v23, 1.0, v23
    v_mfma_f32_32x32x16_bf16 v[64:79], a[156:159], a[60:63], v[64:79]
    ds_read_b64_tr_b16 a[156:157], v14 offset:2048
    ds_read_b64_tr_b16 a[158:159], v14 offset:2560
    v_rcp_f32 v20, v20
    v_rcp_f32 v21, v21
    s_waitcnt lgkmcnt(4)
    v_mfma_f32_32x32x16_bf16 v[64:79], a[144:147], a[64:67], v[64:79]
    ds_read_b64_tr_b16 a[144:145], v14 offset:4096
    ds_read_b64_tr_b16 a[146:147], v14 offset:4608
    buffer_load_dwordx4 v18, s[24:27], s67 offen offset:3072 lds
    s_add_u32 m0, s32, 81920
    v_rcp_f32 v22, v22
    v_mfma_f32_32x32x16_bf16 v[64:79], a[148:151], a[68:71], v[64:79]
    ds_read_b64_tr_b16 a[148:149], v14 offset:6144
    ds_read_b64_tr_b16 a[150:151], v14 offset:6656
    v_rcp_f32 v23, v23
    v_mul_f32 v44, v44, v20
    v_mul_f32 v45, v45, v21
    s_waitcnt lgkmcnt(4)
    v_mfma_f32_32x32x16_bf16 v[80:95], a[152:155], a[0:3], 0
    ds_read_b64_tr_b16 a[152:153], v14 offset:8192
    ds_read_b64_tr_b16 a[154:155], v14 offset:8704
    buffer_load_dwordx4 v18, s[24:27], s68 offen offset:0 lds
    v_mul_f32 v46, v46, v22
    v_mul_f32 v47, v47, v23
    v_mul_f32 v24, s39, v48
    v_mfma_f32_32x32x16_bf16 v[80:95], a[156:159], a[4:7], v[80:95]
    ds_read_b64_tr_b16 a[156:157], v14 offset:10240
    ds_read_b64_tr_b16 a[158:159], v14 offset:10752
    v_mul_f32 v25, s39, v49
    v_mul_f32 v26, s39, v50
    v_mul_f32 v27, s39, v51
    s_waitcnt lgkmcnt(4)
    v_mfma_f32_32x32x16_bf16 v[80:95], a[144:147], a[8:11], v[80:95]
    ds_read_b64_tr_b16 a[144:145], v14 offset:12288
    ds_read_b64_tr_b16 a[146:147], v14 offset:12800
    v_exp_f32 v24, v24
    v_exp_f32 v25, v25
    v_mfma_f32_32x32x16_bf16 v[80:95], a[148:151], a[12:15], v[80:95]
    ds_read_b64_tr_b16 a[148:149], v14 offset:14336
    ds_read_b64_tr_b16 a[150:151], v14 offset:14848
    v_exp_f32 v26, v26
    v_exp_f32 v27, v27
    s_waitcnt lgkmcnt(4)
    v_mfma_f32_32x32x16_bf16 v[80:95], a[152:155], a[16:19], v[80:95]
    ds_read_b64_tr_b16 a[152:153], v14 offset:16384
    ds_read_b64_tr_b16 a[154:155], v14 offset:16896
    v_add_f32 v24, 1.0, v24
    v_add_f32 v25, 1.0, v25
    v_add_f32 v26, 1.0, v26
    v_add_f32 v27, 1.0, v27
    v_mfma_f32_32x32x16_bf16 v[80:95], a[156:159], a[20:23], v[80:95]
    ds_read_b64_tr_b16 a[156:157], v14 offset:18432
    ds_read_b64_tr_b16 a[158:159], v14 offset:18944
    v_rcp_f32 v24, v24
    v_rcp_f32 v25, v25
    s_waitcnt lgkmcnt(4)
    v_mfma_f32_32x32x16_bf16 v[80:95], a[144:147], a[24:27], v[80:95]
    ds_read_b64_tr_b16 a[144:145], v14 offset:20480
    ds_read_b64_tr_b16 a[146:147], v14 offset:20992
    v_rcp_f32 v26, v26
    v_rcp_f32 v27, v27
    v_mfma_f32_32x32x16_bf16 v[80:95], a[148:151], a[28:31], v[80:95]
    ds_read_b64_tr_b16 a[148:149], v14 offset:22528
    ds_read_b64_tr_b16 a[150:151], v14 offset:23040
    v_mul_f32 v48, v48, v24
    v_mul_f32 v49, v49, v25
    v_mul_f32 v50, v50, v26
    v_mul_f32 v51, v51, v27
    s_waitcnt lgkmcnt(4)
    v_mfma_f32_32x32x16_bf16 v[80:95], a[152:155], a[32:35], v[80:95]
    ds_read_b64_tr_b16 a[152:153], v14 offset:24576
    ds_read_b64_tr_b16 a[154:155], v14 offset:25088
    v_mul_f32 v24, s39, v52
    v_mul_f32 v25, s39, v53
    v_mul_f32 v26, s39, v54
    v_mul_f32 v27, s39, v55
    v_mfma_f32_32x32x16_bf16 v[80:95], a[156:159], a[36:39], v[80:95]
    ds_read_b64_tr_b16 a[156:157], v14 offset:26624
    ds_read_b64_tr_b16 a[158:159], v14 offset:27136
    v_exp_f32 v24, v24
    v_exp_f32 v25, v25
    s_waitcnt lgkmcnt(4)
    v_mfma_f32_32x32x16_bf16 v[80:95], a[144:147], a[40:43], v[80:95]
    ds_read_b64_tr_b16 a[144:145], v14 offset:28672
    ds_read_b64_tr_b16 a[146:147], v14 offset:29184
    v_exp_f32 v26, v26
    v_exp_f32 v27, v27
    v_mfma_f32_32x32x16_bf16 v[80:95], a[148:151], a[44:47], v[80:95]
    ds_read_b64_tr_b16 a[148:149], v14 offset:30720
    ds_read_b64_tr_b16 a[150:151], v14 offset:31232
    v_add_f32 v24, 1.0, v24
    v_add_f32 v25, 1.0, v25
    v_add_f32 v26, 1.0, v26
    v_add_f32 v27, 1.0, v27
    s_waitcnt lgkmcnt(4)
    v_mfma_f32_32x32x16_bf16 v[80:95], a[152:155], a[48:51], v[80:95]
    ds_read_b64_tr_b16 a[152:153], v14 offset:32768
    ds_read_b64_tr_b16 a[154:155], v14 offset:33280
    v_rcp_f32 v24, v24
    v_rcp_f32 v25, v25
    v_mfma_f32_32x32x16_bf16 v[80:95], a[156:159], a[52:55], v[80:95]
    ds_read_b64_tr_b16 a[156:157], v14 offset:34816
    ds_read_b64_tr_b16 a[158:159], v14 offset:35328
    v_rcp_f32 v26, v26
    v_rcp_f32 v27, v27
    s_waitcnt lgkmcnt(4)
    v_mfma_f32_32x32x16_bf16 v[80:95], a[144:147], a[56:59], v[80:95]
    s_waitcnt vmcnt(9)
    s_barrier
    v_add_u32 v13, 36864, v10
    v_add_u32 v14, 36864, v11
    ds_read_b64_tr_b16 a[144:145], v13 offset:0
    ds_read_b64_tr_b16 a[146:147], v13 offset:512
    v_mul_f32 v52, v52, v24
    v_mfma_f32_32x32x16_bf16 v[80:95], a[148:151], a[60:63], v[80:95]
    ds_read_b64_tr_b16 a[148:149], v13 offset:2048
    ds_read_b64_tr_b16 a[150:151], v13 offset:2560
    v_mul_f32 v53, v53, v25
    v_mul_f32 v54, v54, v26
    v_mul_f32 v55, v55, v27
    s_waitcnt lgkmcnt(4)
    v_mfma_f32_32x32x16_bf16 v[80:95], a[152:155], a[64:67], v[80:95]
    ds_read_b64_tr_b16 a[152:153], v13 offset:4096
    ds_read_b64_tr_b16 a[154:155], v13 offset:4608
    v_mfma_f32_32x32x16_bf16 v[80:95], a[156:159], a[68:71], v[80:95]
    ds_read_b64_tr_b16 a[156:157], v13 offset:6144
    ds_read_b64_tr_b16 a[158:159], v13 offset:6656
    s_waitcnt lgkmcnt(4)
    v_mfma_f32_32x32x16_bf16 v[64:79], a[144:147], a[72:75], v[64:79]
    ds_read_b64_tr_b16 a[144:145], v13 offset:8192
    ds_read_b64_tr_b16 a[146:147], v13 offset:8704
    s_add_u32 m0, s32, 110592
    v_add_u32 v18, s77, v9
    v_mul_f32 v24, s39, v56
    v_mul_f32 v25, s39, v57
    v_mfma_f32_32x32x16_bf16 v[64:79], a[148:151], a[76:79], v[64:79]
    ds_read_b64_tr_b16 a[148:149], v13 offset:10240
    ds_read_b64_tr_b16 a[150:151], v13 offset:10752
    v_mul_f32 v26, s39, v58
    v_mul_f32 v27, s39, v59
    v_exp_f32 v24, v24
    s_waitcnt lgkmcnt(4)
    v_mfma_f32_32x32x16_bf16 v[64:79], a[152:155], a[80:83], v[64:79]
    ds_read_b64_tr_b16 a[152:153], v13 offset:12288
    ds_read_b64_tr_b16 a[154:155], v13 offset:12800
    buffer_load_dwordx4 v18, s[24:27], s60 offen offset:0 lds
    v_exp_f32 v25, v25
    v_mfma_f32_32x32x16_bf16 v[64:79], a[156:159], a[84:87], v[64:79]
    ds_read_b64_tr_b16 a[156:157], v13 offset:14336
    ds_read_b64_tr_b16 a[158:159], v13 offset:14848
    v_exp_f32 v26, v26
    v_exp_f32 v27, v27
    s_waitcnt lgkmcnt(4)
    v_mfma_f32_32x32x16_bf16 v[64:79], a[144:147], a[88:91], v[64:79]
    ds_read_b64_tr_b16 a[144:145], v13 offset:16384
    ds_read_b64_tr_b16 a[146:147], v13 offset:16896
    buffer_load_dwordx4 v18, s[24:27], s61 offen offset:1024 lds
    v_add_f32 v24, 1.0, v24
    v_add_f32 v25, 1.0, v25
    v_add_f32 v26, 1.0, v26
    v_mfma_f32_32x32x16_bf16 v[64:79], a[148:151], a[92:95], v[64:79]
    ds_read_b64_tr_b16 a[148:149], v13 offset:18432
    ds_read_b64_tr_b16 a[150:151], v13 offset:18944
    v_add_f32 v27, 1.0, v27
    v_rcp_f32 v24, v24
    s_waitcnt lgkmcnt(4)
    v_mfma_f32_32x32x16_bf16 v[64:79], a[152:155], a[96:99], v[64:79]
    ds_read_b64_tr_b16 a[152:153], v13 offset:20480
    ds_read_b64_tr_b16 a[154:155], v13 offset:20992
    buffer_load_dwordx4 v18, s[24:27], s62 offen offset:2048 lds
    v_rcp_f32 v25, v25
    v_mfma_f32_32x32x16_bf16 v[64:79], a[156:159], a[100:103], v[64:79]
    ds_read_b64_tr_b16 a[156:157], v13 offset:22528
    ds_read_b64_tr_b16 a[158:159], v13 offset:23040
    v_rcp_f32 v26, v26
    v_rcp_f32 v27, v27
    s_waitcnt lgkmcnt(4)
    v_mfma_f32_32x32x16_bf16 v[64:79], a[144:147], a[104:107], v[64:79]
    ds_read_b64_tr_b16 a[144:145], v13 offset:24576
    ds_read_b64_tr_b16 a[146:147], v13 offset:25088
    buffer_load_dwordx4 v18, s[24:27], s63 offen offset:3072 lds
    s_add_u32 m0, s32, 114688
    v_mul_f32 v56, v56, v24
    v_mul_f32 v57, v57, v25
    v_mfma_f32_32x32x16_bf16 v[64:79], a[148:151], a[108:111], v[64:79]
    ds_read_b64_tr_b16 a[148:149], v13 offset:26624
    ds_read_b64_tr_b16 a[150:151], v13 offset:27136
    v_mul_f32 v58, v58, v26
    v_mul_f32 v59, v59, v27
    v_mul_f32 v24, s39, v60
    v_mul_f32 v25, s39, v61
    s_waitcnt lgkmcnt(4)
    v_mfma_f32_32x32x16_bf16 v[64:79], a[152:155], a[112:115], v[64:79]
    ds_read_b64_tr_b16 a[152:153], v13 offset:28672
    ds_read_b64_tr_b16 a[154:155], v13 offset:29184
    buffer_load_dwordx4 v18, s[24:27], s64 offen offset:0 lds
    v_mul_f32 v26, s39, v62
    v_mul_f32 v27, s39, v63
    v_mfma_f32_32x32x16_bf16 v[64:79], a[156:159], a[116:119], v[64:79]
    ds_read_b64_tr_b16 a[156:157], v13 offset:30720
    ds_read_b64_tr_b16 a[158:159], v13 offset:31232
    v_exp_f32 v24, v24
    v_exp_f32 v25, v25
    s_waitcnt lgkmcnt(4)
    v_mfma_f32_32x32x16_bf16 v[64:79], a[144:147], a[120:123], v[64:79]
    ds_read_b64_tr_b16 a[144:145], v13 offset:32768
    ds_read_b64_tr_b16 a[146:147], v13 offset:33280
    buffer_load_dwordx4 v18, s[24:27], s65 offen offset:1024 lds
    v_exp_f32 v26, v26
    v_mfma_f32_32x32x16_bf16 v[64:79], a[148:151], a[124:127], v[64:79]
    ds_read_b64_tr_b16 a[148:149], v13 offset:34816
    ds_read_b64_tr_b16 a[150:151], v13 offset:35328
    v_exp_f32 v27, v27
    v_add_f32 v24, 1.0, v24
    v_add_f32 v25, 1.0, v25
    s_waitcnt lgkmcnt(4)
    v_mfma_f32_32x32x16_bf16 v[64:79], a[152:155], a[128:131], v[64:79]
    ds_read_b64_tr_b16 a[152:153], v14 offset:0
    ds_read_b64_tr_b16 a[154:155], v14 offset:512
    buffer_load_dwordx4 v18, s[24:27], s66 offen offset:2048 lds
    v_add_f32 v26, 1.0, v26
    v_add_f32 v27, 1.0, v27
    v_mfma_f32_32x32x16_bf16 v[64:79], a[156:159], a[132:135], v[64:79]
    ds_read_b64_tr_b16 a[156:157], v14 offset:2048
    ds_read_b64_tr_b16 a[158:159], v14 offset:2560
    v_rcp_f32 v24, v24
    v_rcp_f32 v25, v25
    s_waitcnt lgkmcnt(4)
    v_mfma_f32_32x32x16_bf16 v[64:79], a[144:147], a[136:139], v[64:79]
    ds_read_b64_tr_b16 a[144:145], v14 offset:4096
    ds_read_b64_tr_b16 a[146:147], v14 offset:4608
    buffer_load_dwordx4 v18, s[24:27], s67 offen offset:3072 lds
    s_add_u32 m0, s32, 118784
    v_rcp_f32 v26, v26
    v_mfma_f32_32x32x16_bf16 v[64:79], a[148:151], a[140:143], v[64:79]
    ds_read_b64_tr_b16 a[148:149], v14 offset:6144
    ds_read_b64_tr_b16 a[150:151], v14 offset:6656
    v_rcp_f32 v27, v27
    v_mul_f32 v60, v60, v24
    v_mul_f32 v61, v61, v25
    s_waitcnt lgkmcnt(4)
    v_mfma_f32_32x32x16_bf16 v[80:95], a[152:155], a[72:75], v[80:95]
    ds_read_b64_tr_b16 a[152:153], v14 offset:8192
    ds_read_b64_tr_b16 a[154:155], v14 offset:8704
    buffer_load_dwordx4 v18, s[24:27], s68 offen offset:0 lds
    v_mul_f32 v62, v62, v26
    v_mul_f32 v63, v63, v27
    v_mfma_f32_32x32x16_bf16 v[80:95], a[156:159], a[76:79], v[80:95]
    ds_read_b64_tr_b16 a[156:157], v14 offset:10240
    ds_read_b64_tr_b16 a[158:159], v14 offset:10752
    s_waitcnt lgkmcnt(4)
    v_mfma_f32_32x32x16_bf16 v[80:95], a[144:147], a[80:83], v[80:95]
    ds_read_b64_tr_b16 a[144:145], v14 offset:12288
    ds_read_b64_tr_b16 a[146:147], v14 offset:12800
    v_mul_f32 v32, v32, v64
    v_mul_f32 v33, v33, v65
    v_mfma_f32_32x32x16_bf16 v[80:95], a[148:151], a[84:87], v[80:95]
    ds_read_b64_tr_b16 a[148:149], v14 offset:14336
    ds_read_b64_tr_b16 a[150:151], v14 offset:14848
    v_mul_f32 v34, v34, v66
    v_mul_f32 v35, v35, v67
    s_waitcnt lgkmcnt(4)
    v_mfma_f32_32x32x16_bf16 v[80:95], a[152:155], a[88:91], v[80:95]
    ds_read_b64_tr_b16 a[152:153], v14 offset:16384
    ds_read_b64_tr_b16 a[154:155], v14 offset:16896
    v_cvt_pk_bf16_f32 v152, v32, v33
    v_cvt_pk_bf16_f32 v153, v34, v35
    v_mfma_f32_32x32x16_bf16 v[80:95], a[156:159], a[92:95], v[80:95]
    ds_read_b64_tr_b16 a[156:157], v14 offset:18432
    ds_read_b64_tr_b16 a[158:159], v14 offset:18944
    v_mul_f32 v36, v36, v68
    v_mul_f32 v37, v37, v69
    s_waitcnt lgkmcnt(4)
    v_mfma_f32_32x32x16_bf16 v[80:95], a[144:147], a[96:99], v[80:95]
    ds_read_b64_tr_b16 a[144:145], v14 offset:20480
    ds_read_b64_tr_b16 a[146:147], v14 offset:20992
    v_mul_f32 v38, v38, v70
    v_mul_f32 v39, v39, v71
    v_mfma_f32_32x32x16_bf16 v[80:95], a[148:151], a[100:103], v[80:95]
    ds_read_b64_tr_b16 a[148:149], v14 offset:22528
    ds_read_b64_tr_b16 a[150:151], v14 offset:23040
    v_cvt_pk_bf16_f32 v154, v36, v37
    v_cvt_pk_bf16_f32 v155, v38, v39
    s_waitcnt lgkmcnt(4)
    v_mfma_f32_32x32x16_bf16 v[80:95], a[152:155], a[104:107], v[80:95]
    ds_read_b64_tr_b16 a[152:153], v14 offset:24576
    ds_read_b64_tr_b16 a[154:155], v14 offset:25088
    v_mul_f32 v40, v40, v72
    v_mul_f32 v41, v41, v73
    v_mfma_f32_32x32x16_bf16 v[80:95], a[156:159], a[108:111], v[80:95]
    ds_read_b64_tr_b16 a[156:157], v14 offset:26624
    ds_read_b64_tr_b16 a[158:159], v14 offset:27136
    v_mul_f32 v42, v42, v74
    v_mul_f32 v43, v43, v75
    s_waitcnt lgkmcnt(4)
    v_mfma_f32_32x32x16_bf16 v[80:95], a[144:147], a[112:115], v[80:95]
    ds_read_b64_tr_b16 a[144:145], v14 offset:28672
    ds_read_b64_tr_b16 a[146:147], v14 offset:29184
    v_cvt_pk_bf16_f32 v156, v40, v41
    v_cvt_pk_bf16_f32 v157, v42, v43
    v_mfma_f32_32x32x16_bf16 v[80:95], a[148:151], a[116:119], v[80:95]
    ds_read_b64_tr_b16 a[148:149], v14 offset:30720
    ds_read_b64_tr_b16 a[150:151], v14 offset:31232
    v_mul_f32 v44, v44, v76
    v_mul_f32 v45, v45, v77
    s_waitcnt lgkmcnt(4)
    v_mfma_f32_32x32x16_bf16 v[80:95], a[152:155], a[120:123], v[80:95]
    ds_read_b64_tr_b16 a[152:153], v14 offset:32768
    ds_read_b64_tr_b16 a[154:155], v14 offset:33280
    v_mul_f32 v46, v46, v78
    v_mul_f32 v47, v47, v79
    v_mfma_f32_32x32x16_bf16 v[80:95], a[156:159], a[124:127], v[80:95]
    ds_read_b64_tr_b16 a[156:157], v14 offset:34816
    ds_read_b64_tr_b16 a[158:159], v14 offset:35328
    v_cvt_pk_bf16_f32 v158, v44, v45
    v_cvt_pk_bf16_f32 v159, v46, v47
    s_waitcnt lgkmcnt(4)
    v_mfma_f32_32x32x16_bf16 v[80:95], a[144:147], a[128:131], v[80:95]
    s_waitcnt vmcnt(9)
    s_barrier
    v_add_u32 v13, 73728, v10
    v_add_u32 v14, 73728, v11
    ds_read_b64_tr_b16 a[144:145], v13 offset:0
    ds_read_b64_tr_b16 a[146:147], v13 offset:512
    v_mfma_f32_32x32x16_bf16 v[80:95], a[148:151], a[132:135], v[80:95]
    ds_read_b64_tr_b16 a[148:149], v13 offset:2048
    ds_read_b64_tr_b16 a[150:151], v13 offset:2560
    s_waitcnt lgkmcnt(4)
    v_mfma_f32_32x32x16_bf16 v[80:95], a[152:155], a[136:139], v[80:95]
    ds_read_b64_tr_b16 a[152:153], v13 offset:4096
    ds_read_b64_tr_b16 a[154:155], v13 offset:4608
    v_mfma_f32_32x32x16_bf16 v[80:95], a[156:159], a[140:143], v[80:95]
    ds_read_b64_tr_b16 a[156:157], v13 offset:6144
    ds_read_b64_tr_b16 a[158:159], v13 offset:6656
    s_add_u32 s33, s33, 128
    s_add_u32 s35, s35, 1
    s_cmp_lt_u32 s35, 4
    s_cbranch_scc1 mega_kernel_ffn_l1
    s_nop 5
    v_mul_f32 v48, v48, v80
    v_mul_f32 v49, v49, v81
    v_mul_f32 v50, v50, v82
    v_mul_f32 v51, v51, v83
    v_cvt_pk_bf16_f32 v160, v48, v49
    v_cvt_pk_bf16_f32 v161, v50, v51
    v_mul_f32 v52, v52, v84
    v_mul_f32 v53, v53, v85
    v_mul_f32 v54, v54, v86
    v_mul_f32 v55, v55, v87
    v_cvt_pk_bf16_f32 v162, v52, v53
    v_cvt_pk_bf16_f32 v163, v54, v55
    v_mul_f32 v56, v56, v88
    v_mul_f32 v57, v57, v89
    v_mul_f32 v58, v58, v90
    v_mul_f32 v59, v59, v91
    v_cvt_pk_bf16_f32 v164, v56, v57
    v_cvt_pk_bf16_f32 v165, v58, v59
    v_mul_f32 v60, v60, v92
    v_mul_f32 v61, v61, v93
    v_mul_f32 v62, v62, v94
    v_mul_f32 v63, v63, v95
    v_cvt_pk_bf16_f32 v166, v60, v61
    v_cvt_pk_bf16_f32 v167, v62, v63
    s_mov_b32 s35, 0
    s_mov_b32 s72, 110592
    s_mov_b32 s73, 0
    s_mov_b32 s74, 256
    s_mov_b32 s71, 0x7ff00000
    v_and_b32 v8, 31, v0
    v_lshlrev_b32 v8, 7, v8
    s_lshr_b32 s36, s29, 2
    s_cmp_eq_u32 s36, s28
    s_cselect_b32 s36, 2, 100
    s_mov_b32 s37, 0x7ff00000
    buffer_load_dword v7, v8, s[20:23], s37 offen
mega_kernel_ffn_down:
    s_add_u32 s78, s32, s73
    s_cmp_lt_u32 s35, 7
    s_cselect_b32 s18, 0x510000, 0
    s_waitcnt lgkmcnt(4)
    v_mfma_f32_32x32x16_bf16 v[32:47], a[144:147], v[96:99], 0
    ds_read_b64_tr_b16 a[144:145], v13 offset:8192
    ds_read_b64_tr_b16 a[146:147], v13 offset:8704
    s_add_u32 m0, s78, 0
    v_add_u32 v18, s74, v17
    v_mfma_f32_32x32x16_bf16 v[32:47], a[148:151], v[100:103], v[32:47]
    ds_read_b64_tr_b16 a[148:149], v13 offset:10240
    ds_read_b64_tr_b16 a[150:151], v13 offset:10752
    s_waitcnt lgkmcnt(4)
    v_mfma_f32_32x32x16_bf16 v[32:47], a[152:155], v[104:107], v[32:47]
    ds_read_b64_tr_b16 a[152:153], v13 offset:12288
    ds_read_b64_tr_b16 a[154:155], v13 offset:12800
    buffer_load_dwordx4 v18, s[16:19], s50 offen offset:0 lds
    v_mfma_f32_32x32x16_bf16 v[32:47], a[156:159], v[108:111], v[32:47]
    ds_read_b64_tr_b16 a[156:157], v13 offset:14336
    ds_read_b64_tr_b16 a[158:159], v13 offset:14848
    v_cvt_pk_bf16_f32 v176, v48, v49
    s_waitcnt lgkmcnt(4)
    v_mfma_f32_32x32x16_bf16 v[32:47], a[144:147], v[112:115], v[32:47]
    ds_read_b64_tr_b16 a[144:145], v13 offset:16384
    ds_read_b64_tr_b16 a[146:147], v13 offset:16896
    buffer_load_dwordx4 v18, s[16:19], s51 offen offset:1024 lds
    v_cvt_pk_bf16_f32 v177, v50, v51
    v_mfma_f32_32x32x16_bf16 v[32:47], a[148:151], v[116:119], v[32:47]
    ds_read_b64_tr_b16 a[148:149], v13 offset:18432
    ds_read_b64_tr_b16 a[150:151], v13 offset:18944
    v_cvt_pk_bf16_f32 v178, v52, v53
    s_waitcnt lgkmcnt(4)
    v_mfma_f32_32x32x16_bf16 v[32:47], a[152:155], v[120:123], v[32:47]
    ds_read_b64_tr_b16 a[152:153], v13 offset:20480
    ds_read_b64_tr_b16 a[154:155], v13 offset:20992
    buffer_load_dwordx4 v18, s[16:19], s52 offen offset:2048 lds
    v_cvt_pk_bf16_f32 v179, v54, v55
    v_mfma_f32_32x32x16_bf16 v[32:47], a[156:159], v[124:127], v[32:47]
    ds_read_b64_tr_b16 a[156:157], v13 offset:22528
    ds_read_b64_tr_b16 a[158:159], v13 offset:23040
    s_waitcnt lgkmcnt(4)
    v_mfma_f32_32x32x16_bf16 v[32:47], a[144:147], v[128:131], v[32:47]
    ds_read_b64_tr_b16 a[144:145], v13 offset:24576
    ds_read_b64_tr_b16 a[146:147], v13 offset:25088
    buffer_load_dwordx4 v18, s[16:19], s53 offen offset:3072 lds
    s_add_u32 m0, s78, 4096
    buffer_store_dwordx4 v[176:179], v19, s[20:23], s71 offen sc1
    v_mfma_f32_32x32x16_bf16 v[32:47], a[148:151], v[132:135], v[32:47]
    ds_read_b64_tr_b16 a[148:149], v13 offset:26624
    ds_read_b64_tr_b16 a[150:151], v13 offset:27136
    v_cvt_pk_bf16_f32 v180, v56, v57
    s_waitcnt lgkmcnt(4)
    v_mfma_f32_32x32x16_bf16 v[32:47], a[152:155], v[136:139], v[32:47]
    ds_read_b64_tr_b16 a[152:153], v13 offset:28672
    ds_read_b64_tr_b16 a[154:155], v13 offset:29184
    buffer_load_dwordx4 v18, s[16:19], s54 offen offset:0 lds
    v_cvt_pk_bf16_f32 v181, v58, v59
    v_mfma_f32_32x32x16_bf16 v[32:47], a[156:159], v[140:143], v[32:47]
    ds_read_b64_tr_b16 a[156:157], v13 offset:30720
    ds_read_b64_tr_b16 a[158:159], v13 offset:31232
    s_waitcnt lgkmcnt(4)
    v_mfma_f32_32x32x16_bf16 v[32:47], a[144:147], v[144:147], v[32:47]
    ds_read_b64_tr_b16 a[144:145], v13 offset:32768
    ds_read_b64_tr_b16 a[146:147], v13 offset:33280
    buffer_load_dwordx4 v18, s[16:19], s55 offen offset:1024 lds
    v_cvt_pk_bf16_f32 v182, v60, v61
    v_mfma_f32_32x32x16_bf16 v[32:47], a[148:151], v[148:151], v[32:47]
    ds_read_b64_tr_b16 a[148:149], v13 offset:34816
    ds_read_b64_tr_b16 a[150:151], v13 offset:35328
    v_cvt_pk_bf16_f32 v183, v62, v63
    s_waitcnt lgkmcnt(4)
    v_mfma_f32_32x32x16_bf16 v[32:47], a[152:155], v[152:155], v[32:47]
    ds_read_b64_tr_b16 a[152:153], v14 offset:0
    ds_read_b64_tr_b16 a[154:155], v14 offset:512
    buffer_load_dwordx4 v18, s[16:19], s56 offen offset:2048 lds
    buffer_store_dwordx4 v[180:183], v19, s[20:23], s71 offen offset:1024 sc1
    v_mfma_f32_32x32x16_bf16 v[32:47], a[156:159], v[156:159], v[32:47]
    ds_read_b64_tr_b16 a[156:157], v14 offset:2048
    ds_read_b64_tr_b16 a[158:159], v14 offset:2560
    s_waitcnt lgkmcnt(4)
    v_mfma_f32_32x32x16_bf16 v[32:47], a[144:147], v[160:163], v[32:47]
    ds_read_b64_tr_b16 a[144:145], v14 offset:4096
    ds_read_b64_tr_b16 a[146:147], v14 offset:4608
    buffer_load_dwordx4 v18, s[16:19], s57 offen offset:3072 lds
    s_add_u32 m0, s78, 8192
    v_mfma_f32_32x32x16_bf16 v[32:47], a[148:151], v[164:167], v[32:47]
    ds_read_b64_tr_b16 a[148:149], v14 offset:6144
    ds_read_b64_tr_b16 a[150:151], v14 offset:6656
    s_waitcnt lgkmcnt(4)
    v_mfma_f32_32x32x16_bf16 v[48:63], a[152:155], v[96:99], 0
    ds_read_b64_tr_b16 a[152:153], v14 offset:8192
    ds_read_b64_tr_b16 a[154:155], v14 offset:8704
    buffer_load_dwordx4 v18, s[16:19], s58 offen offset:0 lds
    v_mfma_f32_32x32x16_bf16 v[48:63], a[156:159], v[100:103], v[48:63]
    ds_read_b64_tr_b16 a[156:157], v14 offset:10240
    ds_read_b64_tr_b16 a[158:159], v14 offset:10752
    s_waitcnt lgkmcnt(4)
    v_mfma_f32_32x32x16_bf16 v[48:63], a[144:147], v[104:107], v[48:63]
    ds_read_b64_tr_b16 a[144:145], v14 offset:12288
    ds_read_b64_tr_b16 a[146:147], v14 offset:12800
    v_mfma_f32_32x32x16_bf16 v[48:63], a[148:151], v[108:111], v[48:63]
    ds_read_b64_tr_b16 a[148:149], v14 offset:14336
    ds_read_b64_tr_b16 a[150:151], v14 offset:14848
    v_cvt_pk_bf16_f32 v168, v32, v33
    s_waitcnt lgkmcnt(4)
    v_mfma_f32_32x32x16_bf16 v[48:63], a[152:155], v[112:115], v[48:63]
    ds_read_b64_tr_b16 a[152:153], v14 offset:16384
    ds_read_b64_tr_b16 a[154:155], v14 offset:16896
    v_cvt_pk_bf16_f32 v169, v34, v35
    s_add_u32 s74, s74, 128
    v_mfma_f32_32x32x16_bf16 v[48:63], a[156:159], v[116:119], v[48:63]
    ds_read_b64_tr_b16 a[156:157], v14 offset:18432
    ds_read_b64_tr_b16 a[158:159], v14 offset:18944
    v_cvt_pk_bf16_f32 v170, v36, v37
    s_waitcnt lgkmcnt(4)
    v_mfma_f32_32x32x16_bf16 v[48:63], a[144:147], v[120:123], v[48:63]
    ds_read_b64_tr_b16 a[144:145], v14 offset:20480
    ds_read_b64_tr_b16 a[146:147], v14 offset:20992
    v_cvt_pk_bf16_f32 v171, v38, v39
    s_add_u32 s73, s73, 36864
    s_cmp_eq_u32 s73, 147456
    s_cselect_b32 s73, 0, s73
    v_mfma_f32_32x32x16_bf16 v[48:63], a[148:151], v[124:127], v[48:63]
    ds_read_b64_tr_b16 a[148:149], v14 offset:22528
    ds_read_b64_tr_b16 a[150:151], v14 offset:23040
    buffer_store_dwordx4 v[168:171], v19, s[20:23], s70 offen sc1
    s_waitcnt lgkmcnt(4)
    v_mfma_f32_32x32x16_bf16 v[48:63], a[152:155], v[128:131], v[48:63]
    ds_read_b64_tr_b16 a[152:153], v14 offset:24576
    ds_read_b64_tr_b16 a[154:155], v14 offset:25088
    v_cvt_pk_bf16_f32 v172, v40, v41
    v_mfma_f32_32x32x16_bf16 v[48:63], a[156:159], v[132:135], v[48:63]
    ds_read_b64_tr_b16 a[156:157], v14 offset:26624
    ds_read_b64_tr_b16 a[158:159], v14 offset:27136
    v_cvt_pk_bf16_f32 v173, v42, v43
    s_waitcnt lgkmcnt(4)
    v_mfma_f32_32x32x16_bf16 v[48:63], a[144:147], v[136:139], v[48:63]
    ds_read_b64_tr_b16 a[144:145], v14 offset:28672
    ds_read_b64_tr_b16 a[146:147], v14 offset:29184
    v_cvt_pk_bf16_f32 v174, v44, v45
    v_mfma_f32_32x32x16_bf16 v[48:63], a[148:151], v[140:143], v[48:63]
    ds_read_b64_tr_b16 a[148:149], v14 offset:30720
    ds_read_b64_tr_b16 a[150:151], v14 offset:31232
    v_cvt_pk_bf16_f32 v175, v46, v47
    s_waitcnt lgkmcnt(4)
    v_mfma_f32_32x32x16_bf16 v[48:63], a[152:155], v[144:147], v[48:63]
    ds_read_b64_tr_b16 a[152:153], v14 offset:32768
    ds_read_b64_tr_b16 a[154:155], v14 offset:33280
    buffer_store_dwordx4 v[172:175], v19, s[20:23], s70 offen offset:1024 sc1
    v_mfma_f32_32x32x16_bf16 v[48:63], a[156:159], v[148:151], v[48:63]
    ds_read_b64_tr_b16 a[156:157], v14 offset:34816
    ds_read_b64_tr_b16 a[158:159], v14 offset:35328
    s_waitcnt lgkmcnt(4)
    v_mfma_f32_32x32x16_bf16 v[48:63], a[144:147], v[152:155], v[48:63]
    s_waitcnt vmcnt(14)
    s_barrier
    v_add_u32 v13, s72, v10
    v_add_u32 v14, s72, v11
    ds_read_b64_tr_b16 a[144:145], v13 offset:0
    ds_read_b64_tr_b16 a[146:147], v13 offset:512
    s_sub_u32 s37, s70, 8192
    s_cmp_ge_u32 s35, s36
    s_cselect_b32 s37, s37, 0x7ff00000
    buffer_load_dword v7, v8, s[20:23], s37 offen
    v_mfma_f32_32x32x16_bf16 v[48:63], a[148:151], v[156:159], v[48:63]
    ds_read_b64_tr_b16 a[148:149], v13 offset:2048
    ds_read_b64_tr_b16 a[150:151], v13 offset:2560
    s_add_u32 s71, s70, 2048
    s_add_u32 s70, s70, 4096
    s_waitcnt lgkmcnt(4)
    v_mfma_f32_32x32x16_bf16 v[48:63], a[152:155], v[160:163], v[48:63]
    ds_read_b64_tr_b16 a[152:153], v13 offset:4096
    ds_read_b64_tr_b16 a[154:155], v13 offset:4608
    s_add_u32 s72, s72, 36864
    s_cmp_eq_u32 s72, 147456
    s_cselect_b32 s72, 0, s72
    v_mfma_f32_32x32x16_bf16 v[48:63], a[156:159], v[164:167], v[48:63]
    ds_read_b64_tr_b16 a[156:157], v13 offset:6144
    ds_read_b64_tr_b16 a[158:159], v13 offset:6656
    s_add_u32 s35, s35, 1
    s_cmp_lt_u32 s35, 9
    s_cbranch_scc1 mega_kernel_ffn_down
    s_nop 6
    v_cvt_pk_bf16_f32 v176, v48, v49
    v_cvt_pk_bf16_f32 v177, v50, v51
    v_cvt_pk_bf16_f32 v178, v52, v53
    v_cvt_pk_bf16_f32 v179, v54, v55
    buffer_store_dwordx4 v[176:179], v19, s[20:23], s71 offen sc1
    v_cvt_pk_bf16_f32 v180, v56, v57
    v_cvt_pk_bf16_f32 v181, v58, v59
    v_cvt_pk_bf16_f32 v182, v60, v61
    v_cvt_pk_bf16_f32 v183, v62, v63
    buffer_store_dwordx4 v[180:183], v19, s[20:23], s71 offen offset:1024 sc1
    s_waitcnt vmcnt(0)
    s_barrier
    s_cmp_lg_u32 s28, 0
    s_cbranch_scc1 mega_kernel_sigd
    s_lshl_b32 s90, s30, 9
    s_lshr_b32 s91, s29, 2
    s_lshl_b32 s91, s91, 7
    s_add_u32 s90, s90, s91
    s_add_u32 s90, s90, 82665472
    s_mov_b64 s[92:93], exec
    s_mov_b64 exec, 1
    v_mov_b32 v250, 1
    v_mov_b32 v251, 0
    buffer_atomic_add v250, v251, s[20:23], s90 offen
    s_mov_b64 exec, s[92:93]
mega_kernel_sigd:
    s_load_dwordx2 s[4:5], s[0:1], 0
    s_load_dwordx2 s[6:7], s[0:1], 88
    s_load_dwordx2 s[20:21], s[0:1], 104
    v_and_b32 v1, 7, v0
    v_lshrrev_b32 v2, 3, v0
    s_mov_b32 s38, 1152
    v_mul_lo_u32 v5, v1, s38
    v_lshlrev_b32 v4, 4, v2
    v_add_u32 v5, v5, v4
    v_lshrrev_b32 v6, 4, v0
    v_lshlrev_b32 v6, 6, v6
    v_and_b32 v3, 1, v2
    v_lshlrev_b32 v3, 5, v3
    v_add3_u32 v6, v6, v3, v1
    v_lshlrev_b32 v6, 4, v6
    s_lshl_b32 s36, s30, 4
    s_add_u32 s36, s36, s29
    s_mul_i32 s32, s36, 9216
    s_lshr_b32 s33, s36, 2
    s_mul_i32 s33, s33, 36864
    s_and_b32 s36, s36, 3
    s_lshl_b32 s36, s36, 7
    s_add_u32 s33, s33, s36
    s_cmp_eq_u32 s28, 0
    s_cselect_b32 s35, 0, 0x7ff00000
    v_add_u32 v4, 160256, v4
    s_cselect_b32 s36, 1024, 0
    v_add_u32 v3, s36, v4
    s_waitcnt lgkmcnt(0)
    s_mov_b32 s8, s4
    s_mov_b32 s9, s5
    s_mov_b32 s10, 0x240000
    s_mov_b32 s11, 0x20000
    s_mov_b32 s12, s6
    s_mov_b32 s13, s7
    s_mov_b32 s14, 0x240000
    s_mov_b32 s15, 0x20000
    s_mov_b32 s22, 0x4ed8000
    s_mov_b32 s23, 0x20000
    v_lshlrev_b32 v2, 4, v0
    s_mov_b32 s36, 19712
    buffer_load_dwordx4 v[64:67], v2, s[20:23], s36 offen sc1
    s_mov_b32 s36, 33536
    buffer_load_dwordx4 v[68:71], v2, s[20:23], s36 offen sc1
    s_mov_b32 s36, 47360
    buffer_load_dwordx4 v[72:75], v2, s[20:23], s36 offen sc1
    v_lshlrev_b32 v9, 3, v0
    v_add_u32 v9, 160256, v9
    v_cmp_gt_u32 vcc, 144, v0
    s_mov_b64 s[92:93], exec
    s_waitcnt vmcnt(1)
    v_add_f32 v64, v64, v68
    v_add_f32 v65, v65, v69
    v_add_f32 v66, v66, v70
    v_add_f32 v67, v67, v71
    s_waitcnt vmcnt(0)
    v_add_f32 v64, v64, v72
    v_add_f32 v65, v65, v73
    v_add_f32 v66, v66, v74
    v_add_f32 v67, v67, v75
    v_cvt_pk_bf16_f32 v68, v64, v65
    v_cvt_pk_bf16_f32 v69, v66, v67
    s_and_b64 exec, exec, vcc
    ds_write_b64 v9, v[68:69] offset:0
    s_mov_b64 exec, s[92:93]
    s_waitcnt lgkmcnt(0)
    s_barrier
    s_lshl_b32 s83, s30, 9
    s_add_u32 s83, s83, 82665472
    s_lshr_b32 s82, s29, 2
    v_and_b32 v28, 63, v0
    v_add_u32 v28, s82, v28
    v_and_b32 v28, 3, v28
    v_lshlrev_b32 v28, 7, v28
    s_mov_b32 s84, 0
    s_mov_b32 s85, 0
    s_mov_b32 s86, 0
    s_mov_b32 s87, 0
    s_mov_b32 s60, 0x00003f80
    s_mov_b32 s61, 0x3f800000
    s_cmp_ge_u32 s84, 0x4
    s_cbranch_scc1 mega_kernel_qd0d
    s_mov_b32 s91, 0
mega_kernel_qd0l:
    buffer_load_dword v29, v28, s[20:23], s83 offen sc1
    s_waitcnt vmcnt(0)
    v_readlane_b32 s84, v29, 0
    v_readlane_b32 s85, v29, 1
    v_readlane_b32 s86, v29, 2
    v_readlane_b32 s87, v29, 3
    s_add_u32 s91, s91, 1
    s_cmp_ge_u32 s84, 0x4
    s_cbranch_scc1 mega_kernel_qd0d
    s_cmp_lt_u32 s91, 400000
    s_cbranch_scc0 mega_kernel_qd0d
    s_sleep 1
    s_branch mega_kernel_qd0l
mega_kernel_qd0d:
    s_add_u32 s37, s82, 0
    s_and_b32 s37, s37, 3
    s_mul_i32 s37, s37, 9437184
    s_add_u32 s37, s37, s33
    s_add_u32 s36, s37, 44892160
    buffer_load_dwordx4 v[64:67], v6, s[20:23], s36 offen sc1
    s_add_u32 s36, s37, 44908544
    buffer_load_dwordx4 v[128:131], v6, s[20:23], s36 offen sc1
    s_add_u32 s36, s37, 44924928
    s_add_u32 s36, s36, s35
    buffer_load_dwordx4 v[192:195], v6, s[20:23], s36 offen sc1
    s_add_u32 s36, s37, 47251456
    buffer_load_dwordx4 v[68:71], v6, s[20:23], s36 offen sc1
    s_add_u32 s36, s37, 47267840
    buffer_load_dwordx4 v[132:135], v6, s[20:23], s36 offen sc1
    s_add_u32 s36, s37, 47284224
    s_add_u32 s36, s36, s35
    buffer_load_dwordx4 v[196:199], v6, s[20:23], s36 offen sc1
    s_add_u32 s36, s37, 49610752
    buffer_load_dwordx4 v[72:75], v6, s[20:23], s36 offen sc1
    s_add_u32 s36, s37, 49627136
    buffer_load_dwordx4 v[136:139], v6, s[20:23], s36 offen sc1
    s_add_u32 s36, s37, 49643520
    s_add_u32 s36, s36, s35
    buffer_load_dwordx4 v[200:203], v6, s[20:23], s36 offen sc1
    s_add_u32 s36, s37, 51970048
    buffer_load_dwordx4 v[76:79], v6, s[20:23], s36 offen sc1
    s_add_u32 s36, s37, 51986432
    buffer_load_dwordx4 v[140:143], v6, s[20:23], s36 offen sc1
    s_add_u32 s36, s37, 52002816
    s_add_u32 s36, s36, s35
    buffer_load_dwordx4 v[204:207], v6, s[20:23], s36 offen sc1
    s_cmp_ge_u32 s85, 0x4
    s_cbranch_scc1 mega_kernel_qd1d
    s_mov_b32 s91, 0
mega_kernel_qd1l:
    buffer_load_dword v29, v28, s[20:23], s83 offen sc1
    s_waitcnt vmcnt(0)
    v_readlane_b32 s85, v29, 1
    v_readlane_b32 s86, v29, 2
    v_readlane_b32 s87, v29, 3
    s_add_u32 s91, s91, 1
    s_cmp_ge_u32 s85, 0x4
    s_cbranch_scc1 mega_kernel_qd1d
    s_cmp_lt_u32 s91, 400000
    s_cbranch_scc0 mega_kernel_qd1d
    s_sleep 1
    s_branch mega_kernel_qd1l
mega_kernel_qd1d:
    s_add_u32 s37, s82, 1
    s_and_b32 s37, s37, 3
    s_mul_i32 s37, s37, 9437184
    s_add_u32 s37, s37, s33
    s_add_u32 s36, s37, 44892160
    buffer_load_dwordx4 v[80:83], v6, s[20:23], s36 offen sc1
    s_add_u32 s36, s37, 44908544
    buffer_load_dwordx4 v[144:147], v6, s[20:23], s36 offen sc1
    s_add_u32 s36, s37, 44924928
    s_add_u32 s36, s36, s35
    buffer_load_dwordx4 v[208:211], v6, s[20:23], s36 offen sc1
    s_add_u32 s36, s37, 47251456
    buffer_load_dwordx4 v[84:87], v6, s[20:23], s36 offen sc1
    s_add_u32 s36, s37, 47267840
    buffer_load_dwordx4 v[148:151], v6, s[20:23], s36 offen sc1
    s_add_u32 s36, s37, 47284224
    s_add_u32 s36, s36, s35
    buffer_load_dwordx4 v[212:215], v6, s[20:23], s36 offen sc1
    s_add_u32 s36, s37, 49610752
    buffer_load_dwordx4 v[88:91], v6, s[20:23], s36 offen sc1
    s_add_u32 s36, s37, 49627136
    buffer_load_dwordx4 v[152:155], v6, s[20:23], s36 offen sc1
    s_add_u32 s36, s37, 49643520
    s_add_u32 s36, s36, s35
    buffer_load_dwordx4 v[216:219], v6, s[20:23], s36 offen sc1
    s_add_u32 s36, s37, 51970048
    buffer_load_dwordx4 v[92:95], v6, s[20:23], s36 offen sc1
    s_add_u32 s36, s37, 51986432
    buffer_load_dwordx4 v[156:159], v6, s[20:23], s36 offen sc1
    s_add_u32 s36, s37, 52002816
    s_add_u32 s36, s36, s35
    buffer_load_dwordx4 v[220:223], v6, s[20:23], s36 offen sc1
    s_cmp_ge_u32 s86, 0x4
    s_cbranch_scc1 mega_kernel_qd2d
    s_mov_b32 s91, 0
mega_kernel_qd2l:
    buffer_load_dword v29, v28, s[20:23], s83 offen sc1
    s_waitcnt vmcnt(0)
    v_readlane_b32 s86, v29, 2
    v_readlane_b32 s87, v29, 3
    s_add_u32 s91, s91, 1
    s_cmp_ge_u32 s86, 0x4
    s_cbranch_scc1 mega_kernel_qd2d
    s_cmp_lt_u32 s91, 400000
    s_cbranch_scc0 mega_kernel_qd2d
    s_sleep 1
    s_branch mega_kernel_qd2l
mega_kernel_qd2d:
    s_add_u32 s37, s82, 2
    s_and_b32 s37, s37, 3
    s_mul_i32 s37, s37, 9437184
    s_add_u32 s37, s37, s33
    s_add_u32 s36, s37, 44892160
    buffer_load_dwordx4 v[96:99], v6, s[20:23], s36 offen sc1
    s_add_u32 s36, s37, 44908544
    buffer_load_dwordx4 v[160:163], v6, s[20:23], s36 offen sc1
    s_add_u32 s36, s37, 44924928
    s_add_u32 s36, s36, s35
    buffer_load_dwordx4 v[224:227], v6, s[20:23], s36 offen sc1
    s_add_u32 s36, s37, 47251456
    buffer_load_dwordx4 v[100:103], v6, s[20:23], s36 offen sc1
    s_add_u32 s36, s37, 47267840
    buffer_load_dwordx4 v[164:167], v6, s[20:23], s36 offen sc1
    s_add_u32 s36, s37, 47284224
    s_add_u32 s36, s36, s35
    buffer_load_dwordx4 v[228:231], v6, s[20:23], s36 offen sc1
    s_add_u32 s36, s37, 49610752
    buffer_load_dwordx4 v[104:107], v6, s[20:23], s36 offen sc1
    s_add_u32 s36, s37, 49627136
    buffer_load_dwordx4 v[168:171], v6, s[20:23], s36 offen sc1
    s_add_u32 s36, s37, 49643520
    s_add_u32 s36, s36, s35
    buffer_load_dwordx4 v[232:235], v6, s[20:23], s36 offen sc1
    s_add_u32 s36, s37, 51970048
    buffer_load_dwordx4 v[108:111], v6, s[20:23], s36 offen sc1
    s_add_u32 s36, s37, 51986432
    buffer_load_dwordx4 v[172:175], v6, s[20:23], s36 offen sc1
    s_add_u32 s36, s37, 52002816
    s_add_u32 s36, s36, s35
    buffer_load_dwordx4 v[236:239], v6, s[20:23], s36 offen sc1
    s_cmp_ge_u32 s87, 0x4
    s_cbranch_scc1 mega_kernel_qd3d
    s_mov_b32 s91, 0
mega_kernel_qd3l:
    buffer_load_dword v29, v28, s[20:23], s83 offen sc1
    s_waitcnt vmcnt(0)
    v_readlane_b32 s87, v29, 3
    s_add_u32 s91, s91, 1
    s_cmp_ge_u32 s87, 0x4
    s_cbranch_scc1 mega_kernel_qd3d
    s_cmp_lt_u32 s91, 400000
    s_cbranch_scc0 mega_kernel_qd3d
    s_sleep 1
    s_branch mega_kernel_qd3l
mega_kernel_qd3d:
    s_add_u32 s37, s82, 3
    s_and_b32 s37, s37, 3
    s_mul_i32 s37, s37, 9437184
    s_add_u32 s37, s37, s33
    s_add_u32 s36, s37, 44892160
    buffer_load_dwordx4 v[112:115], v6, s[20:23], s36 offen sc1
    s_add_u32 s36, s37, 44908544
    buffer_load_dwordx4 v[176:179], v6, s[20:23], s36 offen sc1
    s_add_u32 s36, s37, 44924928
    s_add_u32 s36, s36, s35
    buffer_load_dwordx4 v[240:243], v6, s[20:23], s36 offen sc1
    s_add_u32 s36, s37, 47251456
    buffer_load_dwordx4 v[116:119], v6, s[20:23], s36 offen sc1
    s_add_u32 s36, s37, 47267840
    buffer_load_dwordx4 v[180:183], v6, s[20:23], s36 offen sc1
    s_add_u32 s36, s37, 47284224
    s_add_u32 s36, s36, s35
    buffer_load_dwordx4 v[244:247], v6, s[20:23], s36 offen sc1
    s_add_u32 s36, s37, 49610752
    buffer_load_dwordx4 v[120:123], v6, s[20:23], s36 offen sc1
    s_add_u32 s36, s37, 49627136
    buffer_load_dwordx4 v[184:187], v6, s[20:23], s36 offen sc1
    s_add_u32 s36, s37, 49643520
    s_add_u32 s36, s36, s35
    buffer_load_dwordx4 v[248:251], v6, s[20:23], s36 offen sc1
    s_add_u32 s36, s37, 51970048
    buffer_load_dwordx4 v[124:127], v6, s[20:23], s36 offen sc1
    s_add_u32 s36, s37, 51986432
    buffer_load_dwordx4 v[188:191], v6, s[20:23], s36 offen sc1
    s_add_u32 s36, s37, 52002816
    s_add_u32 s36, s36, s35
    buffer_load_dwordx4 v[252:255], v6, s[20:23], s36 offen sc1
    s_waitcnt vmcnt(47)
    v_lshlrev_b32 v32, 16, v64
    v_and_b32 v33, 0xffff0000, v64
    v_lshlrev_b32 v34, 16, v65
    v_and_b32 v35, 0xffff0000, v65
    v_lshlrev_b32 v36, 16, v66
    v_and_b32 v37, 0xffff0000, v66
    v_lshlrev_b32 v38, 16, v67
    v_and_b32 v39, 0xffff0000, v67
    s_waitcnt vmcnt(46)
    v_lshlrev_b32 v40, 16, v128
    v_and_b32 v41, 0xffff0000, v128
    v_lshlrev_b32 v42, 16, v129
    v_and_b32 v43, 0xffff0000, v129
    v_lshlrev_b32 v44, 16, v130
    v_and_b32 v45, 0xffff0000, v130
    v_lshlrev_b32 v46, 16, v131
    v_and_b32 v47, 0xffff0000, v131
    s_waitcnt vmcnt(45)
    v_lshlrev_b32 v48, 16, v192
    v_and_b32 v49, 0xffff0000, v192
    v_lshlrev_b32 v50, 16, v193
    v_and_b32 v51, 0xffff0000, v193
    v_lshlrev_b32 v52, 16, v194
    v_and_b32 v53, 0xffff0000, v194
    v_lshlrev_b32 v54, 16, v195
    v_and_b32 v55, 0xffff0000, v195
    s_waitcnt vmcnt(44)
    v_dot2_f32_bf16 v32, v68, s60, v32
    v_dot2_f32_bf16 v33, v68, s61, v33
    v_dot2_f32_bf16 v34, v69, s60, v34
    v_dot2_f32_bf16 v35, v69, s61, v35
    v_dot2_f32_bf16 v36, v70, s60, v36
    v_dot2_f32_bf16 v37, v70, s61, v37
    v_dot2_f32_bf16 v38, v71, s60, v38
    v_dot2_f32_bf16 v39, v71, s61, v39
    s_waitcnt vmcnt(43)
    v_dot2_f32_bf16 v40, v132, s60, v40
    v_dot2_f32_bf16 v41, v132, s61, v41
    v_dot2_f32_bf16 v42, v133, s60, v42
    v_dot2_f32_bf16 v43, v133, s61, v43
    v_dot2_f32_bf16 v44, v134, s60, v44
    v_dot2_f32_bf16 v45, v134, s61, v45
    v_dot2_f32_bf16 v46, v135, s60, v46
    v_dot2_f32_bf16 v47, v135, s61, v47
    s_waitcnt vmcnt(42)
    v_dot2_f32_bf16 v48, v196, s60, v48
    v_dot2_f32_bf16 v49, v196, s61, v49
    v_dot2_f32_bf16 v50, v197, s60, v50
    v_dot2_f32_bf16 v51, v197, s61, v51
    v_dot2_f32_bf16 v52, v198, s60, v52
    v_dot2_f32_bf16 v53, v198, s61, v53
    v_dot2_f32_bf16 v54, v199, s60, v54
    v_dot2_f32_bf16 v55, v199, s61, v55
    s_waitcnt vmcnt(41)
    v_dot2_f32_bf16 v32, v72, s60, v32
    v_dot2_f32_bf16 v33, v72, s61, v33
    v_dot2_f32_bf16 v34, v73, s60, v34
    v_dot2_f32_bf16 v35, v73, s61, v35
    v_dot2_f32_bf16 v36, v74, s60, v36
    v_dot2_f32_bf16 v37, v74, s61, v37
    v_dot2_f32_bf16 v38, v75, s60, v38
    v_dot2_f32_bf16 v39, v75, s61, v39
    s_waitcnt vmcnt(40)
    v_dot2_f32_bf16 v40, v136, s60, v40
    v_dot2_f32_bf16 v41, v136, s61, v41
    v_dot2_f32_bf16 v42, v137, s60, v42
    v_dot2_f32_bf16 v43, v137, s61, v43
    v_dot2_f32_bf16 v44, v138, s60, v44
    v_dot2_f32_bf16 v45, v138, s61, v45
    v_dot2_f32_bf16 v46, v139, s60, v46
    v_dot2_f32_bf16 v47, v139, s61, v47
    s_waitcnt vmcnt(39)
    v_dot2_f32_bf16 v48, v200, s60, v48
    v_dot2_f32_bf16 v49, v200, s61, v49
    v_dot2_f32_bf16 v50, v201, s60, v50
    v_dot2_f32_bf16 v51, v201, s61, v51
    v_dot2_f32_bf16 v52, v202, s60, v52
    v_dot2_f32_bf16 v53, v202, s61, v53
    v_dot2_f32_bf16 v54, v203, s60, v54
    v_dot2_f32_bf16 v55, v203, s61, v55
    s_waitcnt vmcnt(38)
    v_dot2_f32_bf16 v32, v76, s60, v32
    v_dot2_f32_bf16 v33, v76, s61, v33
    v_dot2_f32_bf16 v34, v77, s60, v34
    v_dot2_f32_bf16 v35, v77, s61, v35
    v_dot2_f32_bf16 v36, v78, s60, v36
    v_dot2_f32_bf16 v37, v78, s61, v37
    v_dot2_f32_bf16 v38, v79, s60, v38
    v_dot2_f32_bf16 v39, v79, s61, v39
    s_waitcnt vmcnt(37)
    v_dot2_f32_bf16 v40, v140, s60, v40
    v_dot2_f32_bf16 v41, v140, s61, v41
    v_dot2_f32_bf16 v42, v141, s60, v42
    v_dot2_f32_bf16 v43, v141, s61, v43
    v_dot2_f32_bf16 v44, v142, s60, v44
    v_dot2_f32_bf16 v45, v142, s61, v45
    v_dot2_f32_bf16 v46, v143, s60, v46
    v_dot2_f32_bf16 v47, v143, s61, v47
    s_waitcnt vmcnt(36)
    v_dot2_f32_bf16 v48, v204, s60, v48
    v_dot2_f32_bf16 v49, v204, s61, v49
    v_dot2_f32_bf16 v50, v205, s60, v50
    v_dot2_f32_bf16 v51, v205, s61, v51
    v_dot2_f32_bf16 v52, v206, s60, v52
    v_dot2_f32_bf16 v53, v206, s61, v53
    v_dot2_f32_bf16 v54, v207, s60, v54
    v_dot2_f32_bf16 v55, v207, s61, v55
    s_waitcnt vmcnt(35)
    v_dot2_f32_bf16 v32, v80, s60, v32
    v_dot2_f32_bf16 v33, v80, s61, v33
    v_dot2_f32_bf16 v34, v81, s60, v34
    v_dot2_f32_bf16 v35, v81, s61, v35
    v_dot2_f32_bf16 v36, v82, s60, v36
    v_dot2_f32_bf16 v37, v82, s61, v37
    v_dot2_f32_bf16 v38, v83, s60, v38
    v_dot2_f32_bf16 v39, v83, s61, v39
    s_waitcnt vmcnt(34)
    v_dot2_f32_bf16 v40, v144, s60, v40
    v_dot2_f32_bf16 v41, v144, s61, v41
    v_dot2_f32_bf16 v42, v145, s60, v42
    v_dot2_f32_bf16 v43, v145, s61, v43
    v_dot2_f32_bf16 v44, v146, s60, v44
    v_dot2_f32_bf16 v45, v146, s61, v45
    v_dot2_f32_bf16 v46, v147, s60, v46
    v_dot2_f32_bf16 v47, v147, s61, v47
    s_waitcnt vmcnt(33)
    v_dot2_f32_bf16 v48, v208, s60, v48
    v_dot2_f32_bf16 v49, v208, s61, v49
    v_dot2_f32_bf16 v50, v209, s60, v50
    v_dot2_f32_bf16 v51, v209, s61, v51
    v_dot2_f32_bf16 v52, v210, s60, v52
    v_dot2_f32_bf16 v53, v210, s61, v53
    v_dot2_f32_bf16 v54, v211, s60, v54
    v_dot2_f32_bf16 v55, v211, s61, v55
    s_waitcnt vmcnt(32)
    v_dot2_f32_bf16 v32, v84, s60, v32
    v_dot2_f32_bf16 v33, v84, s61, v33
    v_dot2_f32_bf16 v34, v85, s60, v34
    v_dot2_f32_bf16 v35, v85, s61, v35
    v_dot2_f32_bf16 v36, v86, s60, v36
    v_dot2_f32_bf16 v37, v86, s61, v37
    v_dot2_f32_bf16 v38, v87, s60, v38
    v_dot2_f32_bf16 v39, v87, s61, v39
    s_waitcnt vmcnt(31)
    v_dot2_f32_bf16 v40, v148, s60, v40
    v_dot2_f32_bf16 v41, v148, s61, v41
    v_dot2_f32_bf16 v42, v149, s60, v42
    v_dot2_f32_bf16 v43, v149, s61, v43
    v_dot2_f32_bf16 v44, v150, s60, v44
    v_dot2_f32_bf16 v45, v150, s61, v45
    v_dot2_f32_bf16 v46, v151, s60, v46
    v_dot2_f32_bf16 v47, v151, s61, v47
    s_waitcnt vmcnt(30)
    v_dot2_f32_bf16 v48, v212, s60, v48
    v_dot2_f32_bf16 v49, v212, s61, v49
    v_dot2_f32_bf16 v50, v213, s60, v50
    v_dot2_f32_bf16 v51, v213, s61, v51
    v_dot2_f32_bf16 v52, v214, s60, v52
    v_dot2_f32_bf16 v53, v214, s61, v53
    v_dot2_f32_bf16 v54, v215, s60, v54
    v_dot2_f32_bf16 v55, v215, s61, v55
    s_waitcnt vmcnt(29)
    v_dot2_f32_bf16 v32, v88, s60, v32
    v_dot2_f32_bf16 v33, v88, s61, v33
    v_dot2_f32_bf16 v34, v89, s60, v34
    v_dot2_f32_bf16 v35, v89, s61, v35
    v_dot2_f32_bf16 v36, v90, s60, v36
    v_dot2_f32_bf16 v37, v90, s61, v37
    v_dot2_f32_bf16 v38, v91, s60, v38
    v_dot2_f32_bf16 v39, v91, s61, v39
    s_waitcnt vmcnt(28)
    v_dot2_f32_bf16 v40, v152, s60, v40
    v_dot2_f32_bf16 v41, v152, s61, v41
    v_dot2_f32_bf16 v42, v153, s60, v42
    v_dot2_f32_bf16 v43, v153, s61, v43
    v_dot2_f32_bf16 v44, v154, s60, v44
    v_dot2_f32_bf16 v45, v154, s61, v45
    v_dot2_f32_bf16 v46, v155, s60, v46
    v_dot2_f32_bf16 v47, v155, s61, v47
    s_waitcnt vmcnt(27)
    v_dot2_f32_bf16 v48, v216, s60, v48
    v_dot2_f32_bf16 v49, v216, s61, v49
    v_dot2_f32_bf16 v50, v217, s60, v50
    v_dot2_f32_bf16 v51, v217, s61, v51
    v_dot2_f32_bf16 v52, v218, s60, v52
    v_dot2_f32_bf16 v53, v218, s61, v53
    v_dot2_f32_bf16 v54, v219, s60, v54
    v_dot2_f32_bf16 v55, v219, s61, v55
    s_waitcnt vmcnt(26)
    v_dot2_f32_bf16 v32, v92, s60, v32
    v_dot2_f32_bf16 v33, v92, s61, v33
    v_dot2_f32_bf16 v34, v93, s60, v34
    v_dot2_f32_bf16 v35, v93, s61, v35
    v_dot2_f32_bf16 v36, v94, s60, v36
    v_dot2_f32_bf16 v37, v94, s61, v37
    v_dot2_f32_bf16 v38, v95, s60, v38
    v_dot2_f32_bf16 v39, v95, s61, v39
    s_waitcnt vmcnt(25)
    v_dot2_f32_bf16 v40, v156, s60, v40
    v_dot2_f32_bf16 v41, v156, s61, v41
    v_dot2_f32_bf16 v42, v157, s60, v42
    v_dot2_f32_bf16 v43, v157, s61, v43
    v_dot2_f32_bf16 v44, v158, s60, v44
    v_dot2_f32_bf16 v45, v158, s61, v45
    v_dot2_f32_bf16 v46, v159, s60, v46
    v_dot2_f32_bf16 v47, v159, s61, v47
    s_waitcnt vmcnt(24)
    v_dot2_f32_bf16 v48, v220, s60, v48
    v_dot2_f32_bf16 v49, v220, s61, v49
    v_dot2_f32_bf16 v50, v221, s60, v50
    v_dot2_f32_bf16 v51, v221, s61, v51
    v_dot2_f32_bf16 v52, v222, s60, v52
    v_dot2_f32_bf16 v53, v222, s61, v53
    v_dot2_f32_bf16 v54, v223, s60, v54
    v_dot2_f32_bf16 v55, v223, s61, v55
    s_waitcnt vmcnt(23)
    v_dot2_f32_bf16 v32, v96, s60, v32
    v_dot2_f32_bf16 v33, v96, s61, v33
    v_dot2_f32_bf16 v34, v97, s60, v34
    v_dot2_f32_bf16 v35, v97, s61, v35
    v_dot2_f32_bf16 v36, v98, s60, v36
    v_dot2_f32_bf16 v37, v98, s61, v37
    v_dot2_f32_bf16 v38, v99, s60, v38
    v_dot2_f32_bf16 v39, v99, s61, v39
    s_waitcnt vmcnt(22)
    v_dot2_f32_bf16 v40, v160, s60, v40
    v_dot2_f32_bf16 v41, v160, s61, v41
    v_dot2_f32_bf16 v42, v161, s60, v42
    v_dot2_f32_bf16 v43, v161, s61, v43
    v_dot2_f32_bf16 v44, v162, s60, v44
    v_dot2_f32_bf16 v45, v162, s61, v45
    v_dot2_f32_bf16 v46, v163, s60, v46
    v_dot2_f32_bf16 v47, v163, s61, v47
    s_waitcnt vmcnt(21)
    v_dot2_f32_bf16 v48, v224, s60, v48
    v_dot2_f32_bf16 v49, v224, s61, v49
    v_dot2_f32_bf16 v50, v225, s60, v50
    v_dot2_f32_bf16 v51, v225, s61, v51
    v_dot2_f32_bf16 v52, v226, s60, v52
    v_dot2_f32_bf16 v53, v226, s61, v53
    v_dot2_f32_bf16 v54, v227, s60, v54
    v_dot2_f32_bf16 v55, v227, s61, v55
    s_waitcnt vmcnt(20)
    v_dot2_f32_bf16 v32, v100, s60, v32
    v_dot2_f32_bf16 v33, v100, s61, v33
    v_dot2_f32_bf16 v34, v101, s60, v34
    v_dot2_f32_bf16 v35, v101, s61, v35
    v_dot2_f32_bf16 v36, v102, s60, v36
    v_dot2_f32_bf16 v37, v102, s61, v37
    v_dot2_f32_bf16 v38, v103, s60, v38
    v_dot2_f32_bf16 v39, v103, s61, v39
    s_waitcnt vmcnt(19)
    v_dot2_f32_bf16 v40, v164, s60, v40
    v_dot2_f32_bf16 v41, v164, s61, v41
    v_dot2_f32_bf16 v42, v165, s60, v42
    v_dot2_f32_bf16 v43, v165, s61, v43
    v_dot2_f32_bf16 v44, v166, s60, v44
    v_dot2_f32_bf16 v45, v166, s61, v45
    v_dot2_f32_bf16 v46, v167, s60, v46
    v_dot2_f32_bf16 v47, v167, s61, v47
    s_waitcnt vmcnt(18)
    v_dot2_f32_bf16 v48, v228, s60, v48
    v_dot2_f32_bf16 v49, v228, s61, v49
    v_dot2_f32_bf16 v50, v229, s60, v50
    v_dot2_f32_bf16 v51, v229, s61, v51
    v_dot2_f32_bf16 v52, v230, s60, v52
    v_dot2_f32_bf16 v53, v230, s61, v53
    v_dot2_f32_bf16 v54, v231, s60, v54
    v_dot2_f32_bf16 v55, v231, s61, v55
    s_waitcnt vmcnt(17)
    v_dot2_f32_bf16 v32, v104, s60, v32
    v_dot2_f32_bf16 v33, v104, s61, v33
    v_dot2_f32_bf16 v34, v105, s60, v34
    v_dot2_f32_bf16 v35, v105, s61, v35
    v_dot2_f32_bf16 v36, v106, s60, v36
    v_dot2_f32_bf16 v37, v106, s61, v37
    v_dot2_f32_bf16 v38, v107, s60, v38
    v_dot2_f32_bf16 v39, v107, s61, v39
    s_waitcnt vmcnt(16)
    v_dot2_f32_bf16 v40, v168, s60, v40
    v_dot2_f32_bf16 v41, v168, s61, v41
    v_dot2_f32_bf16 v42, v169, s60, v42
    v_dot2_f32_bf16 v43, v169, s61, v43
    v_dot2_f32_bf16 v44, v170, s60, v44
    v_dot2_f32_bf16 v45, v170, s61, v45
    v_dot2_f32_bf16 v46, v171, s60, v46
    v_dot2_f32_bf16 v47, v171, s61, v47
    s_waitcnt vmcnt(15)
    v_dot2_f32_bf16 v48, v232, s60, v48
    v_dot2_f32_bf16 v49, v232, s61, v49
    v_dot2_f32_bf16 v50, v233, s60, v50
    v_dot2_f32_bf16 v51, v233, s61, v51
    v_dot2_f32_bf16 v52, v234, s60, v52
    v_dot2_f32_bf16 v53, v234, s61, v53
    v_dot2_f32_bf16 v54, v235, s60, v54
    v_dot2_f32_bf16 v55, v235, s61, v55
    s_waitcnt vmcnt(14)
    v_dot2_f32_bf16 v32, v108, s60, v32
    v_dot2_f32_bf16 v33, v108, s61, v33
    v_dot2_f32_bf16 v34, v109, s60, v34
    v_dot2_f32_bf16 v35, v109, s61, v35
    v_dot2_f32_bf16 v36, v110, s60, v36
    v_dot2_f32_bf16 v37, v110, s61, v37
    v_dot2_f32_bf16 v38, v111, s60, v38
    v_dot2_f32_bf16 v39, v111, s61, v39
    s_waitcnt vmcnt(13)
    v_dot2_f32_bf16 v40, v172, s60, v40
    v_dot2_f32_bf16 v41, v172, s61, v41
    v_dot2_f32_bf16 v42, v173, s60, v42
    v_dot2_f32_bf16 v43, v173, s61, v43
    v_dot2_f32_bf16 v44, v174, s60, v44
    v_dot2_f32_bf16 v45, v174, s61, v45
    v_dot2_f32_bf16 v46, v175, s60, v46
    v_dot2_f32_bf16 v47, v175, s61, v47
    s_waitcnt vmcnt(12)
    v_dot2_f32_bf16 v48, v236, s60, v48
    v_dot2_f32_bf16 v49, v236, s61, v49
    v_dot2_f32_bf16 v50, v237, s60, v50
    v_dot2_f32_bf16 v51, v237, s61, v51
    v_dot2_f32_bf16 v52, v238, s60, v52
    v_dot2_f32_bf16 v53, v238, s61, v53
    v_dot2_f32_bf16 v54, v239, s60, v54
    v_dot2_f32_bf16 v55, v239, s61, v55
    s_waitcnt vmcnt(11)
    v_dot2_f32_bf16 v32, v112, s60, v32
    v_dot2_f32_bf16 v33, v112, s61, v33
    v_dot2_f32_bf16 v34, v113, s60, v34
    v_dot2_f32_bf16 v35, v113, s61, v35
    v_dot2_f32_bf16 v36, v114, s60, v36
    v_dot2_f32_bf16 v37, v114, s61, v37
    v_dot2_f32_bf16 v38, v115, s60, v38
    v_dot2_f32_bf16 v39, v115, s61, v39
    s_waitcnt vmcnt(10)
    v_dot2_f32_bf16 v40, v176, s60, v40
    v_dot2_f32_bf16 v41, v176, s61, v41
    v_dot2_f32_bf16 v42, v177, s60, v42
    v_dot2_f32_bf16 v43, v177, s61, v43
    v_dot2_f32_bf16 v44, v178, s60, v44
    v_dot2_f32_bf16 v45, v178, s61, v45
    v_dot2_f32_bf16 v46, v179, s60, v46
    v_dot2_f32_bf16 v47, v179, s61, v47
    s_waitcnt vmcnt(9)
    v_dot2_f32_bf16 v48, v240, s60, v48
    v_dot2_f32_bf16 v49, v240, s61, v49
    v_dot2_f32_bf16 v50, v241, s60, v50
    v_dot2_f32_bf16 v51, v241, s61, v51
    v_dot2_f32_bf16 v52, v242, s60, v52
    v_dot2_f32_bf16 v53, v242, s61, v53
    v_dot2_f32_bf16 v54, v243, s60, v54
    v_dot2_f32_bf16 v55, v243, s61, v55
    s_waitcnt vmcnt(8)
    v_dot2_f32_bf16 v32, v116, s60, v32
    v_dot2_f32_bf16 v33, v116, s61, v33
    v_dot2_f32_bf16 v34, v117, s60, v34
    v_dot2_f32_bf16 v35, v117, s61, v35
    v_dot2_f32_bf16 v36, v118, s60, v36
    v_dot2_f32_bf16 v37, v118, s61, v37
    v_dot2_f32_bf16 v38, v119, s60, v38
    v_dot2_f32_bf16 v39, v119, s61, v39
    s_waitcnt vmcnt(7)
    v_dot2_f32_bf16 v40, v180, s60, v40
    v_dot2_f32_bf16 v41, v180, s61, v41
    v_dot2_f32_bf16 v42, v181, s60, v42
    v_dot2_f32_bf16 v43, v181, s61, v43
    v_dot2_f32_bf16 v44, v182, s60, v44
    v_dot2_f32_bf16 v45, v182, s61, v45
    v_dot2_f32_bf16 v46, v183, s60, v46
    v_dot2_f32_bf16 v47, v183, s61, v47
    s_waitcnt vmcnt(6)
    v_dot2_f32_bf16 v48, v244, s60, v48
    v_dot2_f32_bf16 v49, v244, s61, v49
    v_dot2_f32_bf16 v50, v245, s60, v50
    v_dot2_f32_bf16 v51, v245, s61, v51
    v_dot2_f32_bf16 v52, v246, s60, v52
    v_dot2_f32_bf16 v53, v246, s61, v53
    v_dot2_f32_bf16 v54, v247, s60, v54
    v_dot2_f32_bf16 v55, v247, s61, v55
    s_waitcnt vmcnt(5)
    v_dot2_f32_bf16 v32, v120, s60, v32
    v_dot2_f32_bf16 v33, v120, s61, v33
    v_dot2_f32_bf16 v34, v121, s60, v34
    v_dot2_f32_bf16 v35, v121, s61, v35
    v_dot2_f32_bf16 v36, v122, s60, v36
    v_dot2_f32_bf16 v37, v122, s61, v37
    v_dot2_f32_bf16 v38, v123, s60, v38
    v_dot2_f32_bf16 v39, v123, s61, v39
    s_waitcnt vmcnt(4)
    v_dot2_f32_bf16 v40, v184, s60, v40
    v_dot2_f32_bf16 v41, v184, s61, v41
    v_dot2_f32_bf16 v42, v185, s60, v42
    v_dot2_f32_bf16 v43, v185, s61, v43
    v_dot2_f32_bf16 v44, v186, s60, v44
    v_dot2_f32_bf16 v45, v186, s61, v45
    v_dot2_f32_bf16 v46, v187, s60, v46
    v_dot2_f32_bf16 v47, v187, s61, v47
    s_waitcnt vmcnt(3)
    v_dot2_f32_bf16 v48, v248, s60, v48
    v_dot2_f32_bf16 v49, v248, s61, v49
    v_dot2_f32_bf16 v50, v249, s60, v50
    v_dot2_f32_bf16 v51, v249, s61, v51
    v_dot2_f32_bf16 v52, v250, s60, v52
    v_dot2_f32_bf16 v53, v250, s61, v53
    v_dot2_f32_bf16 v54, v251, s60, v54
    v_dot2_f32_bf16 v55, v251, s61, v55
    s_waitcnt vmcnt(2)
    v_dot2_f32_bf16 v32, v124, s60, v32
    v_dot2_f32_bf16 v33, v124, s61, v33
    v_dot2_f32_bf16 v34, v125, s60, v34
    v_dot2_f32_bf16 v35, v125, s61, v35
    v_dot2_f32_bf16 v36, v126, s60, v36
    v_dot2_f32_bf16 v37, v126, s61, v37
    v_dot2_f32_bf16 v38, v127, s60, v38
    v_dot2_f32_bf16 v39, v127, s61, v39
    s_waitcnt vmcnt(1)
    v_dot2_f32_bf16 v40, v188, s60, v40
    v_dot2_f32_bf16 v41, v188, s61, v41
    v_dot2_f32_bf16 v42, v189, s60, v42
    v_dot2_f32_bf16 v43, v189, s61, v43
    v_dot2_f32_bf16 v44, v190, s60, v44
    v_dot2_f32_bf16 v45, v190, s61, v45
    v_dot2_f32_bf16 v46, v191, s60, v46
    v_dot2_f32_bf16 v47, v191, s61, v47
    s_waitcnt vmcnt(0)
    v_dot2_f32_bf16 v48, v252, s60, v48
    v_dot2_f32_bf16 v49, v252, s61, v49
    v_dot2_f32_bf16 v50, v253, s60, v50
    v_dot2_f32_bf16 v51, v253, s61, v51
    v_dot2_f32_bf16 v52, v254, s60, v52
    v_dot2_f32_bf16 v53, v254, s61, v53
    v_dot2_f32_bf16 v54, v255, s60, v54
    v_dot2_f32_bf16 v55, v255, s61, v55
    ds_read_b128 v[8:11], v4 offset:0
    s_waitcnt lgkmcnt(0)
    v_lshlrev_b32 v16, 16, v8
    v_and_b32 v17, 0xffff0000, v8
    v_lshlrev_b32 v18, 16, v9
    v_and_b32 v19, 0xffff0000, v9
    v_lshlrev_b32 v20, 16, v10
    v_and_b32 v21, 0xffff0000, v10
    v_lshlrev_b32 v22, 16, v11
    v_and_b32 v23, 0xffff0000, v11
    v_accvgpr_read_b32 v8, a160
    v_accvgpr_read_b32 v9, a161
    v_accvgpr_read_b32 v10, a162
    v_accvgpr_read_b32 v11, a163
    v_lshlrev_b32 v24, 16, v8
    v_and_b32 v25, 0xffff0000, v8
    v_lshlrev_b32 v26, 16, v9
    v_and_b32 v27, 0xffff0000, v9
    v_lshlrev_b32 v28, 16, v10
    v_and_b32 v29, 0xffff0000, v10
    v_lshlrev_b32 v30, 16, v11
    v_and_b32 v31, 0xffff0000, v11
    v_fma_f32 v32, v32, v16, v24
    v_fma_f32 v33, v33, v17, v25
    v_fma_f32 v34, v34, v18, v26
    v_fma_f32 v35, v35, v19, v27
    v_fma_f32 v36, v36, v20, v28
    v_fma_f32 v37, v37, v21, v29
    v_fma_f32 v38, v38, v22, v30
    v_fma_f32 v39, v39, v23, v31
    v_cvt_pk_bf16_f32 v8, v32, v33
    v_cvt_pk_bf16_f32 v9, v34, v35
    v_cvt_pk_bf16_f32 v10, v36, v37
    v_cvt_pk_bf16_f32 v11, v38, v39
    s_add_u32 s37, s32, 0
    buffer_store_dwordx4 v[8:11], v5, s[12:15], s37 offen offset:0 sc1
    s_nop 1
    ds_read_b128 v[8:11], v4 offset:512
    s_waitcnt lgkmcnt(0)
    v_lshlrev_b32 v16, 16, v8
    v_and_b32 v17, 0xffff0000, v8
    v_lshlrev_b32 v18, 16, v9
    v_and_b32 v19, 0xffff0000, v9
    v_lshlrev_b32 v20, 16, v10
    v_and_b32 v21, 0xffff0000, v10
    v_lshlrev_b32 v22, 16, v11
    v_and_b32 v23, 0xffff0000, v11
    v_accvgpr_read_b32 v8, a164
    v_accvgpr_read_b32 v9, a165
    v_accvgpr_read_b32 v10, a166
    v_accvgpr_read_b32 v11, a167
    v_lshlrev_b32 v24, 16, v8
    v_and_b32 v25, 0xffff0000, v8
    v_lshlrev_b32 v26, 16, v9
    v_and_b32 v27, 0xffff0000, v9
    v_lshlrev_b32 v28, 16, v10
    v_and_b32 v29, 0xffff0000, v10
    v_lshlrev_b32 v30, 16, v11
    v_and_b32 v31, 0xffff0000, v11
    v_fma_f32 v40, v40, v16, v24
    v_fma_f32 v41, v41, v17, v25
    v_fma_f32 v42, v42, v18, v26
    v_fma_f32 v43, v43, v19, v27
    v_fma_f32 v44, v44, v20, v28
    v_fma_f32 v45, v45, v21, v29
    v_fma_f32 v46, v46, v22, v30
    v_fma_f32 v47, v47, v23, v31
    v_cvt_pk_bf16_f32 v8, v40, v41
    v_cvt_pk_bf16_f32 v9, v42, v43
    v_cvt_pk_bf16_f32 v10, v44, v45
    v_cvt_pk_bf16_f32 v11, v46, v47
    s_add_u32 s37, s32, 0
    buffer_store_dwordx4 v[8:11], v5, s[12:15], s37 offen offset:512 sc1
    s_nop 1
    ds_read_b128 v[8:11], v3 offset:0
    s_waitcnt lgkmcnt(0)
    v_lshlrev_b32 v16, 16, v8
    v_and_b32 v17, 0xffff0000, v8
    v_lshlrev_b32 v18, 16, v9
    v_and_b32 v19, 0xffff0000, v9
    v_lshlrev_b32 v20, 16, v10
    v_and_b32 v21, 0xffff0000, v10
    v_lshlrev_b32 v22, 16, v11
    v_and_b32 v23, 0xffff0000, v11
    v_accvgpr_read_b32 v8, a168
    v_accvgpr_read_b32 v9, a169
    v_accvgpr_read_b32 v10, a170
    v_accvgpr_read_b32 v11, a171
    v_lshlrev_b32 v24, 16, v8
    v_and_b32 v25, 0xffff0000, v8
    v_lshlrev_b32 v26, 16, v9
    v_and_b32 v27, 0xffff0000, v9
    v_lshlrev_b32 v28, 16, v10
    v_and_b32 v29, 0xffff0000, v10
    v_lshlrev_b32 v30, 16, v11
    v_and_b32 v31, 0xffff0000, v11
    v_fma_f32 v48, v48, v16, v24
    v_fma_f32 v49, v49, v17, v25
    v_fma_f32 v50, v50, v18, v26
    v_fma_f32 v51, v51, v19, v27
    v_fma_f32 v52, v52, v20, v28
    v_fma_f32 v53, v53, v21, v29
    v_fma_f32 v54, v54, v22, v30
    v_fma_f32 v55, v55, v23, v31
    v_cvt_pk_bf16_f32 v8, v48, v49
    v_cvt_pk_bf16_f32 v9, v50, v51
    v_cvt_pk_bf16_f32 v10, v52, v53
    v_cvt_pk_bf16_f32 v11, v54, v55
    s_add_u32 s37, s32, 0
    s_add_u32 s37, s37, s35
    buffer_store_dwordx4 v[8:11], v5, s[12:15], s37 offen offset:1024 sc1
    s_waitcnt vmcnt(0)
    s_branch mega_kernel_end
mega_kernel_att_slowA:
    s_nop 15
    v_mov_b32 v27, v25
    s_nop 1
    v_permlane32_swap_b32 v27, v25
    v_max_f32 v25, v25, v27
    v_max_f32 v25, s41, v25
    v_sub_f32 v32, v32, v25
    v_sub_f32 v64, v64, v25
    v_sub_f32 v33, v33, v25
    v_sub_f32 v65, v65, v25
    v_sub_f32 v34, v34, v25
    v_sub_f32 v66, v66, v25
    v_sub_f32 v35, v35, v25
    v_sub_f32 v67, v67, v25
    v_sub_f32 v36, v36, v25
    v_sub_f32 v68, v68, v25
    v_sub_f32 v37, v37, v25
    v_sub_f32 v69, v69, v25
    v_sub_f32 v38, v38, v25
    v_sub_f32 v70, v70, v25
    v_sub_f32 v39, v39, v25
    v_sub_f32 v71, v71, v25
    v_sub_f32 v40, v40, v25
    v_sub_f32 v72, v72, v25
    v_sub_f32 v41, v41, v25
    v_sub_f32 v73, v73, v25
    v_sub_f32 v42, v42, v25
    v_sub_f32 v74, v74, v25
    v_sub_f32 v43, v43, v25
    v_sub_f32 v75, v75, v25
    v_sub_f32 v44, v44, v25
    v_sub_f32 v76, v76, v25
    v_sub_f32 v45, v45, v25
    v_sub_f32 v77, v77, v25
    v_sub_f32 v46, v46, v25
    v_sub_f32 v78, v78, v25
    v_sub_f32 v47, v47, v25
    v_sub_f32 v79, v79, v25
    v_max_f32 v27, 0, v25
    v_exp_f32 v27, -v27
    s_mov_b32 s39, 0x41800000
    s_mov_b32 s41, 0
    v_mul_f32 v112, v112, v27
    v_mul_f32 v113, v113, v27
    v_mul_f32 v114, v114, v27
    v_mul_f32 v115, v115, v27
    v_mul_f32 v116, v116, v27
    v_mul_f32 v117, v117, v27
    v_mul_f32 v118, v118, v27
    v_mul_f32 v119, v119, v27
    v_mul_f32 v120, v120, v27
    v_mul_f32 v121, v121, v27
    v_mul_f32 v122, v122, v27
    v_mul_f32 v123, v123, v27
    v_mul_f32 v124, v124, v27
    v_mul_f32 v125, v125, v27
    v_mul_f32 v126, v126, v27
    v_mul_f32 v127, v127, v27
    v_mul_f32 v128, v128, v27
    v_mul_f32 v129, v129, v27
    v_mul_f32 v130, v130, v27
    v_mul_f32 v131, v131, v27
    v_mul_f32 v132, v132, v27
    v_mul_f32 v133, v133, v27
    v_mul_f32 v134, v134, v27
    v_mul_f32 v135, v135, v27
    v_mul_f32 v136, v136, v27
    v_mul_f32 v137, v137, v27
    v_mul_f32 v138, v138, v27
    v_mul_f32 v139, v139, v27
    v_mul_f32 v140, v140, v27
    v_mul_f32 v141, v141, v27
    v_mul_f32 v142, v142, v27
    v_mul_f32 v143, v143, v27
    v_mul_f32 v144, v144, v27
    v_mul_f32 v145, v145, v27
    v_mul_f32 v146, v146, v27
    v_mul_f32 v147, v147, v27
    v_mul_f32 v148, v148, v27
    v_mul_f32 v149, v149, v27
    v_mul_f32 v150, v150, v27
    v_mul_f32 v151, v151, v27
    v_mul_f32 v152, v152, v27
    v_mul_f32 v153, v153, v27
    v_mul_f32 v154, v154, v27
    v_mul_f32 v155, v155, v27
    v_mul_f32 v156, v156, v27
    v_mul_f32 v157, v157, v27
    v_mul_f32 v158, v158, v27
    v_mul_f32 v159, v159, v27
    v_mul_f32 v160, v160, v27
    v_mul_f32 v161, v161, v27
    v_mul_f32 v162, v162, v27
    v_mul_f32 v163, v163, v27
    v_mul_f32 v164, v164, v27
    v_mul_f32 v165, v165, v27
    v_mul_f32 v166, v166, v27
    v_mul_f32 v167, v167, v27
    v_mul_f32 v168, v168, v27
    v_mul_f32 v169, v169, v27
    v_mul_f32 v170, v170, v27
    v_mul_f32 v171, v171, v27
    v_mul_f32 v172, v172, v27
    v_mul_f32 v173, v173, v27
    v_mul_f32 v174, v174, v27
    v_mul_f32 v175, v175, v27
    v_mul_f32 v23, v23, v27
    s_nop 3
    s_branch mega_kernel_att_backA
mega_kernel_att_slowB:
    s_nop 15
    v_mov_b32 v27, v26
    s_nop 1
    v_permlane32_swap_b32 v27, v26
    v_max_f32 v26, v26, v27
    v_max_f32 v26, s42, v26
    v_sub_f32 v48, v48, v26
    v_sub_f32 v80, v80, v26
    v_sub_f32 v49, v49, v26
    v_sub_f32 v81, v81, v26
    v_sub_f32 v50, v50, v26
    v_sub_f32 v82, v82, v26
    v_sub_f32 v51, v51, v26
    v_sub_f32 v83, v83, v26
    v_sub_f32 v52, v52, v26
    v_sub_f32 v84, v84, v26
    v_sub_f32 v53, v53, v26
    v_sub_f32 v85, v85, v26
    v_sub_f32 v54, v54, v26
    v_sub_f32 v86, v86, v26
    v_sub_f32 v55, v55, v26
    v_sub_f32 v87, v87, v26
    v_sub_f32 v56, v56, v26
    v_sub_f32 v88, v88, v26
    v_sub_f32 v57, v57, v26
    v_sub_f32 v89, v89, v26
    v_sub_f32 v58, v58, v26
    v_sub_f32 v90, v90, v26
    v_sub_f32 v59, v59, v26
    v_sub_f32 v91, v91, v26
    v_sub_f32 v60, v60, v26
    v_sub_f32 v92, v92, v26
    v_sub_f32 v61, v61, v26
    v_sub_f32 v93, v93, v26
    v_sub_f32 v62, v62, v26
    v_sub_f32 v94, v94, v26
    v_sub_f32 v63, v63, v26
    v_sub_f32 v95, v95, v26
    v_max_f32 v27, 0, v26
    v_exp_f32 v27, -v27
    s_mov_b32 s40, 0x41800000
    s_mov_b32 s42, 0
    v_mul_f32 v176, v176, v27
    v_mul_f32 v177, v177, v27
    v_mul_f32 v178, v178, v27
    v_mul_f32 v179, v179, v27
    v_mul_f32 v180, v180, v27
    v_mul_f32 v181, v181, v27
    v_mul_f32 v182, v182, v27
    v_mul_f32 v183, v183, v27
    v_mul_f32 v184, v184, v27
    v_mul_f32 v185, v185, v27
    v_mul_f32 v186, v186, v27
    v_mul_f32 v187, v187, v27
    v_mul_f32 v188, v188, v27
    v_mul_f32 v189, v189, v27
    v_mul_f32 v190, v190, v27
    v_mul_f32 v191, v191, v27
    v_mul_f32 v192, v192, v27
    v_mul_f32 v193, v193, v27
    v_mul_f32 v194, v194, v27
    v_mul_f32 v195, v195, v27
    v_mul_f32 v196, v196, v27
    v_mul_f32 v197, v197, v27
    v_mul_f32 v198, v198, v27
    v_mul_f32 v199, v199, v27
    v_mul_f32 v200, v200, v27
    v_mul_f32 v201, v201, v27
    v_mul_f32 v202, v202, v27
    v_mul_f32 v203, v203, v27
    v_mul_f32 v204, v204, v27
    v_mul_f32 v205, v205, v27
    v_mul_f32 v206, v206, v27
    v_mul_f32 v207, v207, v27
    v_mul_f32 v208, v208, v27
    v_mul_f32 v209, v209, v27
    v_mul_f32 v210, v210, v27
    v_mul_f32 v211, v211, v27
    v_mul_f32 v212, v212, v27
    v_mul_f32 v213, v213, v27
    v_mul_f32 v214, v214, v27
    v_mul_f32 v215, v215, v27
    v_mul_f32 v216, v216, v27
    v_mul_f32 v217, v217, v27
    v_mul_f32 v218, v218, v27
    v_mul_f32 v219, v219, v27
    v_mul_f32 v220, v220, v27
    v_mul_f32 v221, v221, v27
    v_mul_f32 v222, v222, v27
    v_mul_f32 v223, v223, v27
    v_mul_f32 v224, v224, v27
    v_mul_f32 v225, v225, v27
    v_mul_f32 v226, v226, v27
    v_mul_f32 v227, v227, v27
    v_mul_f32 v228, v228, v27
    v_mul_f32 v229, v229, v27
    v_mul_f32 v230, v230, v27
    v_mul_f32 v231, v231, v27
    v_mul_f32 v232, v232, v27
    v_mul_f32 v233, v233, v27
    v_mul_f32 v234, v234, v27
    v_mul_f32 v235, v235, v27
    v_mul_f32 v236, v236, v27
    v_mul_f32 v237, v237, v27
    v_mul_f32 v238, v238, v27
    v_mul_f32 v239, v239, v27
    v_mul_f32 v24, v24, v27
    s_nop 3
    s_branch mega_kernel_att_backB

mega_kernel_end:
    s_endpgm

.section .rodata,"a"
.p2align 6
.amdhsa_kernel mega_kernel
  .amdhsa_next_free_vgpr 512
  .amdhsa_next_free_sgpr 102
  .amdhsa_accum_offset 256
  .amdhsa_group_segment_fixed_size 0
  .amdhsa_kernarg_size 112
  .amdhsa_user_sgpr_count 2
  .amdhsa_user_sgpr_kernarg_segment_ptr 1
  .amdhsa_system_sgpr_workgroup_id_x 1
  .amdhsa_float_denorm_mode_32 3
.end_amdhsa_kernel
.text
```
